```python
import torch

def _softmax(x, axis=-1):
    return torch.softmax(x, dim=axis)
def _gelu(x):
    return torch.nn.functional.gelu(x, approximate="tanh")
def _silu(x):
    return torch.nn.functional.silu(x)
def _sigmoid(x):
    return torch.sigmoid(x)
def _layernorm(x, axis=-1, eps=1e-5):
    m = x.mean(dim=axis, keepdim=True)
    v = x.var(dim=axis, keepdim=True, unbiased=False)
    return (x - m) / torch.sqrt(v + eps)
def _scatter_add(tgt, idx, src, axis=0):
    return tgt.clone().index_add_(axis, idx, src)
def _segment_sum(src, seg, n):
    out = torch.zeros((n,) + src.shape[1:], dtype=src.dtype)
    return out.index_add_(0, seg, src)
def _pad(x, pw):
    flat = tuple(v for pair in reversed(pw) for v in pair)
    return torch.nn.functional.pad(x, flat)

kernel_name = 'interleave_layers__sliding_block__glu_gated_reglu__prompt'

def setup_inputs():

    _w = (lambda a: (lambda t: t.to(torch.bfloat16) if t.is_floating_point() else t)(torch.as_tensor(a)))
    def _A_setup():
        B, S, D = 1, 2048, 512
        return {
            "x": _w((lambda *s: torch.randn(*s, dtype=torch.bfloat16) * 0.05)(B, S, D)),
            "wqkv": _w((lambda *s: torch.randn(*s, dtype=torch.bfloat16) * 0.05)(D, 3 * D)),
            "wo": _w((lambda *s: torch.randn(*s, dtype=torch.bfloat16) * 0.05)(D, D)),
        }
    _A_in = _A_setup()

    def _B_setup():
        B, S, D, F = 1, 2048, 512, 1792
        return {
            "x": _w((lambda *s: torch.randn(*s, dtype=torch.bfloat16) * 0.05)(B, S, D)),
            "W_gate": _w((lambda *s: torch.randn(*s, dtype=torch.bfloat16) * 0.8)(D, F) * (2.0 / D) ** 0.5),
            "W_up": _w((lambda *s: torch.randn(*s, dtype=torch.bfloat16) * 0.8)(D, F) * (2.0 / D) ** 0.5),
            "W_down": _w((lambda *s: torch.randn(*s, dtype=torch.bfloat16) * 0.8)(F, D) * (1.0 / F) ** 0.5),
        }
    _B_in = _B_setup()

    return {
        "A_x": _A_in["x"],
        "A_wqkv": _A_in["wqkv"],
        "A_wo": _A_in["wo"],
        "B_x": _B_in["x"],
        "B_W_gate": _B_in["W_gate"],
        "B_W_up": _B_in["W_up"],
        "B_W_down": _B_in["W_down"],
    }

def reference(A_x, A_wqkv, A_wo, B_x, B_W_gate, B_W_up, B_W_down):
    def _A_ref(x, wqkv, wo):
        B, S, D = x.shape
        H = 32; Dh = D // H; W = 256
        qkv = (lambda x, *d: x.permute(*d))((x @ wqkv).reshape(B, S, 3, H, Dh), 2, 0, 3, 1, 4)
        q, k, v = qkv[0], qkv[1], qkv[2]
        scores = torch.einsum("bhqd,bhkd->bhqk", q, k) * (Dh ** -0.5)
        idx = torch.arange(S)
        mask = (idx[:, None] - idx[None, :] >= 0) & (idx[:, None] - idx[None, :] < W)
        scores = torch.where(mask[None, None], scores, -1e9)
        p = _softmax(scores, axis=-1)
        o = torch.einsum("bhqk,bhkd->bhqd", p, v)
        return (lambda x, *d: x.permute(*d))(o, 0, 2, 1, 3).reshape(B, S, D) @ wo

    def _B_ref(x, W_gate, W_up, W_down):
        gate = torch.einsum("bsd,df->bsf", x, W_gate)
        up = torch.einsum("bsd,df->bsf", x, W_up)
        gate = gate * (lambda x, dt: x.to(dt))(gate > 0, gate.dtype)
        h = gate * up
        return torch.einsum("bsf,fd->bsd", h, W_down)

    x = A_x
    x = x + _A_ref(_layernorm(x, axis=-1), A_wqkv, A_wo)
    x = x + _B_ref(_layernorm(x, axis=-1), B_W_gate, B_W_up, B_W_down)
    x = x + _A_ref(_layernorm(x, axis=-1), A_wqkv, A_wo)
    x = x + _B_ref(_layernorm(x, axis=-1), B_W_gate, B_W_up, B_W_down)
    return x
```

```asm
; @launch grid=(256,1,1) block=(256,1,1) lds=163840
.amdgcn_target "amdgcn-amd-amdhsa--gfx950"
.text
.globl interleave_layers__sliding_block__glu_gated_reglu__prompt_kernel
.p2align 8
.type interleave_layers__sliding_block__glu_gated_reglu__prompt_kernel,@function
interleave_layers__sliding_block__glu_gated_reglu__prompt_kernel:
    s_cmp_ge_u32 s2, 256
    s_cbranch_scc1 L_end
    s_load_dwordx16 s[64:79], s[0:1], 0
    s_load_dwordx4 s[80:83], s[0:1], 64
    s_memrealtime s[42:43]
    v_lshrrev_b32 v18, 6, v0
    v_and_b32 v0, 63, v0
    v_readfirstlane_b32 s36, v18
    s_and_b32 s58, s2, 6
    s_lshl_b32 s37, s58, 1
    s_lshr_b32 s60, s2, 6
    s_add_u32 s37, s37, s60
    s_bfe_u32 s59, s2, 0x30003
    s_and_b32 s58, s2, 1
    s_lshl_b32 s38, s58, 3
    s_add_u32 s38, s38, s59
    s_getpc_b64 s[84:85]
L_pc:
    s_mov_b32 s86, L_end - L_pc
    s_mov_b32 s87, 0x20000
    s_lshr_b32 s58, s2, 3
    s_lshl_b32 s58, s58, 2
    s_add_u32 s58, s58, s36
    s_mul_i32 s58, s58, 384
    v_lshlrev_b32 v255, 7, v0
    s_and_b32 s59, s2, 0xe7
    s_cbranch_scc0 L_nocode
    s_mov_b64 exec, 7
    buffer_load_dword v255, v255, s[84:87], s58 offen
    s_mov_b64 exec, -1
L_nocode:
    s_lshl_b32 s48, s37, 2
    s_add_u32 s48, s48, s36
    s_mul_i32 s51, s36, 3072
    s_mul_i32 s59, s36, 49152
    s_lshl_b32 s60, s38, 6
    s_add_u32 s59, s59, s60
    v_add_u32 v18, 0, v0
    v_mul_u32_u24 v19, 5462, v18
    v_lshrrev_b32 v19, 16, v19
    v_mul_u32_u24 v20, 12, v19
    v_sub_u32 v20, v18, v20
    v_lshrrev_b32 v22, 1, v19
    v_xor_b32 v22, v22, v19
    v_bfe_u32 v22, v22, 2, 1
    v_mul_u32_u24 v19, 3072, v19
    v_lshrrev_b32 v21, 2, v20
    v_lshl_add_u32 v19, v21, 10, v19
    v_and_b32 v20, 3, v20
    v_lshl_add_u32 v241, v20, 7, v19
    v_lshl_add_u32 v19, v20, 4, v19
    v_lshlrev_b32 v22, 5, v22
    v_xor_b32 v19, v22, v19
    v_add_u32 v2, s59, v19
    v_add_u32 v18, 64, v0
    v_mul_u32_u24 v19, 5462, v18
    v_lshrrev_b32 v19, 16, v19
    v_mul_u32_u24 v20, 12, v19
    v_sub_u32 v20, v18, v20
    v_lshrrev_b32 v22, 1, v19
    v_xor_b32 v22, v22, v19
    v_bfe_u32 v22, v22, 2, 1
    v_mul_u32_u24 v19, 3072, v19
    v_lshrrev_b32 v21, 2, v20
    v_lshl_add_u32 v19, v21, 10, v19
    v_and_b32 v20, 3, v20
    v_lshl_add_u32 v19, v20, 4, v19
    v_lshlrev_b32 v22, 5, v22
    v_xor_b32 v19, v22, v19
    v_add_u32 v3, s59, v19
    v_subrev_u32 v3, 1024, v3
    v_add_u32 v18, 128, v0
    v_mul_u32_u24 v19, 5462, v18
    v_lshrrev_b32 v19, 16, v19
    v_mul_u32_u24 v20, 12, v19
    v_sub_u32 v20, v18, v20
    v_lshrrev_b32 v22, 1, v19
    v_xor_b32 v22, v22, v19
    v_bfe_u32 v22, v22, 2, 1
    v_mul_u32_u24 v19, 3072, v19
    v_lshrrev_b32 v21, 2, v20
    v_lshl_add_u32 v19, v21, 10, v19
    v_and_b32 v20, 3, v20
    v_lshl_add_u32 v19, v20, 4, v19
    v_lshlrev_b32 v22, 5, v22
    v_xor_b32 v19, v22, v19
    v_add_u32 v4, s59, v19
    v_subrev_u32 v4, 2048, v4
    v_lshrrev_b32 v18, 3, v0
    v_and_b32 v19, 7, v0
    v_lshlrev_b32 v23, 7, v0
    s_lshr_b32 s58, s2, 3
    s_lshl_b32 s58, s58, 2
    s_add_u32 s58, s58, s36
    s_mul_i32 s3, s58, 12288
    s_and_b32 s61, s2, 1
    s_lshl_b32 s61, s61, 9
    s_add_u32 s3, s3, s61
    s_lshl_b32 s58, s58, 12
    s_and_b32 s61, s2, 6
    s_lshl_b32 s61, s61, 18
    s_add_u32 s58, s58, s61
    v_lshrrev_b32 v20, 1, v18
    v_xor_b32 v19, v19, v20
    v_lshlrev_b32 v19, 4, v19
    v_lshl_add_u32 v224, v18, 10, v19
    v_xor_b32 v225, 64, v224
    v_add_u32 v226, 14336, v224
    v_add_u32 v227, 21504, v225
    v_add_u32 v225, 7168, v225
    s_lshl_b32 s93, s48, 15
    s_lshl_b32 s45, s37, 1
    s_xor_b32 s45, s45, s38
    s_and_b32 s45, s45, 7
    s_lshl_b32 s89, s45, 7
    s_add_u32 s93, s93, s89
    s_lshl_b32 s89, s36, 14
    s_add_u32 s89, s89, 98304
    s_waitcnt lgkmcnt(0)
    s_mov_b32 s4, s64
    s_mov_b32 s5, s65
    s_mov_b32 s6, 2097152
    s_mov_b32 s7, 0x20000
    s_mov_b32 s8, s66
    s_mov_b32 s9, s67
    s_mov_b32 s10, 1572864
    s_mov_b32 s11, 0x20000
    s_mov_b32 s32, s80
    s_mov_b32 s33, s81
    s_mov_b32 s34, 256
    s_mov_b32 s35, 0x20000
    s_mov_b32 s24, s82
    s_mov_b32 s25, s83
    s_mov_b32 s26, 268435456
    s_mov_b32 s27, 0x20000
    s_and_b32 s61, s2, 0xe7
    s_cbranch_scc1 L_nat_1
    s_cmp_lg_u32 s36, 0
    s_cbranch_scc1 L_nat_2
    s_mov_b64 exec, 1
    s_lshl_b32 s61, s2, 9
    s_and_b32 s61, s61, 0x2000
    s_mul_i32 s62, s2, 144
    s_add_u32 s61, s61, s62
    s_xor_b32 s62, s61, 0x2000
    buffer_store_dword v0, off, s[24:27], s61 offset:1024 sc1
    buffer_store_dword v0, off, s[24:27], s62 offset:1024 sc1
    s_lshl_b64 s[42:43], s[42:43], 4
    s_or_b32 s43, s43, 0x40000000
    v_mov_b32 v250, s42
    v_mov_b32 v251, s43
    s_lshr_b32 s61, s2, 3
    s_waitcnt vmcnt(1)
    s_memtime s[84:85]
    s_waitcnt vmcnt(0)
    s_memtime s[86:87]
    s_waitcnt lgkmcnt(0)
    s_sub_u32 s62, s86, s84
    s_lshr_b32 s62, s62, 1
    s_min_u32 s62, s62, 255
    s_or_b32 s62, s62, 1
    v_mov_b32 v252, s62
    buffer_store_byte v252, off, s[32:35], s61 offset:8 sc1
    s_cmp_eq_u32 s2, 0
    s_cselect_b64 exec, 1, 0
    buffer_store_dwordx2 v[250:251], off, s[32:35], 0 sc1
    s_mov_b64 exec, -1
L_nat_2:
    s_barrier
L_nat_1:
    s_mov_b32 exec_lo, 0x88888888
    s_mov_b32 exec_hi, 0x8888
    buffer_load_dword v255, v241, s[8:11], s3 offen offset:0
    s_mov_b64 exec, -1
    s_mov_b32 exec_hi, -1
    s_xor_b32 s98, s45, 0
    s_mul_i32 s98, s98, 196608
    s_add_u32 m0, s51, 0
    s_nop 0
    buffer_load_dwordx4 v2, s[8:11], s98 offen offset:0 lds
    buffer_load_dwordx4 v3, s[8:11], s98 offen offset:1024 lds
    buffer_load_dwordx4 v4, s[8:11], s98 offen offset:2048 lds
    s_xor_b32 s99, s93, 0
    s_add_u32 m0, s89, 0
    s_nop 0
    buffer_load_dwordx4 v224, s[4:7], s99 offen offset:0 lds
    buffer_load_dwordx4 v225, s[4:7], s99 offen offset:1024 lds
    buffer_load_dwordx4 v226, s[4:7], s99 offen offset:2048 lds
    buffer_load_dwordx4 v227, s[4:7], s99 offen offset:3072 lds
    s_xor_b32 s98, s45, 1
    s_mul_i32 s98, s98, 196608
    s_add_u32 m0, s51, 12288
    s_nop 0
    buffer_load_dwordx4 v2, s[8:11], s98 offen offset:0 lds
    s_mov_b32 s12, s68
    s_mov_b32 s13, s69
    s_mov_b32 s14, 524288
    s_mov_b32 s15, 0x20000
    s_mov_b32 s20, s76
    s_mov_b32 s21, s77
    s_mov_b32 s22, 1835008
    s_mov_b32 s23, 0x20000
    s_mov_b32 s28, s78
    s_mov_b32 s29, s79
    buffer_load_dwordx4 v3, s[8:11], s98 offen offset:1024 lds
    s_mov_b32 s30, 2097152
    s_mov_b32 s31, 0x20000
    s_lshr_b32 s63, s36, 1
    s_and_b32 s95, s36, 1
    s_cmp_eq_u32 s63, 0
    s_cselect_b32 s16, s72, s74
    s_cselect_b32 s17, s73, s75
    s_lshr_b32 s0, s2, 3
    s_lshl_b32 s61, s0, 1
    s_lshl_b32 s0, s0, 2
    s_add_u32 s0, s0, s36
    s_and_b32 s1, s2, 1
    buffer_load_dwordx4 v4, s[8:11], s98 offen offset:2048 lds
    s_add_u32 s61, s61, s95
    s_mul_i32 s61, s61, 28672
    v_lshrrev_b32 v18, 1, v0
    v_and_b32 v19, 1, v18
    v_lshlrev_b32 v19, 9, v19
    s_lshl_b32 s59, s1, 10
    s_add_u32 s59, s59, 384
    v_add_u32 v19, s59, v19
    v_and_b32 v20, 1, v0
    s_xor_b32 s99, s93, 128
    s_add_u32 m0, s89, 4096
    s_nop 0
    buffer_load_dwordx4 v224, s[4:7], s99 offen offset:0 lds
    v_lshl_add_u32 v19, v20, 11, v19
    v_min_u32 v20, 0xd80, v19
    v_mov_b32 v21, 2944
    v_cmp_eq_u32 vcc, v19, v20
    v_mul_u32_u24 v18, 3584, v18
    s_lshl_b32 s1, s1, 9
    v_cndmask_b32 v19, v21, v19, vcc
    v_add3_u32 v243, v18, v19, s61
    s_mov_b32 s18, 1835008
    buffer_load_dwordx4 v225, s[4:7], s99 offen offset:1024 lds
    s_mov_b32 s19, 0x20000
    s_and_b32 s61, s38, 1
    s_lshl_b32 s58, s61, 1
    s_lshl_b32 s49, s37, 2
    s_add_u32 s49, s49, s58
    s_add_u32 s49, s49, s95
    s_lshr_b32 s58, s38, 1
    s_lshl_b32 s50, s58, 1
    s_add_u32 s50, s50, s63
    buffer_load_dwordx4 v226, s[4:7], s99 offen offset:2048 lds
    s_mul_i32 s52, s63, 12416
    s_mul_i32 s59, s95, 6144
    s_add_u32 s52, s52, s59
    s_mul_i32 s96, s95, 229376
    s_cmp_eq_u32 s36, 0
    s_cselect_b64 s[100:101], -1, 0
    s_lshl_b32 s53, s36, 13
    s_lshl_b32 s59, s95, 16
    s_lshl_b32 s54, s63, 18
    s_add_u32 s54, s54, s59
    buffer_load_dwordx4 v227, s[4:7], s99 offen offset:3072 lds
    s_lshl_b32 s59, s58, 7
    s_add_u32 s54, s54, s59
    s_and_b32 s59, s38, 7
    s_lshl_b32 s60, s59, 1
    s_and_b32 s55, s60, 14
    s_xor_b32 s55, s55, s36
    s_lshl_b32 s55, s55, 15
    s_and_b32 s97, s60, 0
    s_xor_b32 s97, s97, s36
    s_xor_b32 s98, s45, 2
    s_mul_i32 s98, s98, 196608
    s_add_u32 m0, s51, 24576
    s_nop 0
    buffer_load_dwordx4 v2, s[8:11], s98 offen offset:0 lds
    s_lshl_b32 s97, s97, 15
    s_lshl_b32 s59, s59, 7
    s_add_u32 s55, s55, s59
    s_add_u32 s97, s97, s59
    s_lshr_b32 s60, s38, 3
    s_lshl_b32 s59, s60, 19
    s_add_u32 s55, s55, s59
    s_mul_i32 s59, s60, 393216
    s_add_u32 s97, s97, s59
    buffer_load_dwordx4 v3, s[8:11], s98 offen offset:1024 lds
    s_add_u32 s97, s97, 1048576
    s_mov_b32 s56, 0xffff0000
    s_mov_b32 s90, 0x3f803f80
    s_mov_b32 s86, 0
    s_mov_b32 s87, -1
    s_and_b32 s57, s48, -2
    s_min_u32 s57, s57, 8
    s_add_u32 s57, s57, 1
    s_mov_b32 s62, 200000
    buffer_load_dwordx4 v4, s[8:11], s98 offen offset:2048 lds
    s_mov_b32 s39, 4194304
    s_mov_b32 s40, 0
    s_mov_b32 s41, 0
    s_mul_i32 s88, s37, 262144
    s_lshl_b32 s59, s38, 3
    s_add_u32 s88, s88, s59
    s_lshl1_add_u32 s94, s38, s63
    s_lshl3_add_u32 s94, s94, s95
    s_mul_i32 s94, s94, 6144
    s_xor_b32 s99, s93, 256
    s_add_u32 m0, s89, 8192
    s_nop 0
    buffer_load_dwordx4 v224, s[4:7], s99 offen offset:0 lds
    s_add_u32 s94, s94, 104857600
    v_lshlrev_b32 v1, 4, v0
    v_lshrrev_b32 v18, 3, v0
    v_and_b32 v19, 6, v18
    v_and_b32 v20, 7, v0
    v_xor_b32 v20, v20, v19
    v_lshlrev_b32 v20, 4, v20
    v_lshl_add_u32 v12, v18, 10, v20
    v_xor_b32 v14, 64, v12
    buffer_load_dwordx4 v225, s[4:7], s99 offen offset:1024 lds
    v_add_u32 v15, 14336, v12
    v_add_u32 v228, 21504, v14
    v_add_u32 v14, 7168, v14
    v_lshrrev_b32 v18, 3, v0
    v_and_b32 v19, 6, v18
    v_and_b32 v20, 7, v0
    v_xor_b32 v20, v20, v19
    v_lshlrev_b32 v20, 4, v20
    v_mul_u32_u24 v18, 3584, v18
    buffer_load_dwordx4 v226, s[4:7], s99 offen offset:2048 lds
    s_lshl_b32 s59, s38, 7
    v_add3_u32 v5, v18, v20, s59
    v_add_u32 v6, 27648, v5
    v_add_u32 v7, 55296, v5
    v_add_u32 v8, 82944, v5
    s_mul_i32 s59, s38, 96
    v_add_u32 v18, 0, v0
    v_mul_u32_u24 v19, 10923, v18
    v_lshrrev_b32 v19, 16, v19
    buffer_load_dwordx4 v227, s[4:7], s99 offen offset:3072 lds
    v_mul_u32_u24 v20, 6, v19
    v_sub_u32 v20, v18, v20
    v_mul_u32_u24 v19, 3584, v19
    v_lshl_add_u32 v19, v20, 4, v19
    v_add_u32 v9, s59, v19
    v_add_u32 v9, 2048, v9
    v_add_u32 v18, 64, v0
    v_mul_u32_u24 v19, 10923, v18
    v_lshrrev_b32 v19, 16, v19
    s_xor_b32 s98, s45, 3
    s_mul_i32 s98, s98, 196608
    s_add_u32 m0, s51, 36864
    s_nop 0
    buffer_load_dwordx4 v2, s[8:11], s98 offen offset:0 lds
    v_mul_u32_u24 v20, 6, v19
    v_sub_u32 v20, v18, v20
    v_mul_u32_u24 v19, 3584, v19
    v_lshl_add_u32 v19, v20, 4, v19
    v_add_u32 v10, s59, v19
    v_add_u32 v10, 1024, v10
    v_and_b32 v18, 15, v0
    v_lshlrev_b32 v18, 3, v18
    s_and_b32 s59, s88, -128
    buffer_load_dwordx4 v3, s[8:11], s98 offen offset:1024 lds
    v_add_u32 v13, s59, v18
    s_sub_u32 s59, s88, 262144
    s_cmp_ge_u32 s37, 1
    s_cselect_b32 s59, s59, s88
    s_sub_u32 s60, s88, 524288
    s_cmp_ge_u32 s37, 2
    s_cselect_b32 s60, s60, s88
    v_mov_b32 v16, s59
    v_writelane_b32 v16, s60, 1
    v_and_b32 v18, 15, v0
    v_lshrrev_b32 v19, 4, v0
    buffer_load_dwordx4 v4, s[8:11], s98 offen offset:2048 lds
    v_lshlrev_b32 v20, 9, v19
    v_lshl_add_u32 v254, v18, 4, v20
    v_lshlrev_b32 v19, 3, v19
    v_lshl_add_u32 v17, v18, 10, v19
    s_lshl_b32 s91, s49, 15
    s_lshl_b32 s59, s50, 6
    s_add_u32 s91, s91, s59
    v_mov_b32 v236, s90
    v_mov_b32 v237, s90
    s_xor_b32 s99, s93, 384
    s_add_u32 m0, s89, 12288
    s_nop 0
    buffer_load_dwordx4 v224, s[4:7], s99 offen offset:0 lds
    v_mov_b32 v238, s90
    v_mov_b32 v239, s90
    v_and_b32 v18, 15, v0
    v_lshrrev_b32 v19, 4, v0
    v_lshrrev_b32 v20, 1, v18
    v_xor_b32 v19, v19, v20
    v_lshlrev_b32 v19, 4, v19
    v_lshl_add_u32 v18, v18, 7, v19
    s_lshl_b32 s59, s95, 6
    buffer_load_dwordx4 v225, s[4:7], s99 offen offset:1024 lds
    v_xor_b32 v18, s59, v18
    v_add_u32 v244, s89, v18
    v_xor_b32 v245, 64, v244
    v_add_u32 v248, s89, v1
    v_and_b32 v18, 15, v0
    v_lshrrev_b32 v19, 2, v18
    v_lshrrev_b32 v20, 4, v0
    v_lshl_add_u32 v19, v20, 3, v19
    v_mul_u32_u24 v19, 192, v19
    buffer_load_dwordx4 v226, s[4:7], s99 offen offset:2048 lds
    v_and_b32 v18, 3, v18
    v_lshl_add_u32 v19, v18, 3, v19
    v_xor_b32 v20, s63, v20
    v_and_b32 v20, 1, v20
    v_lshl_add_u32 v28, v20, 5, v19
    v_xor_b32 v29, 32, v28
    s_xor_b32 s59, s95, 0
    s_mul_i32 s59, s59, 6144
    v_add_u32 v18, s59, v28
    buffer_load_dwordx4 v227, s[4:7], s99 offen offset:3072 lds
    v_add_u32 v22, 49152, v18
    v_add_u32 v19, s59, v29
    v_add_u32 v23, 49152, v19
    s_xor_b32 s59, s95, 1
    s_mul_i32 s59, s59, 6144
    v_add_u32 v20, s59, v28
    v_add_u32 v24, 49152, v20
    v_add_u32 v21, s59, v29
    v_add_u32 v25, 49152, v21
    s_waitcnt vmcnt(21)
    ds_read_b128 v[96:99], v244 offset:0
    ds_read_b128 v[100:103], v244 offset:2048
    ds_read_b128 v[104:107], v245 offset:0
    ds_read_b128 v[108:111], v245 offset:2048
    s_barrier
    ds_read_b64_tr_b16 a[8:9], v18 offset:64
    ds_read_b64_tr_b16 a[10:11], v19 offset:832
    ds_read_b64_tr_b16 a[12:13], v19 offset:64
    ds_read_b64_tr_b16 a[14:15], v18 offset:832
    ds_read_b64_tr_b16 a[16:17], v18 offset:128
    ds_read_b64_tr_b16 a[18:19], v19 offset:896
    ds_read_b64_tr_b16 a[20:21], v19 offset:128
    ds_read_b64_tr_b16 a[22:23], v18 offset:896
    ds_read_b64_tr_b16 a[64:65], v18 offset:0
    ds_read_b64_tr_b16 a[66:67], v19 offset:768
    ds_read_b64_tr_b16 a[68:69], v19 offset:0
    ds_read_b64_tr_b16 a[70:71], v18 offset:768
    s_waitcnt lgkmcnt(8)
    v_mfma_f32_16x16x32_bf16 v[48:51], a[8:11], v[96:99], 0
    ds_read_b64_tr_b16 a[32:33], v20 offset:64
    s_xor_b32 s98, s45, 4
    v_mfma_f32_16x16x32_bf16 v[52:55], a[8:11], v[100:103], 0
    ds_read_b64_tr_b16 a[34:35], v21 offset:832
    s_mul_i32 s98, s98, 196608
    v_mfma_f32_16x16x32_bf16 v[56:59], a[12:15], v[96:99], 0
    ds_read_b64_tr_b16 a[36:37], v21 offset:64
    s_add_u32 m0, s51, 49152
    v_mfma_f32_16x16x32_bf16 v[60:63], a[12:15], v[100:103], 0
    ds_read_b64_tr_b16 a[38:39], v20 offset:832
    s_waitcnt lgkmcnt(8)
    v_mfma_f32_16x16x32_bf16 v[64:67], v[96:99], a[16:19], 0
    ds_read_b64_tr_b16 a[40:41], v20 offset:128
    buffer_load_dwordx4 v2, s[8:11], s98 offen offset:0 lds
    v_mfma_f32_16x16x32_bf16 v[68:71], v[100:103], a[16:19], 0
    ds_read_b64_tr_b16 a[42:43], v21 offset:896
    buffer_load_dwordx4 v3, s[8:11], s98 offen offset:1024 lds
    v_mfma_f32_16x16x32_bf16 v[72:75], v[96:99], a[20:23], 0
    ds_read_b64_tr_b16 a[44:45], v21 offset:128
    v_mfma_f32_16x16x32_bf16 v[76:79], v[100:103], a[20:23], 0
    ds_read_b64_tr_b16 a[46:47], v20 offset:896
    v_mfma_f32_16x16x32_bf16 v[80:83], v[96:99], v[96:99], 0
    ds_read_b64_tr_b16 a[72:73], v20 offset:0
    v_mfma_f32_16x16x32_bf16 v[88:91], v[236:239], v[96:99], 0
    ds_read_b64_tr_b16 a[74:75], v21 offset:768
    buffer_load_dwordx4 v4, s[8:11], s98 offen offset:2048 lds
    v_mfma_f32_16x16x32_bf16 v[84:87], v[100:103], v[100:103], 0
    ds_read_b64_tr_b16 a[76:77], v21 offset:0
    v_mfma_f32_16x16x32_bf16 v[92:95], v[236:239], v[100:103], 0
    ds_read_b64_tr_b16 a[78:79], v20 offset:768
    v_mfma_f32_16x16x32_bf16 a[52:55], v[236:239], a[8:11], 0
    s_xor_b32 s99, s93, 512
    v_mfma_f32_16x16x32_bf16 a[56:59], v[236:239], a[16:19], 0
    buffer_load_dwordx4 v[160:163], v224, s[4:7], s99 offen offset:0
    s_waitcnt lgkmcnt(12)
    v_mfma_f32_16x16x32_bf16 a[48:51], v[236:239], a[64:67], 0
    s_waitcnt vmcnt(22)
    s_barrier
    s_waitcnt lgkmcnt(8)
    v_mfma_f32_16x16x32_bf16 v[48:51], a[32:35], v[104:107], v[48:51]
    ds_read_b64_tr_b16 a[8:9], v18 offset:12352
    v_mfma_f32_16x16x32_bf16 v[52:55], a[32:35], v[108:111], v[52:55]
    ds_read_b64_tr_b16 a[10:11], v19 offset:13120
    v_mfma_f32_16x16x32_bf16 v[56:59], a[36:39], v[104:107], v[56:59]
    ds_read_b64_tr_b16 a[12:13], v19 offset:12352
    buffer_load_dwordx4 v[164:167], v225, s[4:7], s99 offen offset:1024
    v_mfma_f32_16x16x32_bf16 v[60:63], a[36:39], v[108:111], v[60:63]
    ds_read_b64_tr_b16 a[14:15], v18 offset:13120
    s_waitcnt vmcnt(19)
    ds_read_b128 v[112:115], v244 offset:4096
    s_waitcnt lgkmcnt(9)
    v_mfma_f32_16x16x32_bf16 v[64:67], v[104:107], a[40:43], v[64:67]
    ds_read_b64_tr_b16 a[16:17], v18 offset:12416
    v_mfma_f32_16x16x32_bf16 v[68:71], v[108:111], a[40:43], v[68:71]
    ds_read_b64_tr_b16 a[18:19], v19 offset:13184
    ds_read_b128 v[116:119], v244 offset:6144
    v_mfma_f32_16x16x32_bf16 v[72:75], v[104:107], a[44:47], v[72:75]
    ds_read_b64_tr_b16 a[20:21], v19 offset:12416
    buffer_load_dwordx4 v[168:171], v226, s[4:7], s99 offen offset:2048
    v_mfma_f32_16x16x32_bf16 v[76:79], v[108:111], a[44:47], v[76:79]
    ds_read_b64_tr_b16 a[22:23], v18 offset:13184
    ds_read_b128 v[120:123], v245 offset:4096
    v_mfma_f32_16x16x32_bf16 v[80:83], v[104:107], v[104:107], v[80:83]
    ds_read_b64_tr_b16 a[80:81], v18 offset:12288
    v_mfma_f32_16x16x32_bf16 v[88:91], v[236:239], v[104:107], v[88:91]
    ds_read_b64_tr_b16 a[82:83], v19 offset:13056
    ds_read_b128 v[124:127], v245 offset:6144
    v_mfma_f32_16x16x32_bf16 v[84:87], v[108:111], v[108:111], v[84:87]
    ds_read_b64_tr_b16 a[84:85], v19 offset:12288
    buffer_load_dwordx4 v[172:175], v227, s[4:7], s99 offen offset:3072
    v_mfma_f32_16x16x32_bf16 v[92:95], v[236:239], v[108:111], v[92:95]
    ds_read_b64_tr_b16 a[86:87], v18 offset:13056
    s_waitcnt lgkmcnt(8)
    v_mfma_f32_16x16x32_bf16 v[48:51], a[8:11], v[112:115], v[48:51]
    ds_read_b64_tr_b16 a[32:33], v20 offset:12352
    s_xor_b32 s98, s45, 5
    v_mfma_f32_16x16x32_bf16 v[52:55], a[8:11], v[116:119], v[52:55]
    ds_read_b64_tr_b16 a[34:35], v21 offset:13120
    s_mul_i32 s98, s98, 196608
    v_mfma_f32_16x16x32_bf16 v[56:59], a[12:15], v[112:115], v[56:59]
    ds_read_b64_tr_b16 a[36:37], v21 offset:12352
    s_add_u32 m0, s51, 61440
    v_mfma_f32_16x16x32_bf16 v[60:63], a[12:15], v[116:119], v[60:63]
    ds_read_b64_tr_b16 a[38:39], v20 offset:13120
    s_waitcnt lgkmcnt(10)
    v_mfma_f32_16x16x32_bf16 v[64:67], v[112:115], a[16:19], v[64:67]
    ds_read_b64_tr_b16 a[40:41], v20 offset:12416
    buffer_load_dwordx4 v2, s[8:11], s98 offen offset:0 lds
    v_mfma_f32_16x16x32_bf16 v[68:71], v[116:119], a[16:19], v[68:71]
    ds_read_b64_tr_b16 a[42:43], v21 offset:13184
    v_mfma_f32_16x16x32_bf16 v[72:75], v[112:115], a[20:23], v[72:75]
    ds_read_b64_tr_b16 a[44:45], v21 offset:12416
    buffer_load_dwordx4 v3, s[8:11], s98 offen offset:1024 lds
    v_mfma_f32_16x16x32_bf16 v[76:79], v[116:119], a[20:23], v[76:79]
    ds_read_b64_tr_b16 a[46:47], v20 offset:13184
    v_mfma_f32_16x16x32_bf16 v[80:83], v[112:115], v[112:115], v[80:83]
    ds_read_b64_tr_b16 a[88:89], v20 offset:12288
    v_mfma_f32_16x16x32_bf16 v[88:91], v[236:239], v[112:115], v[88:91]
    ds_read_b64_tr_b16 a[90:91], v21 offset:13056
    v_mfma_f32_16x16x32_bf16 v[84:87], v[116:119], v[116:119], v[84:87]
    ds_read_b64_tr_b16 a[92:93], v21 offset:12288
    buffer_load_dwordx4 v4, s[8:11], s98 offen offset:2048 lds
    v_mfma_f32_16x16x32_bf16 v[92:95], v[236:239], v[116:119], v[92:95]
    ds_read_b64_tr_b16 a[94:95], v20 offset:13056
    v_mfma_f32_16x16x32_bf16 a[52:55], v[236:239], a[8:11], a[52:55]
    v_mfma_f32_16x16x32_bf16 a[56:59], v[236:239], a[16:19], a[56:59]
    s_xor_b32 s99, s93, 640
    s_waitcnt lgkmcnt(12)
    v_mfma_f32_16x16x32_bf16 a[48:51], v[236:239], a[80:83], a[48:51]
    buffer_load_dwordx4 v[176:179], v224, s[4:7], s99 offen offset:0
    s_waitcnt vmcnt(22)
    s_barrier
    s_waitcnt lgkmcnt(8)
    v_mfma_f32_16x16x32_bf16 v[48:51], a[32:35], v[120:123], v[48:51]
    ds_read_b64_tr_b16 a[8:9], v18 offset:24640
    v_mfma_f32_16x16x32_bf16 v[52:55], a[32:35], v[124:127], v[52:55]
    ds_read_b64_tr_b16 a[10:11], v19 offset:25408
    v_mfma_f32_16x16x32_bf16 v[56:59], a[36:39], v[120:123], v[56:59]
    ds_read_b64_tr_b16 a[12:13], v19 offset:24640
    v_mfma_f32_16x16x32_bf16 v[60:63], a[36:39], v[124:127], v[60:63]
    ds_read_b64_tr_b16 a[14:15], v18 offset:25408
    s_waitcnt vmcnt(18)
    ds_read_b128 v[128:131], v244 offset:8192
    s_waitcnt lgkmcnt(9)
    v_mfma_f32_16x16x32_bf16 v[64:67], v[120:123], a[40:43], v[64:67]
    ds_read_b64_tr_b16 a[16:17], v18 offset:24704
    buffer_load_dwordx4 v[180:183], v225, s[4:7], s99 offen offset:1024
    v_mfma_f32_16x16x32_bf16 v[68:71], v[124:127], a[40:43], v[68:71]
    ds_read_b64_tr_b16 a[18:19], v19 offset:25472
    ds_read_b128 v[132:135], v244 offset:10240
    v_mfma_f32_16x16x32_bf16 v[72:75], v[120:123], a[44:47], v[72:75]
    ds_read_b64_tr_b16 a[20:21], v19 offset:24704
    v_mfma_f32_16x16x32_bf16 v[76:79], v[124:127], a[44:47], v[76:79]
    ds_read_b64_tr_b16 a[22:23], v18 offset:25472
    ds_read_b128 v[136:139], v245 offset:8192
    v_mfma_f32_16x16x32_bf16 v[80:83], v[120:123], v[120:123], v[80:83]
    ds_read_b64_tr_b16 a[96:97], v18 offset:24576
    buffer_load_dwordx4 v[184:187], v226, s[4:7], s99 offen offset:2048
    v_mfma_f32_16x16x32_bf16 v[88:91], v[236:239], v[120:123], v[88:91]
    ds_read_b64_tr_b16 a[98:99], v19 offset:25344
    ds_read_b128 v[140:143], v245 offset:10240
    v_mfma_f32_16x16x32_bf16 v[84:87], v[124:127], v[124:127], v[84:87]
    ds_read_b64_tr_b16 a[100:101], v19 offset:24576
    v_mfma_f32_16x16x32_bf16 v[92:95], v[236:239], v[124:127], v[92:95]
    ds_read_b64_tr_b16 a[102:103], v18 offset:25344
    s_waitcnt lgkmcnt(8)
    v_mfma_f32_16x16x32_bf16 v[48:51], a[8:11], v[128:131], v[48:51]
    ds_read_b64_tr_b16 a[32:33], v20 offset:24640
    buffer_load_dwordx4 v[188:191], v227, s[4:7], s99 offen offset:3072
    v_mfma_f32_16x16x32_bf16 v[52:55], a[8:11], v[132:135], v[52:55]
    ds_read_b64_tr_b16 a[34:35], v21 offset:25408
    s_xor_b32 s98, s45, 6
    v_mfma_f32_16x16x32_bf16 v[56:59], a[12:15], v[128:131], v[56:59]
    ds_read_b64_tr_b16 a[36:37], v21 offset:24640
    s_mul_i32 s98, s98, 196608
    v_mfma_f32_16x16x32_bf16 v[60:63], a[12:15], v[132:135], v[60:63]
    ds_read_b64_tr_b16 a[38:39], v20 offset:25408
    s_waitcnt lgkmcnt(10)
    v_mfma_f32_16x16x32_bf16 v[64:67], v[128:131], a[16:19], v[64:67]
    ds_read_b64_tr_b16 a[40:41], v20 offset:24704
    s_add_u32 m0, s51, 73728
    v_mfma_f32_16x16x32_bf16 v[68:71], v[132:135], a[16:19], v[68:71]
    ds_read_b64_tr_b16 a[42:43], v21 offset:25472
    buffer_load_dwordx4 v2, s[8:11], s98 offen offset:0 lds
    v_mfma_f32_16x16x32_bf16 v[72:75], v[128:131], a[20:23], v[72:75]
    ds_read_b64_tr_b16 a[44:45], v21 offset:24704
    v_mfma_f32_16x16x32_bf16 v[76:79], v[132:135], a[20:23], v[76:79]
    ds_read_b64_tr_b16 a[46:47], v20 offset:25472
    buffer_load_dwordx4 v3, s[8:11], s98 offen offset:1024 lds
    v_mfma_f32_16x16x32_bf16 v[80:83], v[128:131], v[128:131], v[80:83]
    ds_read_b64_tr_b16 a[104:105], v20 offset:24576
    v_mfma_f32_16x16x32_bf16 v[88:91], v[236:239], v[128:131], v[88:91]
    ds_read_b64_tr_b16 a[106:107], v21 offset:25344
    v_mfma_f32_16x16x32_bf16 v[84:87], v[132:135], v[132:135], v[84:87]
    ds_read_b64_tr_b16 a[108:109], v21 offset:24576
    v_mfma_f32_16x16x32_bf16 v[92:95], v[236:239], v[132:135], v[92:95]
    ds_read_b64_tr_b16 a[110:111], v20 offset:25344
    buffer_load_dwordx4 v4, s[8:11], s98 offen offset:2048 lds
    v_mfma_f32_16x16x32_bf16 a[52:55], v[236:239], a[8:11], a[52:55]
    v_mfma_f32_16x16x32_bf16 a[56:59], v[236:239], a[16:19], a[56:59]
    s_waitcnt lgkmcnt(12)
    v_mfma_f32_16x16x32_bf16 a[48:51], v[236:239], a[96:99], a[48:51]
    s_xor_b32 s99, s93, 768
    s_waitcnt vmcnt(21)
    s_barrier
    s_waitcnt lgkmcnt(8)
    v_mfma_f32_16x16x32_bf16 v[48:51], a[32:35], v[136:139], v[48:51]
    ds_read_b64_tr_b16 a[8:9], v18 offset:36928
    buffer_load_dwordx4 v[192:195], v224, s[4:7], s99 offen offset:0
    v_mfma_f32_16x16x32_bf16 v[52:55], a[32:35], v[140:143], v[52:55]
    ds_read_b64_tr_b16 a[10:11], v19 offset:37696
    v_mfma_f32_16x16x32_bf16 v[56:59], a[36:39], v[136:139], v[56:59]
    ds_read_b64_tr_b16 a[12:13], v19 offset:36928
    v_mfma_f32_16x16x32_bf16 v[60:63], a[36:39], v[140:143], v[60:63]
    ds_read_b64_tr_b16 a[14:15], v18 offset:37696
    s_waitcnt vmcnt(18)
    ds_read_b128 v[144:147], v244 offset:12288
    s_waitcnt lgkmcnt(9)
    v_mfma_f32_16x16x32_bf16 v[64:67], v[136:139], a[40:43], v[64:67]
    ds_read_b64_tr_b16 a[16:17], v18 offset:36992
    buffer_load_dwordx4 v[196:199], v225, s[4:7], s99 offen offset:1024
    v_mfma_f32_16x16x32_bf16 v[68:71], v[140:143], a[40:43], v[68:71]
    ds_read_b64_tr_b16 a[18:19], v19 offset:37760
    ds_read_b128 v[148:151], v244 offset:14336
    v_mfma_f32_16x16x32_bf16 v[72:75], v[136:139], a[44:47], v[72:75]
    ds_read_b64_tr_b16 a[20:21], v19 offset:36992
    v_mfma_f32_16x16x32_bf16 v[76:79], v[140:143], a[44:47], v[76:79]
    ds_read_b64_tr_b16 a[22:23], v18 offset:37760
    ds_read_b128 v[152:155], v245 offset:12288
    v_mfma_f32_16x16x32_bf16 v[80:83], v[136:139], v[136:139], v[80:83]
    ds_read_b64_tr_b16 a[112:113], v18 offset:36864
    buffer_load_dwordx4 v[200:203], v226, s[4:7], s99 offen offset:2048
    v_mfma_f32_16x16x32_bf16 v[88:91], v[236:239], v[136:139], v[88:91]
    ds_read_b64_tr_b16 a[114:115], v19 offset:37632
    ds_read_b128 v[156:159], v245 offset:14336
    v_mfma_f32_16x16x32_bf16 v[84:87], v[140:143], v[140:143], v[84:87]
    ds_read_b64_tr_b16 a[116:117], v19 offset:36864
    v_mfma_f32_16x16x32_bf16 v[92:95], v[236:239], v[140:143], v[92:95]
    ds_read_b64_tr_b16 a[118:119], v18 offset:37632
    s_waitcnt lgkmcnt(8)
    v_mfma_f32_16x16x32_bf16 v[48:51], a[8:11], v[144:147], v[48:51]
    ds_read_b64_tr_b16 a[32:33], v20 offset:36928
    buffer_load_dwordx4 v[204:207], v227, s[4:7], s99 offen offset:3072
    v_mfma_f32_16x16x32_bf16 v[52:55], a[8:11], v[148:151], v[52:55]
    ds_read_b64_tr_b16 a[34:35], v21 offset:37696
    s_waitcnt vmcnt(17)
    ds_write_b128 v248, v[160:163] offset:0
    v_mfma_f32_16x16x32_bf16 v[56:59], a[12:15], v[144:147], v[56:59]
    ds_read_b64_tr_b16 a[36:37], v21 offset:36928
    s_xor_b32 s98, s45, 7
    v_mfma_f32_16x16x32_bf16 v[60:63], a[12:15], v[148:151], v[60:63]
    ds_read_b64_tr_b16 a[38:39], v20 offset:37696
    s_waitcnt lgkmcnt(11)
    v_mfma_f32_16x16x32_bf16 v[64:67], v[144:147], a[16:19], v[64:67]
    ds_read_b64_tr_b16 a[40:41], v20 offset:36992
    s_waitcnt vmcnt(16)
    ds_write_b128 v248, v[164:167] offset:1024
    v_mfma_f32_16x16x32_bf16 v[68:71], v[148:151], a[16:19], v[68:71]
    ds_read_b64_tr_b16 a[42:43], v21 offset:37760
    s_mul_i32 s98, s98, 196608
    v_mfma_f32_16x16x32_bf16 v[72:75], v[144:147], a[20:23], v[72:75]
    ds_read_b64_tr_b16 a[44:45], v21 offset:36992
    s_add_u32 m0, s51, 86016
    v_mfma_f32_16x16x32_bf16 v[76:79], v[148:151], a[20:23], v[76:79]
    ds_read_b64_tr_b16 a[46:47], v20 offset:37760
    s_waitcnt vmcnt(15)
    ds_write_b128 v248, v[168:171] offset:2048
    v_mfma_f32_16x16x32_bf16 v[80:83], v[144:147], v[144:147], v[80:83]
    ds_read_b64_tr_b16 a[120:121], v20 offset:36864
    buffer_load_dwordx4 v2, s[8:11], s98 offen offset:0 lds
    v_mfma_f32_16x16x32_bf16 v[88:91], v[236:239], v[144:147], v[88:91]
    ds_read_b64_tr_b16 a[122:123], v21 offset:37632
    buffer_load_dwordx4 v3, s[8:11], s98 offen offset:1024 lds
    v_mfma_f32_16x16x32_bf16 v[84:87], v[148:151], v[148:151], v[84:87]
    ds_read_b64_tr_b16 a[124:125], v21 offset:36864
    s_waitcnt vmcnt(16)
    ds_write_b128 v248, v[172:175] offset:3072
    v_mfma_f32_16x16x32_bf16 v[92:95], v[236:239], v[148:151], v[92:95]
    ds_read_b64_tr_b16 a[126:127], v20 offset:37632
    v_mfma_f32_16x16x32_bf16 a[52:55], v[236:239], a[8:11], a[52:55]
    buffer_load_dwordx4 v4, s[8:11], s98 offen offset:2048 lds
    v_mfma_f32_16x16x32_bf16 a[56:59], v[236:239], a[16:19], a[56:59]
    s_waitcnt lgkmcnt(15)
    v_mfma_f32_16x16x32_bf16 a[48:51], v[236:239], a[112:115], a[48:51]
    s_barrier
    s_waitcnt lgkmcnt(11)
    v_mfma_f32_16x16x32_bf16 v[48:51], a[32:35], v[152:155], v[48:51]
    ds_read_b64_tr_b16 a[8:9], v22 offset:64
    s_xor_b32 s99, s93, 896
    v_mfma_f32_16x16x32_bf16 v[52:55], a[32:35], v[156:159], v[52:55]
    ds_read_b64_tr_b16 a[10:11], v23 offset:832
    buffer_load_dwordx4 v[208:211], v224, s[4:7], s99 offen offset:0
    v_mfma_f32_16x16x32_bf16 v[56:59], a[36:39], v[152:155], v[56:59]
    ds_read_b64_tr_b16 a[12:13], v23 offset:64
    v_mfma_f32_16x16x32_bf16 v[60:63], a[36:39], v[156:159], v[60:63]
    ds_read_b64_tr_b16 a[14:15], v22 offset:832
    ds_read_b128 v[160:163], v244 offset:0
    s_waitcnt lgkmcnt(11)
    v_mfma_f32_16x16x32_bf16 v[64:67], v[152:155], a[40:43], v[64:67]
    ds_read_b64_tr_b16 a[16:17], v22 offset:128
    v_mfma_f32_16x16x32_bf16 v[68:71], v[156:159], a[40:43], v[68:71]
    ds_read_b64_tr_b16 a[18:19], v23 offset:896
    ds_read_b128 v[164:167], v244 offset:2048
    v_mfma_f32_16x16x32_bf16 v[72:75], v[152:155], a[44:47], v[72:75]
    ds_read_b64_tr_b16 a[20:21], v23 offset:128
    buffer_load_dwordx4 v[212:215], v225, s[4:7], s99 offen offset:1024
    v_mfma_f32_16x16x32_bf16 v[76:79], v[156:159], a[44:47], v[76:79]
    ds_read_b64_tr_b16 a[22:23], v22 offset:896
    ds_read_b128 v[168:171], v245 offset:0
    v_mfma_f32_16x16x32_bf16 v[80:83], v[152:155], v[152:155], v[80:83]
    ds_read_b64_tr_b16 a[128:129], v22 offset:0
    v_mfma_f32_16x16x32_bf16 v[88:91], v[236:239], v[152:155], v[88:91]
    ds_read_b64_tr_b16 a[130:131], v23 offset:768
    ds_read_b128 v[172:175], v245 offset:2048
    v_mfma_f32_16x16x32_bf16 v[84:87], v[156:159], v[156:159], v[84:87]
    ds_read_b64_tr_b16 a[132:133], v23 offset:0
    buffer_load_dwordx4 v[216:219], v226, s[4:7], s99 offen offset:2048
    v_mfma_f32_16x16x32_bf16 v[92:95], v[236:239], v[156:159], v[92:95]
    ds_read_b64_tr_b16 a[134:135], v22 offset:768
    s_waitcnt lgkmcnt(8)
    v_mfma_f32_16x16x32_bf16 v[48:51], a[8:11], v[160:163], v[48:51]
    ds_read_b64_tr_b16 a[32:33], v24 offset:64
    v_mfma_f32_16x16x32_bf16 v[52:55], a[8:11], v[164:167], v[52:55]
    ds_read_b64_tr_b16 a[34:35], v25 offset:832
    s_waitcnt vmcnt(16)
    ds_write_b128 v248, v[176:179] offset:4096
    v_mfma_f32_16x16x32_bf16 v[56:59], a[12:15], v[160:163], v[56:59]
    ds_read_b64_tr_b16 a[36:37], v25 offset:64
    buffer_load_dwordx4 v[220:223], v227, s[4:7], s99 offen offset:3072
    v_mfma_f32_16x16x32_bf16 v[60:63], a[12:15], v[164:167], v[60:63]
    ds_read_b64_tr_b16 a[38:39], v24 offset:832
    s_waitcnt lgkmcnt(11)
    v_mfma_f32_16x16x32_bf16 v[64:67], v[160:163], a[16:19], v[64:67]
    ds_read_b64_tr_b16 a[40:41], v24 offset:128
    s_waitcnt vmcnt(16)
    ds_write_b128 v248, v[180:183] offset:5120
    v_mfma_f32_16x16x32_bf16 v[68:71], v[164:167], a[16:19], v[68:71]
    ds_read_b64_tr_b16 a[42:43], v25 offset:896
    s_lshr_b32 s3, s37, 1
    v_mfma_f32_16x16x32_bf16 v[72:75], v[160:163], a[20:23], v[72:75]
    ds_read_b64_tr_b16 a[44:45], v25 offset:128
    s_and_b32 s59, s37, 1
    v_mfma_f32_16x16x32_bf16 v[76:79], v[164:167], a[20:23], v[76:79]
    ds_read_b64_tr_b16 a[46:47], v24 offset:896
    s_waitcnt vmcnt(15)
    ds_write_b128 v248, v[184:187] offset:6144
    v_mfma_f32_16x16x32_bf16 v[80:83], v[160:163], v[160:163], v[80:83]
    ds_read_b64_tr_b16 a[136:137], v24 offset:0
    s_mul_i32 s3, s3, 12288
    v_mfma_f32_16x16x32_bf16 v[88:91], v[236:239], v[160:163], v[88:91]
    ds_read_b64_tr_b16 a[138:139], v25 offset:768
    s_mul_i32 s59, s59, 1536
    v_mfma_f32_16x16x32_bf16 v[84:87], v[164:167], v[164:167], v[84:87]
    ds_read_b64_tr_b16 a[140:141], v25 offset:0
    s_waitcnt vmcnt(14)
    ds_write_b128 v248, v[188:191] offset:7168
    v_mfma_f32_16x16x32_bf16 v[92:95], v[236:239], v[164:167], v[92:95]
    ds_read_b64_tr_b16 a[142:143], v24 offset:768
    s_add_u32 s3, s3, s51
    v_mfma_f32_16x16x32_bf16 a[52:55], v[236:239], a[8:11], a[52:55]
    s_add_u32 s3, s3, s59
    s_lshr_b32 s59, s37, 1
    v_mfma_f32_16x16x32_bf16 a[56:59], v[236:239], a[16:19], a[56:59]
    s_xor_b32 s60, s59, s45
    s_waitcnt lgkmcnt(15)
    v_mfma_f32_16x16x32_bf16 a[48:51], v[236:239], a[128:131], a[48:51]
    s_sub_i32 s59, s60, s59
    s_barrier
    s_waitcnt lgkmcnt(11)
    v_mfma_f32_16x16x32_bf16 v[48:51], a[32:35], v[168:171], v[48:51]
    ds_read_b64_tr_b16 a[8:9], v22 offset:12352
    s_mul_i32 s59, s59, 12288
    v_mfma_f32_16x16x32_bf16 v[52:55], a[32:35], v[172:175], v[52:55]
    ds_read_b64_tr_b16 a[10:11], v23 offset:13120
    s_add_u32 s59, s59, s3
    v_mfma_f32_16x16x32_bf16 v[56:59], a[36:39], v[168:171], v[56:59]
    ds_read_b64_tr_b16 a[12:13], v23 offset:12352
    v_add_u32 v26, s59, v1
    v_mfma_f32_16x16x32_bf16 v[60:63], a[36:39], v[172:175], v[60:63]
    ds_read_b64_tr_b16 a[14:15], v22 offset:13120
    ds_read_b128 v[176:179], v244 offset:4096
    s_waitcnt lgkmcnt(11)
    v_mfma_f32_16x16x32_bf16 v[64:67], v[168:171], a[40:43], v[64:67]
    ds_read_b64_tr_b16 a[16:17], v22 offset:12416
    s_lshl1_add_u32 s59, s37, s95
    v_mfma_f32_16x16x32_bf16 v[68:71], v[172:175], a[40:43], v[68:71]
    ds_read_b64_tr_b16 a[18:19], v23 offset:13184
    ds_read_b128 v[180:183], v244 offset:6144
    v_mfma_f32_16x16x32_bf16 v[72:75], v[168:171], a[44:47], v[72:75]
    ds_read_b64_tr_b16 a[20:21], v23 offset:12416
    s_mul_i32 s59, s59, 57344
    v_mfma_f32_16x16x32_bf16 v[76:79], v[172:175], a[44:47], v[76:79]
    ds_read_b64_tr_b16 a[22:23], v22 offset:13184
    ds_read_b128 v[184:187], v245 offset:4096
    v_mfma_f32_16x16x32_bf16 v[80:83], v[168:171], v[168:171], v[80:83]
    ds_read_b64_tr_b16 a[144:145], v22 offset:12288
    buffer_load_dwordx4 a[192:195], v9, s[16:19], s59 offen
    v_mfma_f32_16x16x32_bf16 v[88:91], v[236:239], v[168:171], v[88:91]
    ds_read_b64_tr_b16 a[146:147], v23 offset:13056
    ds_read_b128 v[188:191], v245 offset:6144
    v_mfma_f32_16x16x32_bf16 v[84:87], v[172:175], v[172:175], v[84:87]
    ds_read_b64_tr_b16 a[148:149], v23 offset:12288
    s_mov_b32 exec_hi, 0
    buffer_load_dwordx4 a[196:199], v10, s[16:19], s59 offen offset:1024
    s_mov_b32 exec_hi, -1
    v_mfma_f32_16x16x32_bf16 v[92:95], v[236:239], v[172:175], v[92:95]
    ds_read_b64_tr_b16 a[150:151], v22 offset:13056
    s_waitcnt lgkmcnt(8)
    v_mfma_f32_16x16x32_bf16 v[48:51], a[8:11], v[176:179], v[48:51]
    ds_read_b64_tr_b16 a[32:33], v24 offset:12352
    buffer_load_dwordx2 a[248:249], v17, s[4:7], s91 offen offset:0
    v_mfma_f32_16x16x32_bf16 v[52:55], a[8:11], v[180:183], v[52:55]
    ds_read_b64_tr_b16 a[34:35], v25 offset:13120
    s_waitcnt vmcnt(13)
    ds_write_b128 v248, v[192:195] offset:8192
    v_mfma_f32_16x16x32_bf16 v[56:59], a[12:15], v[176:179], v[56:59]
    ds_read_b64_tr_b16 a[36:37], v25 offset:12352
    v_mfma_f32_16x16x32_bf16 v[60:63], a[12:15], v[180:183], v[60:63]
    ds_read_b64_tr_b16 a[38:39], v24 offset:13120
    s_waitcnt lgkmcnt(11)
    v_mfma_f32_16x16x32_bf16 v[64:67], v[176:179], a[16:19], v[64:67]
    ds_read_b64_tr_b16 a[40:41], v24 offset:12416
    s_waitcnt vmcnt(12)
    ds_write_b128 v248, v[196:199] offset:9216
    v_mfma_f32_16x16x32_bf16 v[68:71], v[180:183], a[16:19], v[68:71]
    ds_read_b64_tr_b16 a[42:43], v25 offset:13184
    buffer_load_dwordx2 a[250:251], v17, s[4:7], s91 offen offset:32
    v_mfma_f32_16x16x32_bf16 v[72:75], v[176:179], a[20:23], v[72:75]
    ds_read_b64_tr_b16 a[44:45], v25 offset:12416
    v_mfma_f32_16x16x32_bf16 v[76:79], v[180:183], a[20:23], v[76:79]
    ds_read_b64_tr_b16 a[46:47], v24 offset:13184
    s_waitcnt vmcnt(12)
    ds_write_b128 v248, v[200:203] offset:10240
    v_mfma_f32_16x16x32_bf16 v[80:83], v[176:179], v[176:179], v[80:83]
    ds_read_b64_tr_b16 a[152:153], v24 offset:12288
    s_add_u32 s98, s91, 16384
    v_mfma_f32_16x16x32_bf16 v[88:91], v[236:239], v[176:179], v[88:91]
    ds_read_b64_tr_b16 a[154:155], v25 offset:13056
    buffer_load_dwordx2 a[252:253], v17, s[4:7], s98 offen offset:0
    v_mfma_f32_16x16x32_bf16 v[84:87], v[180:183], v[180:183], v[84:87]
    ds_read_b64_tr_b16 a[156:157], v25 offset:12288
    s_waitcnt vmcnt(12)
    ds_write_b128 v248, v[204:207] offset:11264
    v_mfma_f32_16x16x32_bf16 v[92:95], v[236:239], v[180:183], v[92:95]
    ds_read_b64_tr_b16 a[158:159], v24 offset:13056
    v_mfma_f32_16x16x32_bf16 a[52:55], v[236:239], a[8:11], a[52:55]
    v_mfma_f32_16x16x32_bf16 a[56:59], v[236:239], a[16:19], a[56:59]
    buffer_load_dwordx2 a[254:255], v17, s[4:7], s98 offen offset:32
    s_waitcnt lgkmcnt(15)
    v_mfma_f32_16x16x32_bf16 a[48:51], v[236:239], a[144:147], a[48:51]
    s_barrier
    s_waitcnt lgkmcnt(11)
    v_mfma_f32_16x16x32_bf16 v[48:51], a[32:35], v[184:187], v[48:51]
    ds_read_b64_tr_b16 a[8:9], v22 offset:24640
    v_mfma_f32_16x16x32_bf16 v[52:55], a[32:35], v[188:191], v[52:55]
    ds_read_b64_tr_b16 a[10:11], v23 offset:25408
    v_mfma_f32_16x16x32_bf16 v[56:59], a[36:39], v[184:187], v[56:59]
    ds_read_b64_tr_b16 a[12:13], v23 offset:24640
    buffer_load_dwordx3 v[250:252], off, s[32:35], 0 sc1
    v_mfma_f32_16x16x32_bf16 v[60:63], a[36:39], v[188:191], v[60:63]
    ds_read_b64_tr_b16 a[14:15], v22 offset:25408
    ds_read_b128 v[192:195], v244 offset:8192
    s_waitcnt lgkmcnt(11)
    v_mfma_f32_16x16x32_bf16 v[64:67], v[184:187], a[40:43], v[64:67]
    ds_read_b64_tr_b16 a[16:17], v22 offset:24704
    v_mfma_f32_16x16x32_bf16 v[68:71], v[188:191], a[40:43], v[68:71]
    ds_read_b64_tr_b16 a[18:19], v23 offset:25472
    ds_read_b128 v[196:199], v244 offset:10240
    v_mfma_f32_16x16x32_bf16 v[72:75], v[184:187], a[44:47], v[72:75]
    ds_read_b64_tr_b16 a[20:21], v23 offset:24704
    s_bfe_u32 s59, s2, 0x20001
    v_mfma_f32_16x16x32_bf16 v[76:79], v[188:191], a[44:47], v[76:79]
    ds_read_b64_tr_b16 a[22:23], v22 offset:25472
    ds_read_b128 v[200:203], v245 offset:8192
    v_mfma_f32_16x16x32_bf16 v[80:83], v[184:187], v[184:187], v[80:83]
    ds_read_b64_tr_b16 a[160:161], v22 offset:24576
    s_lshl2_add_u32 s60, s0, s59
    v_mfma_f32_16x16x32_bf16 v[88:91], v[236:239], v[184:187], v[88:91]
    ds_read_b64_tr_b16 a[162:163], v23 offset:25344
    ds_read_b128 v[204:207], v245 offset:10240
    v_mfma_f32_16x16x32_bf16 v[84:87], v[188:191], v[188:191], v[84:87]
    ds_read_b64_tr_b16 a[164:165], v23 offset:24576
    v_lshlrev_b32 v27, 7, v0
    v_mfma_f32_16x16x32_bf16 v[92:95], v[236:239], v[188:191], v[92:95]
    ds_read_b64_tr_b16 a[166:167], v22 offset:25344
    s_waitcnt lgkmcnt(8)
    v_mfma_f32_16x16x32_bf16 v[48:51], a[8:11], v[192:195], v[48:51]
    ds_read_b64_tr_b16 a[32:33], v24 offset:24640
    s_lshl_b32 s98, s60, 10
    v_mfma_f32_16x16x32_bf16 v[52:55], a[8:11], v[196:199], v[52:55]
    ds_read_b64_tr_b16 a[34:35], v25 offset:25408
    s_waitcnt vmcnt(10)
    ds_write_b128 v248, v[208:211] offset:12288
    v_mfma_f32_16x16x32_bf16 v[56:59], a[12:15], v[192:195], v[56:59]
    ds_read_b64_tr_b16 a[36:37], v25 offset:24640
    s_add_u32 s98, s98, s1
    v_mfma_f32_16x16x32_bf16 v[60:63], a[12:15], v[196:199], v[60:63]
    ds_read_b64_tr_b16 a[38:39], v24 offset:25408
    s_waitcnt lgkmcnt(11)
    v_mfma_f32_16x16x32_bf16 v[64:67], v[192:195], a[16:19], v[64:67]
    ds_read_b64_tr_b16 a[40:41], v24 offset:24704
    s_waitcnt vmcnt(9)
    ds_write_b128 v248, v[212:215] offset:13312
    v_mfma_f32_16x16x32_bf16 v[68:71], v[196:199], a[16:19], v[68:71]
    ds_read_b64_tr_b16 a[42:43], v25 offset:25472
    s_mov_b32 exec_lo, 0xf
    s_mov_b32 exec_hi, 0x0
    buffer_load_dword v255, v27, s[12:15], s98 offen offset:0
    s_mov_b64 exec, -1
    v_mfma_f32_16x16x32_bf16 v[72:75], v[192:195], a[20:23], v[72:75]
    ds_read_b64_tr_b16 a[44:45], v25 offset:24704
    s_lshr_b32 s98, s0, 2
    v_mfma_f32_16x16x32_bf16 v[76:79], v[196:199], a[20:23], v[76:79]
    ds_read_b64_tr_b16 a[46:47], v24 offset:25472
    s_waitcnt vmcnt(9)
    ds_write_b128 v248, v[216:219] offset:14336
    v_mfma_f32_16x16x32_bf16 v[80:83], v[192:195], v[192:195], v[80:83]
    ds_read_b64_tr_b16 a[168:169], v24 offset:24576
    s_lshl1_add_u32 s98, s98, s95
    v_mfma_f32_16x16x32_bf16 v[88:91], v[236:239], v[192:195], v[88:91]
    ds_read_b64_tr_b16 a[170:171], v25 offset:25344
    s_lshl2_add_u32 s98, s98, s59
    v_mfma_f32_16x16x32_bf16 v[84:87], v[196:199], v[196:199], v[84:87]
    ds_read_b64_tr_b16 a[172:173], v25 offset:24576
    s_waitcnt vmcnt(8)
    ds_write_b128 v248, v[220:223] offset:15360
    v_mfma_f32_16x16x32_bf16 v[92:95], v[236:239], v[196:199], v[92:95]
    ds_read_b64_tr_b16 a[174:175], v24 offset:25344
    s_mul_i32 s98, s98, 7168
    v_mfma_f32_16x16x32_bf16 a[52:55], v[236:239], a[8:11], a[52:55]
    s_lshl1_add_u32 s98, s1, s98
    s_mov_b32 exec_lo, 0xff
    s_mov_b32 exec_hi, 0x0
    buffer_load_dword v255, v27, s[16:19], s98 offen offset:0
    s_mov_b64 exec, -1
    v_mfma_f32_16x16x32_bf16 a[56:59], v[236:239], a[16:19], a[56:59]
    s_mov_b32 exec_lo, 0xff
    s_mov_b32 exec_hi, 0x0
    buffer_load_dword v255, v27, s[16:19], s98 offen offset:3584
    s_mov_b64 exec, -1
    s_waitcnt lgkmcnt(15)
    v_mfma_f32_16x16x32_bf16 a[48:51], v[236:239], a[160:163], a[48:51]
    ds_read_b128 a[200:203], v26
    s_mov_b32 exec_hi, 0
    ds_read_b128 a[204:207], v26 offset:1024
    s_mov_b32 exec_hi, -1
    s_barrier
    s_waitcnt lgkmcnt(13)
    v_mfma_f32_16x16x32_bf16 v[48:51], a[32:35], v[200:203], v[48:51]
    ds_read_b64_tr_b16 a[8:9], v22 offset:36928
    v_mfma_f32_16x16x32_bf16 v[52:55], a[32:35], v[204:207], v[52:55]
    ds_read_b64_tr_b16 a[10:11], v23 offset:37696
    s_add_u32 s60, s60, s1
    v_mfma_f32_16x16x32_bf16 v[56:59], a[36:39], v[200:203], v[56:59]
    ds_read_b64_tr_b16 a[12:13], v23 offset:36928
    s_lshl_b32 s98, s60, 10
    v_mfma_f32_16x16x32_bf16 v[60:63], a[36:39], v[204:207], v[60:63]
    ds_read_b64_tr_b16 a[14:15], v22 offset:37696
    ds_read_b128 v[208:211], v244 offset:12288
    s_waitcnt lgkmcnt(13)
    v_mfma_f32_16x16x32_bf16 v[64:67], v[200:203], a[40:43], v[64:67]
    ds_read_b64_tr_b16 a[16:17], v22 offset:36992
    s_mov_b32 exec_lo, 0xff
    s_mov_b32 exec_hi, 0x0
    buffer_load_dword v255, v27, s[20:23], s98 offen offset:0
    s_mov_b64 exec, -1
    v_mfma_f32_16x16x32_bf16 v[68:71], v[204:207], a[40:43], v[68:71]
    ds_read_b64_tr_b16 a[18:19], v23 offset:37760
    ds_read_b128 v[212:215], v244 offset:14336
    v_mfma_f32_16x16x32_bf16 v[72:75], v[200:203], a[44:47], v[72:75]
    ds_read_b64_tr_b16 a[20:21], v23 offset:36992
    v_mfma_f32_16x16x32_bf16 v[76:79], v[204:207], a[44:47], v[76:79]
    ds_read_b64_tr_b16 a[22:23], v22 offset:37760
    ds_read_b128 v[216:219], v245 offset:12288
    v_mfma_f32_16x16x32_bf16 v[80:83], v[200:203], v[200:203], v[80:83]
    ds_read_b64_tr_b16 a[176:177], v22 offset:36864
    s_mul_i32 s98, s60, 768
    v_mfma_f32_16x16x32_bf16 v[88:91], v[236:239], v[200:203], v[88:91]
    ds_read_b64_tr_b16 a[178:179], v23 offset:37632
    ds_read_b128 v[220:223], v245 offset:14336
    v_mfma_f32_16x16x32_bf16 v[84:87], v[204:207], v[204:207], v[84:87]
    ds_read_b64_tr_b16 a[180:181], v23 offset:36864
    s_add_u32 s98, s98, 1048576
    v_mfma_f32_16x16x32_bf16 v[92:95], v[236:239], v[204:207], v[92:95]
    ds_read_b64_tr_b16 a[182:183], v22 offset:37632
    s_waitcnt lgkmcnt(8)
    v_mfma_f32_16x16x32_bf16 v[48:51], a[8:11], v[208:211], v[48:51]
    ds_read_b64_tr_b16 a[32:33], v24 offset:36928
    s_mov_b32 exec_lo, 0x3f
    s_mov_b32 exec_hi, 0x0
    buffer_load_dword v255, v27, s[20:23], s98 offen offset:0
    s_mov_b64 exec, -1
    v_mfma_f32_16x16x32_bf16 v[52:55], a[8:11], v[212:215], v[52:55]
    ds_read_b64_tr_b16 a[34:35], v25 offset:37696
    v_mfma_f32_16x16x32_bf16 v[56:59], a[12:15], v[208:211], v[56:59]
    ds_read_b64_tr_b16 a[36:37], v25 offset:36928
    v_mfma_f32_16x16x32_bf16 v[60:63], a[12:15], v[212:215], v[60:63]
    ds_read_b64_tr_b16 a[38:39], v24 offset:37696
    s_waitcnt lgkmcnt(10)
    v_mfma_f32_16x16x32_bf16 v[64:67], v[208:211], a[16:19], v[64:67]
    ds_read_b64_tr_b16 a[40:41], v24 offset:36992
    v_mfma_f32_16x16x32_bf16 v[68:71], v[212:215], a[16:19], v[68:71]
    ds_read_b64_tr_b16 a[42:43], v25 offset:37760
    v_mfma_f32_16x16x32_bf16 v[72:75], v[208:211], a[20:23], v[72:75]
    ds_read_b64_tr_b16 a[44:45], v25 offset:36992
    v_mfma_f32_16x16x32_bf16 v[76:79], v[212:215], a[20:23], v[76:79]
    ds_read_b64_tr_b16 a[46:47], v24 offset:37760
    v_mfma_f32_16x16x32_bf16 v[80:83], v[208:211], v[208:211], v[80:83]
    ds_read_b64_tr_b16 a[184:185], v24 offset:36864
    v_mfma_f32_16x16x32_bf16 v[88:91], v[236:239], v[208:211], v[88:91]
    ds_read_b64_tr_b16 a[186:187], v25 offset:37632
    v_mfma_f32_16x16x32_bf16 v[84:87], v[212:215], v[212:215], v[84:87]
    ds_read_b64_tr_b16 a[188:189], v25 offset:36864
    v_mfma_f32_16x16x32_bf16 v[92:95], v[236:239], v[212:215], v[92:95]
    ds_read_b64_tr_b16 a[190:191], v24 offset:37632
    v_mfma_f32_16x16x32_bf16 a[52:55], v[236:239], a[8:11], a[52:55]
    v_mfma_f32_16x16x32_bf16 a[56:59], v[236:239], a[16:19], a[56:59]
    s_waitcnt lgkmcnt(12)
    v_mfma_f32_16x16x32_bf16 a[48:51], v[236:239], a[176:179], a[48:51]
    s_waitcnt lgkmcnt(8)
    v_mfma_f32_16x16x32_bf16 v[48:51], a[32:35], v[216:219], v[48:51]
    v_mfma_f32_16x16x32_bf16 v[52:55], a[32:35], v[220:223], v[52:55]
    v_mfma_f32_16x16x32_bf16 v[56:59], a[36:39], v[216:219], v[56:59]
    v_mfma_f32_16x16x32_bf16 v[60:63], a[36:39], v[220:223], v[60:63]
    s_waitcnt lgkmcnt(4)
    v_mfma_f32_16x16x32_bf16 v[64:67], v[216:219], a[40:43], v[64:67]
    v_mfma_f32_16x16x32_bf16 v[68:71], v[220:223], a[40:43], v[68:71]
    v_mfma_f32_16x16x32_bf16 v[72:75], v[216:219], a[44:47], v[72:75]
    v_mfma_f32_16x16x32_bf16 v[76:79], v[220:223], a[44:47], v[76:79]
    v_mfma_f32_16x16x32_bf16 v[80:83], v[216:219], v[216:219], v[80:83]
    v_mfma_f32_16x16x32_bf16 v[88:91], v[236:239], v[216:219], v[88:91]
    v_mfma_f32_16x16x32_bf16 v[84:87], v[220:223], v[220:223], v[84:87]
    v_mfma_f32_16x16x32_bf16 v[92:95], v[236:239], v[220:223], v[92:95]
    v_and_b32 v18, 15, v0
    v_mfma_f32_16x16x32_bf16 v[32:35], a[64:67], v[96:99], 0
    s_lshl_b32 s58, s63, 7
    s_lshl_b32 s59, s95, 2
    v_mfma_f32_16x16x32_bf16 v[36:39], a[64:67], v[100:103], 0
    s_add_u32 s59, s59, s58
    v_lshrrev_b32 v19, 5, v0
    v_mfma_f32_16x16x32_bf16 v[40:43], a[68:71], v[96:99], 0
    v_lshlrev_b32 v19, 7, v19
    v_xor_b32 v19, s58, v19
    v_mfma_f32_16x16x32_bf16 v[44:47], a[68:71], v[100:103], 0
    v_lshl_add_u32 v19, v18, 3, v19
    v_lshl_add_u32 v18, v18, 3, s59
    v_mfma_f32_16x16x32_bf16 v[32:35], a[72:75], v[104:107], v[32:35]
    v_accvgpr_read_b32 v20, a48
    v_accvgpr_read_b32 v21, a52
    v_mfma_f32_16x16x32_bf16 v[36:39], a[72:75], v[108:111], v[36:39]
    v_accvgpr_read_b32 v22, a56
    ds_write_b32 v18, v20 offset:0
    v_mfma_f32_16x16x32_bf16 v[40:43], a[76:79], v[104:107], v[40:43]
    ds_write_b32 v18, v21 offset:256
    ds_write_b32 v18, v22 offset:512
    v_mfma_f32_16x16x32_bf16 v[44:47], a[76:79], v[108:111], v[44:47]
    s_mov_b32 s84, 0xaaaaaaaa
    s_mov_b32 s85, 0xaaaaaaaa
    v_mfma_f32_16x16x32_bf16 v[32:35], a[80:83], v[112:115], v[32:35]
    v_cndmask_b32 v80, v80, v81, s[84:85]
    v_cndmask_b32 v81, v82, v83, s[84:85]
    v_mfma_f32_16x16x32_bf16 v[36:39], a[80:83], v[116:119], v[36:39]
    v_cndmask_b32 v82, v84, v85, s[84:85]
    v_cndmask_b32 v83, v86, v87, s[84:85]
    v_mfma_f32_16x16x32_bf16 v[40:43], a[84:87], v[112:115], v[40:43]
    s_mov_b32 s84, 0xcccccccc
    s_mov_b32 s85, 0xcccccccc
    v_mfma_f32_16x16x32_bf16 v[44:47], a[84:87], v[116:119], v[44:47]
    v_cndmask_b32 v80, v80, v81, s[84:85]
    v_cndmask_b32 v81, v82, v83, s[84:85]
    v_mfma_f32_16x16x32_bf16 v[32:35], a[88:91], v[120:123], v[32:35]
    s_mov_b32 s84, 0x00f0000f
    s_mov_b32 s85, 0xf0000f00
    v_mfma_f32_16x16x32_bf16 v[36:39], a[88:91], v[124:127], v[36:39]
    v_cndmask_b32 v80, 0, v80, s[84:85]
    v_cndmask_b32 v81, 0, v81, s[84:85]
    v_mfma_f32_16x16x32_bf16 v[40:43], a[92:95], v[120:123], v[40:43]
    s_mov_b32 s84, s56
    s_mov_b32 s85, s56
    v_mfma_f32_16x16x32_bf16 v[44:47], a[92:95], v[124:127], v[44:47]
    v_permlane16_swap_b32 v80, v81
    v_add_f32 v81, v80, v81
    v_mfma_f32_16x16x32_bf16 v[32:35], a[96:99], v[128:131], v[32:35]
    v_cndmask_b32 v80, v88, v92, s[84:85]
    v_and_b32 v24, 31, v0
    v_mfma_f32_16x16x32_bf16 v[36:39], a[96:99], v[132:135], v[36:39]
    v_lshrrev_b32 v25, 4, v0
    s_add_u32 s60, s53, 98304
    v_mfma_f32_16x16x32_bf16 v[40:43], a[100:103], v[128:131], v[40:43]
    v_lshl_add_u32 v24, v24, 2, s60
    v_lshl_add_u32 v25, v25, 4, s60
    v_mfma_f32_16x16x32_bf16 v[44:47], a[100:103], v[132:135], v[44:47]
    s_mul_i32 s59, s37, 3072
    s_mul_i32 s60, s95, 4608
    v_mfma_f32_16x16x32_bf16 v[32:35], a[104:107], v[136:139], v[32:35]
    s_add_u32 s59, s59, s94
    s_sub_u32 s59, s59, s60
    v_mfma_f32_16x16x32_bf16 v[36:39], a[104:107], v[140:143], v[36:39]
    s_mul_i32 s60, s38, 98304
    s_add_u32 s60, s60, 106954752
    v_mfma_f32_16x16x32_bf16 v[40:43], a[108:111], v[136:139], v[40:43]
    s_add_u32 s8, s24, s60
    s_addc_u32 s9, s25, 0
    v_mfma_f32_16x16x32_bf16 v[44:47], a[108:111], v[140:143], v[44:47]
    s_mov_b32 s10, 98304
    buffer_store_dwordx4 a[200:203], v1, s[8:11], s3 offen sc1
    v_mfma_f32_16x16x32_bf16 v[32:35], a[112:115], v[144:147], v[32:35]
    s_waitcnt vmcnt(6)
    buffer_store_dwordx4 a[192:195], v1, s[24:27], s59 offen sc1
    s_mov_b32 exec_hi, 0
    buffer_store_dwordx4 a[196:199], v1, s[24:27], s59 offen offset:1024 sc1
    buffer_store_dwordx4 a[204:207], v1, s[8:11], s3 offen offset:1024 sc1
    s_mov_b32 exec_hi, -1
    v_mfma_f32_16x16x32_bf16 v[36:39], a[112:115], v[148:151], v[36:39]
    s_and_b32 s3, s48, 15
    s_mul_i32 s3, s3, 6144
    v_mfma_f32_16x16x32_bf16 v[40:43], a[116:119], v[144:147], v[40:43]
    v_lshlrev_b32 v241, 7, v0
L_nonce:
    v_readfirstlane_b32 s43, v251
    v_readfirstlane_b32 s60, v252
    v_readfirstlane_b32 s42, v250
    s_lshr_b32 s59, s37, 3
    s_lshl_b32 s4, s59, 21
    s_lshr_b32 s59, s43, 29
    s_and_b32 s61, s60, 0x01010101
    s_or_b32 s61, s61, s59
    s_bfe_u32 s59, s37, 0x20001
    s_cmp_lg_u32 s61, 0x01010103
    s_cbranch_scc0 L_nonce2
L_nspin:
    buffer_load_dwordx3 v[250:252], off, s[32:35], 0 sc1
    s_sub_u32 s62, s62, 1
    s_waitcnt vmcnt(0)
    s_cmp_gt_i32 s62, 0
    s_cbranch_scc1 L_nonce
L_nonce2:
    s_lshl_b32 s59, s59, 22
    v_mfma_f32_16x16x32_bf16 v[44:47], a[116:119], v[148:151], v[44:47]
    s_add_u32 s4, s4, s59
    s_and_b32 s59, s37, 1
    v_mfma_f32_16x16x32_bf16 v[32:35], a[120:123], v[152:155], v[32:35]
    s_lshl_b32 s59, s59, 20
    s_add_u32 s4, s4, s59
    v_mfma_f32_16x16x32_bf16 v[36:39], a[120:123], v[156:159], v[36:39]
    s_add_u32 s4, s4, 25165824
    s_add_u32 s46, s42, 15
    v_mfma_f32_16x16x32_bf16 v[40:43], a[124:127], v[152:155], v[40:43]
    s_mov_b32 s47, s43
    s_and_b32 s59, s60, 0x00ff00ff
    v_mfma_f32_16x16x32_bf16 v[44:47], a[124:127], v[156:159], v[44:47]
    s_lshr_b32 s60, s60, 8
    s_and_b32 s60, s60, 0x00ff00ff
    s_add_u32 s59, s59, s60
    s_lshr_b32 s60, s59, 16
    s_and_b32 s59, s59, 0xffff
    s_cmp_gt_u32 s60, s59
    s_cselect_b32 s59, 0x2000, 0
    s_add_u32 s39, s39, s59
    s_add_u32 s88, s88, s59
    v_add_u32 v13, s59, v13
    v_add_u32 v16, s59, v16
    s_lshl_b32 s5, s36, 7
    s_add_u32 s5, s5, s88
    s_add_u32 s5, s5, 128
    s_and_b32 s6, s38, 7
    s_lshr_b32 s59, s38, 3
    s_lshl1_add_u32 s6, s6, s59
    s_lshl_b32 s91, s48, 15
    s_lshl_b32 s59, s6, 6
    s_add_u32 s91, s91, s59
    s_lshl_b32 s33, s36, 12
    s_waitcnt lgkmcnt(0)
    s_barrier
    ds_read_b64 v[88:89], v19 offset:0
    ds_read_b64 v[90:91], v19 offset:256
    ds_read_b64 v[92:93], v19 offset:512
    v_mov_b32 v22, v80
    v_mov_b32 v23, v81
    s_nop 1
    v_permlane32_swap_b32 v80, v22
    v_permlane32_swap_b32 v81, v23
    v_add_f32 v80, v80, v22
    v_add_f32 v81, v81, v23
    v_mul_f32 v232, 0xba800000, v80
    v_mul_f32 v81, 0x3b000000, v81
    v_fma_f32 v81, -v232, v232, v81
    v_max_f32 v81, 0, v81
    v_add_f32 v81, 0x3727c5ac, v81
    v_rsq_f32 v240, v81
    s_waitcnt lgkmcnt(0)
    v_add_f32 v88, v88, v89
    v_add_f32 v90, v90, v91
    v_add_f32 v92, v92, v93
    v_accvgpr_write_b32 a224, v88
    v_accvgpr_write_b32 a225, v90
    v_accvgpr_write_b32 a226, v92
    s_nop 0
    ds_write_b32 v24, v240
    v_mov_b32 v235, v240
    ds_read_b128 v[96:99], v25
    ds_read_b128 v[100:103], v25 offset:64
    v_permlane16_swap_b32 v240, v235
    v_mul_f32 v242, 0x3eb8aa3b, v240
    v_mul_f32 v234, 0x3eb8aa3b, v235
L_g1_epi:
    v_mfma_f32_16x16x1_4b_f32 v[48:63], a225, v232, v[48:63]
    v_mfma_f32_16x16x1_4b_f32 v[64:79], v232, a226, v[64:79]
    s_lshl_b32 s93, s48, 16
    v_mfma_f32_16x16x32_bf16 v[32:35], a[128:131], v[160:163], v[32:35]
    s_add_u32 s93, s93, s39
    s_lshl_b32 s58, s38, 11
    s_and_b32 s59, s58, -8192
    v_mfma_f32_16x16x32_bf16 v[36:39], a[128:131], v[164:167], v[36:39]
    s_add_u32 s89, s93, s58
    s_add_u32 s89, s89, s59
    s_add_u32 s59, s89, 4194304
    v_mfma_f32_16x16x32_bf16 v[40:43], a[132:135], v[160:163], v[40:43]
    s_lshl_b32 s58, s63, 10
    v_add_u32 v135, s58, v1
    v_xor_b32 v136, 1024, v135
    v_mfma_f32_16x16x32_bf16 v[44:47], a[132:135], v[164:167], v[44:47]
    v_and_b32 v31, 512, v1
    v_add_u32 v31, v31, v1
    v_xor_b32 v31, s58, v31
    v_mfma_f32_16x16x32_bf16 v[32:35], a[136:139], v[168:171], v[32:35]
    v_mul_f32 v48, v48, v240
    v_mul_f32 v49, v49, v240
    v_mul_f32 v50, v50, v240
    v_mfma_f32_16x16x32_bf16 v[36:39], a[136:139], v[172:175], v[36:39]
    v_mul_f32 v51, v51, v240
    v_mul_f32 v52, v52, v235
    v_mul_f32 v53, v53, v235
    v_mfma_f32_16x16x32_bf16 v[40:43], a[140:143], v[168:171], v[40:43]
    v_mul_f32 v54, v54, v235
    v_mul_f32 v55, v55, v235
    v_mul_f32 v56, v56, v240
    v_mfma_f32_16x16x32_bf16 v[44:47], a[140:143], v[172:175], v[44:47]
    v_mul_f32 v57, v57, v240
    v_mul_f32 v58, v58, v240
    v_mul_f32 v59, v59, v240
    v_mfma_f32_16x16x32_bf16 v[32:35], a[144:147], v[176:179], v[32:35]
    v_mul_f32 v60, v60, v235
    v_mul_f32 v61, v61, v235
    v_mul_f32 v62, v62, v235
    v_mfma_f32_16x16x32_bf16 v[36:39], a[144:147], v[180:183], v[36:39]
    v_mul_f32 v63, v63, v235
    v_cvt_pk_bf16_f32 v112, v48, v49
    v_cvt_pk_bf16_f32 v113, v50, v51
    v_mfma_f32_16x16x32_bf16 v[40:43], a[148:151], v[176:179], v[40:43]
    v_cvt_pk_bf16_f32 v114, v52, v53
    v_cvt_pk_bf16_f32 v115, v54, v55
    v_cvt_pk_bf16_f32 v116, v56, v57
    v_mfma_f32_16x16x32_bf16 v[44:47], a[148:151], v[180:183], v[44:47]
    v_cvt_pk_bf16_f32 v117, v58, v59
    v_cvt_pk_bf16_f32 v118, v60, v61
    v_cvt_pk_bf16_f32 v119, v62, v63
    v_mfma_f32_16x16x32_bf16 v[32:35], a[152:155], v[184:187], v[32:35]
    v_permlane16_swap_b32 v112, v114
    v_permlane16_swap_b32 v113, v115
    v_permlane16_swap_b32 v116, v118
    v_mfma_f32_16x16x32_bf16 v[36:39], a[152:155], v[188:191], v[36:39]
    v_permlane16_swap_b32 v117, v119
    buffer_store_dwordx4 v[112:115], v135, s[24:27], s89 offen sc1
    buffer_store_dwordx4 v[116:119], v136, s[24:27], s89 offen sc1
    v_mfma_f32_16x16x32_bf16 v[40:43], a[156:159], v[184:187], v[40:43]
    s_waitcnt lgkmcnt(0)
    v_mul_f32 v64, v64, v96
    v_mul_f32 v65, v65, v97
    v_mul_f32 v66, v66, v98
    v_mfma_f32_16x16x32_bf16 v[44:47], a[156:159], v[188:191], v[44:47]
    v_mul_f32 v67, v67, v99
    v_mul_f32 v68, v68, v100
    v_mul_f32 v69, v69, v101
    v_mfma_f32_16x16x32_bf16 v[32:35], a[160:163], v[192:195], v[32:35]
    v_mul_f32 v70, v70, v102
    v_mul_f32 v71, v71, v103
    v_mul_f32 v72, v72, v96
    v_mfma_f32_16x16x32_bf16 v[36:39], a[160:163], v[196:199], v[36:39]
    v_mul_f32 v73, v73, v97
    v_mul_f32 v74, v74, v98
    v_mul_f32 v75, v75, v99
    v_mfma_f32_16x16x32_bf16 v[40:43], a[164:167], v[192:195], v[40:43]
    v_mul_f32 v76, v76, v100
    v_mul_f32 v77, v77, v101
    v_mul_f32 v78, v78, v102
    v_mfma_f32_16x16x32_bf16 v[44:47], a[164:167], v[196:199], v[44:47]
    v_mul_f32 v79, v79, v103
    v_cvt_pk_bf16_f32 v120, v64, v65
    v_cvt_pk_bf16_f32 v121, v66, v67
    v_mfma_f32_16x16x32_bf16 v[32:35], a[168:171], v[200:203], v[32:35]
    v_cvt_pk_bf16_f32 v124, v68, v69
    v_cvt_pk_bf16_f32 v125, v70, v71
    v_cvt_pk_bf16_f32 v122, v72, v73
    v_mfma_f32_16x16x32_bf16 v[36:39], a[168:171], v[204:207], v[36:39]
    v_cvt_pk_bf16_f32 v123, v74, v75
    v_cvt_pk_bf16_f32 v126, v76, v77
    v_cvt_pk_bf16_f32 v127, v78, v79
    v_mfma_f32_16x16x32_bf16 v[40:43], a[172:175], v[200:203], v[40:43]
    v_and_b32 v30, 15, v0
    v_lshrrev_b32 v128, 5, v0
    v_permlane32_swap_b32 v120, v122
    v_mfma_f32_16x16x32_bf16 v[44:47], a[172:175], v[204:207], v[44:47]
    v_permlane32_swap_b32 v121, v123
    v_permlane32_swap_b32 v124, v126
    v_permlane32_swap_b32 v125, v127
    v_mfma_f32_16x16x32_bf16 v[32:35], a[176:179], v[208:211], v[32:35]
    buffer_store_dwordx4 v[120:123], v31, s[24:27], s59 offen sc1
    buffer_store_dwordx4 v[124:127], v31, s[24:27], s59 offen offset:512 sc1
    v_lshl_add_u32 v30, v128, 4, v30
    v_mfma_f32_16x16x32_bf16 v[36:39], a[176:179], v[212:215], v[36:39]
    v_lshlrev_b32 v30, 4, v30
    v_and_b32 v128, 16, v0
    v_cmp_eq_u32 vcc, 0, v128
    v_mfma_f32_16x16x32_bf16 v[40:43], a[180:183], v[208:211], v[40:43]
    s_mul_i32 s58, s36, 4160
    s_add_u32 s58, s58, 81664
    v_add_u32 v128, s58, v135
    v_mfma_f32_16x16x32_bf16 v[44:47], a[180:183], v[212:215], v[44:47]
    v_add_u32 v130, s58, v136
    v_add_u32 v129, s58, v31
    ds_write_b128 v128, v[112:115]
    v_mfma_f32_16x16x32_bf16 v[32:35], a[184:187], v[216:219], v[32:35]
    s_lshl_b32 s58, s36, 11
    s_add_u32 s58, s58, 40192
    v_add_u32 v135, s58, v135
    v_mfma_f32_16x16x32_bf16 v[36:39], a[184:187], v[220:223], v[36:39]
    ds_write_b128 v130, v[116:119]
    v_add_u32 v136, s58, v136
    ds_write_b128 v129, v[120:123] offset:2048
    v_mfma_f32_16x16x32_bf16 v[40:43], a[188:191], v[216:219], v[40:43]
    v_mul_u32_u24 v128, 4160, v0
    ds_write_b128 v129, v[124:127] offset:2560
    s_mov_b64 exec, 0xfff
    ds_write_b128 v128, v[236:239] offset:52480
    s_mov_b64 exec, -1
    v_mfma_f32_16x16x32_bf16 v[44:47], a[188:191], v[220:223], v[44:47]
    s_mul_i32 s58, s63, 8320
    s_add_u32 s58, s58, 48384
    s_lshl_b32 s59, s95, 10
    s_add_u32 s61, s58, 4096
    s_add_u32 s58, s58, s59
    v_add_u32 v131, s58, v1
    s_add_u32 s58, s58, 2048
    v_mov_b32 v128, s61
    v_add_u32 v132, s58, v30
    v_add_u32 v133, 512, v132
    s_lshl_b32 s58, s63, 12
    s_add_u32 s58, s58, s59
    s_add_u32 s58, s58, 40192
    v_cndmask_b32 v132, v128, v132, vcc
    v_cndmask_b32 v133, v128, v133, vcc
    v_add_u32 v134, s58, v1
    v_lshrrev_b32 v22, 5, v0
    v_and_b32 v23, 31, v0
    v_lshlrev_b32 v22, 2, v22
    v_sub_u32 v22, v23, v22
    s_mov_b32 s58, 0xffff
    v_pk_sub_i16 v160, s58, v22 op_sel_hi:[1,0]
    s_mov_b32 s59, 0x20001
    v_pk_sub_i16 v161, s59, v22 op_sel_hi:[1,0]
    s_mov_b32 s58, 0x80007
    v_pk_sub_i16 v162, s58, v22 op_sel_hi:[1,0]
    v_mfma_f32_16x16x1_4b_f32 v[32:47], a224, v232, v[32:47]
    s_mov_b32 s59, 0xa0009
    v_pk_sub_i16 v163, s59, v22 op_sel_hi:[1,0]
    s_mov_b32 s58, 0x10000f
    v_pk_sub_i16 v164, s58, v22 op_sel_hi:[1,0]
    s_mov_b32 s59, 0x120011
    v_pk_sub_i16 v165, s59, v22 op_sel_hi:[1,0]
    s_mov_b32 s58, 0x180017
    v_pk_sub_i16 v166, s58, v22 op_sel_hi:[1,0]
    s_mov_b32 s59, 0x1a0019
    v_pk_sub_i16 v167, s59, v22 op_sel_hi:[1,0]
    v_pk_mul_f32 v[32:33], v[32:33], v[242:243] op_sel_hi:[1,0]
    v_pk_mul_f32 v[34:35], v[34:35], v[242:243] op_sel_hi:[1,0]
    v_pk_mul_f32 v[36:37], v[36:37], v[234:235] op_sel_hi:[1,0]
    v_pk_mul_f32 v[38:39], v[38:39], v[234:235] op_sel_hi:[1,0]
    v_pk_mul_f32 v[40:41], v[40:41], v[242:243] op_sel_hi:[1,0]
    v_pk_mul_f32 v[42:43], v[42:43], v[242:243] op_sel_hi:[1,0]
    v_pk_mul_f32 v[44:45], v[44:45], v[234:235] op_sel_hi:[1,0]
    v_pk_mul_f32 v[46:47], v[46:47], v[234:235] op_sel_hi:[1,0]
    v_cvt_pk_bf16_f32 v244, v32, v33
    v_cvt_pk_bf16_f32 v245, v34, v35
    v_cvt_pk_bf16_f32 v246, v36, v37
    v_cvt_pk_bf16_f32 v247, v38, v39
    v_cvt_pk_bf16_f32 v248, v40, v41
    v_cvt_pk_bf16_f32 v249, v42, v43
    v_cvt_pk_bf16_f32 v250, v44, v45
    v_cvt_pk_bf16_f32 v251, v46, v47
    v_permlane16_swap_b32 v244, v246
    v_permlane16_swap_b32 v245, v247
    v_permlane16_swap_b32 v248, v250
    ds_write_b128 v135, v[244:247]
    v_permlane16_swap_b32 v249, v251
    ds_write_b128 v136, v[248:251]
    s_waitcnt vmcnt(0) lgkmcnt(0)
    s_barrier
    s_add_u32 s44, s42, s41
    s_mov_b32 s45, s43
    s_add_u32 s44, s44, 1
    v_mov_b32 v19, s45
    v_mov_b32 v18, s44
    s_and_b64 exec, s[100:101], 1
    buffer_store_dwordx2 v[18:19], off, s[24:27], s88 sc1
    s_mov_b64 exec, -1
    ds_read_b128 v[248:251], v134 offset:2048
    ds_read_b128 a[0:3], v131 offset:37440
    ds_read_b128 v[244:247], v134
    ds_read_b128 a[4:7], v131 offset:33280
    ds_read_b128 a[40:43], v132 offset:37440
    ds_read_b128 a[44:47], v133 offset:37440
    ds_read_b128 a[48:51], v132 offset:33280
    ds_read_b128 a[52:55], v133 offset:33280
    s_waitcnt lgkmcnt(6)
    v_mfma_f32_32x32x16_bf16 v[32:47], a[0:3], v[248:251], 0
    s_waitcnt lgkmcnt(4)
    v_mfma_f32_32x32x16_bf16 v[48:63], a[4:7], v[244:247], 0
    v_pk_ashrrev_i16 v160, 15, v160 op_sel_hi:[0,1]
    v_pk_ashrrev_i16 v161, 15, v161 op_sel_hi:[0,1]
    v_pk_ashrrev_i16 v162, 15, v162 op_sel_hi:[0,1]
    v_pk_ashrrev_i16 v163, 15, v163 op_sel_hi:[0,1]
    v_pk_ashrrev_i16 v164, 15, v164 op_sel_hi:[0,1]
    v_pk_ashrrev_i16 v165, 15, v165 op_sel_hi:[0,1]
    v_pk_ashrrev_i16 v166, 15, v166 op_sel_hi:[0,1]
    v_pk_ashrrev_i16 v167, 15, v167 op_sel_hi:[0,1]
    s_sub_u32 s58, s36, 8
    s_lshl_b32 s58, s58, 16
    s_add_u32 s93, s89, s58
    s_mul_i32 s85, s36, 8320
    s_xor_b32 s58, s95, 1
    s_lshl_b32 s58, s58, 16
    s_add_u32 s89, s89, s58
    s_lshl_b32 s58, s95, 10
    s_add_u32 s89, s89, s58
    s_add_u32 s61, s85, 48384
    v_max3_f32 v21, v32, v33, v34
    v_max3_f32 v20, v48, v49, v50
    v_max3_f32 v21, v21, v35, v36
    v_max3_f32 v20, v20, v51, v52
    v_max3_f32 v21, v21, v37, v38
    v_max3_f32 v20, v20, v53, v54
    v_max3_f32 v21, v21, v39, v40
    v_max3_f32 v20, v20, v55, v56
    v_max3_f32 v21, v21, v41, v42
    v_max3_f32 v20, v20, v57, v58
    v_max3_f32 v21, v21, v43, v44
    v_max3_f32 v20, v20, v59, v60
    v_max3_f32 v21, v21, v45, v46
    v_max3_f32 v20, v20, v61, v62
    v_max_f32 v21, v21, v47
    v_max_f32 v20, v20, v63
    v_mov_b32 v18, v20
    v_mov_b32 v19, v21
    s_nop 1
    v_permlane32_swap_b32 v20, v18
    v_permlane32_swap_b32 v21, v19
    v_max_f32 v20, v20, v18
    v_max_f32 v21, v21, v19
    v_sub_f32 v112, 0, v21
    v_sub_f32 v113, 0, v21
    v_sub_f32 v114, 0, v21
    v_sub_f32 v115, 0, v21
    v_sub_f32 v116, 0, v21
    v_sub_f32 v117, 0, v21
    v_sub_f32 v118, 0, v21
    v_sub_f32 v119, 0, v21
    v_sub_f32 v120, 0, v21
    v_sub_f32 v121, 0, v21
    v_sub_f32 v122, 0, v21
    v_sub_f32 v123, 0, v21
    v_sub_f32 v124, 0, v21
    v_sub_f32 v125, 0, v21
    v_sub_f32 v126, 0, v21
    v_sub_f32 v127, 0, v21
    v_sub_f32 v96, 0, v20
    v_sub_f32 v97, 0, v20
    v_mfma_f32_32x32x16_bf16 v[32:47], a[0:3], v[248:251], v[112:127]
    v_sub_f32 v98, 0, v20
    v_sub_f32 v99, 0, v20
    v_sub_f32 v100, 0, v20
    v_sub_f32 v101, 0, v20
    v_sub_f32 v102, 0, v20
    v_sub_f32 v103, 0, v20
    v_sub_f32 v104, 0, v20
    v_sub_f32 v105, 0, v20
    v_sub_f32 v106, 0, v20
    v_sub_f32 v107, 0, v20
    v_sub_f32 v108, 0, v20
    v_sub_f32 v109, 0, v20
    v_sub_f32 v110, 0, v20
    v_sub_f32 v111, 0, v20
    s_nop 1
    v_mfma_f32_32x32x16_bf16 v[48:63], a[4:7], v[244:247], v[96:111]
    v_exp_f32 v32, v32
    v_exp_f32 v33, v33
    v_exp_f32 v34, v34
    v_exp_f32 v35, v35
    s_mov_b64 exec, s[100:101]
    buffer_load_dwordx2 v[26:27], v16, s[24:27], 0 offen sc1
    s_mov_b64 exec, -1
    v_exp_f32 v36, v36
    v_exp_f32 v37, v37
    v_mfma_f32_32x32x16_bf16 v[64:79], a[4:7], v[248:251], v[112:127]
    v_exp_f32 v38, v38
    v_exp_f32 v39, v39
    v_cvt_pk_bf16_f32 v200, v32, v33
    v_cvt_pk_bf16_f32 v201, v34, v35
    v_cvt_pk_bf16_f32 v202, v36, v37
    v_cvt_pk_bf16_f32 v203, v38, v39
    v_and_b32 v200, v160, v200
    v_and_b32 v201, v161, v201
    v_and_b32 v202, v162, v202
    v_and_b32 v203, v163, v203
    v_exp_f32 v40, v40
    v_exp_f32 v41, v41
    s_waitcnt lgkmcnt(2)
    v_mfma_f32_32x32x16_bf16 v[184:199], a[40:43], v[200:203], 0
    v_exp_f32 v42, v42
    v_exp_f32 v43, v43
    v_exp_f32 v44, v44
    v_exp_f32 v45, v45
    v_exp_f32 v46, v46
    v_exp_f32 v47, v47
    v_cvt_pk_bf16_f32 v204, v40, v41
    v_cvt_pk_bf16_f32 v205, v42, v43
    v_cvt_pk_bf16_f32 v206, v44, v45
    v_cvt_pk_bf16_f32 v207, v46, v47
    v_and_b32 v204, v164, v204
    v_and_b32 v205, v165, v205
    v_and_b32 v206, v166, v206
    v_and_b32 v207, v167, v207
    s_waitcnt vmcnt(0)
    s_mov_b64 exec, s[100:101]
    v_cmp_ge_u64 vcc, v[26:27], s[44:45]
    v_cmp_le_u64 s[84:85], v[26:27], s[46:47]
    s_mov_b64 exec, -1
    s_and_b64 vcc, vcc, s[84:85]
    s_cmp_eq_u64 vcc, s[100:101]
    s_cbranch_scc1 L_back_4
L_spin_3:
    buffer_load_dwordx2 v[26:27], v16, s[24:27], 0 offen sc1
    s_sub_u32 s62, s62, 1
    s_waitcnt vmcnt(0)
    v_cmp_ge_u64 vcc, v[26:27], s[44:45]
    v_cmp_le_u64 s[84:85], v[26:27], s[46:47]
    s_cmp_le_i32 s62, 0
    s_cbranch_scc1 L_back_4
    s_and_b64 vcc, vcc, s[84:85]
    s_cmp_eq_u64 vcc, -1
    s_cbranch_scc0 L_spin_3
L_back_4:
    s_barrier
    s_add_u32 m0, s61, 0
    s_add_u32 s60, s93, 0
    buffer_load_dwordx4 v1, s[24:27], s60 offen offset:0 sc1 lds
    buffer_load_dwordx4 v1, s[24:27], s60 offen offset:1024 sc1 lds
    s_add_u32 m0, s61, 2048
    s_add_u32 s60, s93, 4194304
    buffer_load_dwordx4 v1, s[24:27], s60 offen offset:0 sc1 lds
    buffer_load_dwordx4 v1, s[24:27], s60 offen offset:1024 sc1 lds
    s_add_u32 m0, s61, 4160
    s_add_u32 s60, s93, 65536
    buffer_load_dwordx4 v1, s[24:27], s60 offen offset:0 sc1 lds
    buffer_load_dwordx4 v1, s[24:27], s60 offen offset:1024 sc1 lds
    s_add_u32 m0, s61, 6208
    s_add_u32 s60, s93, 4259840
    buffer_load_dwordx4 v1, s[24:27], s60 offen offset:0 sc1 lds
    buffer_load_dwordx4 v1, s[24:27], s60 offen offset:1024 sc1 lds
    s_and_b32 s60, s88, 262143
    v_and_b32 v9, 15, v0
    v_mul_u32_u24 v9, 262144, v9
    v_add_u32 v9, s60, v9
    s_add_u32 m0, s53, 98304
    s_add_u32 s60, s54, 131072
    v_exp_f32 v48, v48
    v_exp_f32 v49, v49
    v_mfma_f32_32x32x16_bf16 v[184:199], a[44:47], v[204:207], v[184:199]
    v_exp_f32 v50, v50
    v_exp_f32 v51, v51
    buffer_load_dwordx4 v12, s[12:15], s60 offen offset:0 lds
    v_exp_f32 v52, v52
    v_exp_f32 v53, v53
    v_exp_f32 v54, v54
    buffer_load_dwordx4 v14, s[12:15], s60 offen offset:1024 lds
    v_exp_f32 v55, v55
    v_cvt_pk_bf16_f32 v208, v48, v49
    v_cvt_pk_bf16_f32 v209, v50, v51
    v_cvt_pk_bf16_f32 v210, v52, v53
    v_cvt_pk_bf16_f32 v211, v54, v55
    v_and_b32 v208, v160, v208
    v_and_b32 v209, v161, v209
    v_and_b32 v210, v162, v210
    v_and_b32 v211, v163, v211
    v_exp_f32 v56, v56
    v_exp_f32 v57, v57
    s_waitcnt lgkmcnt(0)
    v_mfma_f32_32x32x16_bf16 v[168:183], a[48:51], v[208:211], 0
    v_exp_f32 v58, v58
    v_exp_f32 v59, v59
    buffer_load_dwordx4 v15, s[12:15], s60 offen offset:2048 lds
    v_exp_f32 v60, v60
    v_exp_f32 v61, v61
    v_exp_f32 v62, v62
    buffer_load_dwordx4 v228, s[12:15], s60 offen offset:3072 lds
    v_exp_f32 v63, v63
    v_cvt_pk_bf16_f32 v212, v56, v57
    v_cvt_pk_bf16_f32 v213, v58, v59
    v_cvt_pk_bf16_f32 v214, v60, v61
    v_cvt_pk_bf16_f32 v215, v62, v63
    v_and_b32 v212, v164, v212
    v_and_b32 v213, v165, v213
    v_and_b32 v214, v166, v214
    v_and_b32 v215, v167, v215
    s_add_u32 m0, s53, 102400
    s_add_u32 s60, s54, 163840
    v_exp_f32 v64, v64
    v_exp_f32 v65, v65
    v_mfma_f32_32x32x16_bf16 v[168:183], a[52:55], v[212:215], v[168:183]
    v_exp_f32 v66, v66
    v_exp_f32 v67, v67
    buffer_load_dwordx4 v12, s[12:15], s60 offen offset:0 lds
    v_exp_f32 v68, v68
    v_exp_f32 v69, v69
    v_exp_f32 v70, v70
    buffer_load_dwordx4 v14, s[12:15], s60 offen offset:1024 lds
    v_exp_f32 v71, v71
    v_cvt_pk_bf16_f32 v200, v64, v65
    v_cvt_pk_bf16_f32 v201, v66, v67
    v_cvt_pk_bf16_f32 v202, v68, v69
    v_cvt_pk_bf16_f32 v203, v70, v71
    v_exp_f32 v72, v72
    v_exp_f32 v73, v73
    v_mfma_f32_32x32x16_bf16 v[184:199], a[48:51], v[200:203], v[184:199]
    v_exp_f32 v74, v74
    v_exp_f32 v75, v75
    buffer_load_dwordx4 v15, s[12:15], s60 offen offset:2048 lds
    v_exp_f32 v76, v76
    v_exp_f32 v77, v77
    v_exp_f32 v78, v78
    buffer_load_dwordx4 v228, s[12:15], s60 offen offset:3072 lds
    v_exp_f32 v79, v79
    v_cvt_pk_bf16_f32 v204, v72, v73
    v_cvt_pk_bf16_f32 v205, v74, v75
    v_cvt_pk_bf16_f32 v206, v76, v77
    v_cvt_pk_bf16_f32 v207, v78, v79
    s_nop 1
    v_mfma_f32_32x32x16_bf16 v[184:199], a[52:55], v[204:207], v[184:199]
    s_lshl_b32 s58, s6, 11
    s_and_b32 s34, s58, -8192
    s_add_u32 s34, s34, s58
    s_and_b32 s7, s34, -4096
    s_lshl_b32 s58, s48, 16
    s_add_u32 s7, s7, s58
    s_add_u32 s7, s7, s39
    s_and_b32 s58, s6, 1
    s_lshl_b32 s58, s58, 22
    s_add_u32 s32, s7, s58
    s_sub_u32 s7, s7, s58
    s_add_u32 s32, s32, 8388608
    s_add_u32 s7, s7, 12582912
    s_lshl_b32 s58, s48, 7
    v_mov_b32 v140, -1
    v_mov_b32 v141, -1
    v_mov_b32 v142, -1
    v_mov_b32 v143, -1
    s_add_u32 s58, s58, s38
    s_lshl_b32 s58, s58, 9
    s_add_u32 s58, s58, s39
    s_add_u32 s58, s58, 21004288
    s_mov_b32 exec_hi, 0
    buffer_store_dwordx4 v[140:143], v1, s[24:27], s58 offen sc1
    s_mov_b32 exec_hi, -1
    s_waitcnt vmcnt(9)
    s_cmp_eq_u32 s57, 1
    s_barrier
    s_cbranch_scc1 L_p2exit_5
    ds_read_b128 a[8:11], v131 offset:29120
    ds_read_b128 a[12:15], v131 offset:24960
    ds_read_b128 a[56:59], v132 offset:29120
    ds_read_b128 a[60:63], v133 offset:29120
    ds_read_b128 a[16:19], v131 offset:20800
    s_waitcnt lgkmcnt(4)
    v_mfma_f32_32x32x16_bf16 v[80:95], a[8:11], v[244:247], v[96:111]
    v_mfma_f32_32x32x16_bf16 v[32:47], a[8:11], v[248:251], v[112:127]
    ds_read_b128 a[64:67], v132 offset:24960
    ds_read_b128 a[68:71], v133 offset:24960
    ds_read_b128 a[20:23], v131 offset:16640
    ds_read_b128 a[72:75], v132 offset:20800
    ds_read_b128 a[76:79], v133 offset:20800
    ds_read_b128 a[24:27], v131 offset:12480
    ds_read_b128 a[80:83], v132 offset:16640
    ds_read_b128 a[84:87], v133 offset:16640
    ds_read_b128 a[28:31], v131 offset:8320
    ds_read_b128 a[88:91], v132 offset:12480
    ds_read_b128 a[92:95], v133 offset:12480
    ds_read_b128 a[32:35], v131 offset:4160
    ds_read_b128 a[96:99], v132 offset:8320
    ds_read_b128 a[100:103], v133 offset:8320
    ds_read_b128 a[36:39], v131 offset:0
    ds_read_b128 a[104:107], v132 offset:4160
    ds_read_b128 a[108:111], v133 offset:4160
    ds_read_b128 a[112:115], v132 offset:0
    ds_read_b128 a[116:119], v133 offset:0
    s_add_u32 m0, s53, 131072
    s_add_u32 s60, s54, 0
    v_exp_f32 v80, v80
    v_exp_f32 v81, v81
    v_exp_f32 v82, v82
    v_exp_f32 v83, v83
    buffer_load_dwordx4 v12, s[12:15], s60 offen offset:0 lds
    v_exp_f32 v84, v84
    v_exp_f32 v85, v85
    s_waitcnt lgkmcnt(15)
    v_mfma_f32_32x32x16_bf16 v[48:63], a[12:15], v[244:247], v[96:111]
    v_exp_f32 v86, v86
    buffer_load_dwordx4 v14, s[12:15], s60 offen offset:1024 lds
    v_exp_f32 v87, v87
    v_cvt_pk_bf16_f32 v208, v80, v81
    v_cvt_pk_bf16_f32 v209, v82, v83
    v_cvt_pk_bf16_f32 v210, v84, v85
    v_cvt_pk_bf16_f32 v211, v86, v87
    v_exp_f32 v88, v88
    v_exp_f32 v89, v89
    v_mfma_f32_32x32x16_bf16 v[168:183], a[56:59], v[208:211], v[168:183]
    v_exp_f32 v90, v90
    v_exp_f32 v91, v91
    buffer_load_dwordx4 v15, s[12:15], s60 offen offset:2048 lds
    v_exp_f32 v92, v92
    v_exp_f32 v93, v93
    v_exp_f32 v94, v94
    buffer_load_dwordx4 v228, s[12:15], s60 offen offset:3072 lds
    v_exp_f32 v95, v95
    v_cvt_pk_bf16_f32 v212, v88, v89
    v_cvt_pk_bf16_f32 v213, v90, v91
    v_cvt_pk_bf16_f32 v214, v92, v93
    v_cvt_pk_bf16_f32 v215, v94, v95
    s_add_u32 m0, s53, 135168
    s_add_u32 s60, s54, 32768
    v_exp_f32 v32, v32
    v_exp_f32 v33, v33
    v_mfma_f32_32x32x16_bf16 v[168:183], a[60:63], v[212:215], v[168:183]
    v_exp_f32 v34, v34
    v_exp_f32 v35, v35
    buffer_load_dwordx4 v12, s[12:15], s60 offen offset:0 lds
    v_exp_f32 v36, v36
    v_exp_f32 v37, v37
    v_mfma_f32_32x32x16_bf16 v[64:79], a[12:15], v[248:251], v[112:127]
    v_exp_f32 v38, v38
    buffer_load_dwordx4 v14, s[12:15], s60 offen offset:1024 lds
    v_exp_f32 v39, v39
    v_cvt_pk_bf16_f32 v200, v32, v33
    v_cvt_pk_bf16_f32 v201, v34, v35
    v_cvt_pk_bf16_f32 v202, v36, v37
    v_cvt_pk_bf16_f32 v203, v38, v39
    v_exp_f32 v40, v40
    v_exp_f32 v41, v41
    v_mfma_f32_32x32x16_bf16 v[184:199], a[56:59], v[200:203], v[184:199]
    v_exp_f32 v42, v42
    v_exp_f32 v43, v43
    buffer_load_dwordx4 v15, s[12:15], s60 offen offset:2048 lds
    v_exp_f32 v44, v44
    v_exp_f32 v45, v45
    v_exp_f32 v46, v46
    buffer_load_dwordx4 v228, s[12:15], s60 offen offset:3072 lds
    v_exp_f32 v47, v47
    v_cvt_pk_bf16_f32 v204, v40, v41
    v_cvt_pk_bf16_f32 v205, v42, v43
    v_cvt_pk_bf16_f32 v206, v44, v45
    v_cvt_pk_bf16_f32 v207, v46, v47
    s_waitcnt lgkmcnt(0)
    s_barrier
    s_add_u32 m0, s53, 0
    s_add_u32 s60, s96, 0
    v_exp_f32 v48, v48
    v_exp_f32 v49, v49
    v_mfma_f32_32x32x16_bf16 v[184:199], a[60:63], v[204:207], v[184:199]
    v_exp_f32 v50, v50
    v_exp_f32 v51, v51
    buffer_load_dwordx4 v5, s[16:19], s60 offen offset:0 lds
    v_exp_f32 v52, v52
    v_exp_f32 v53, v53
    v_mfma_f32_32x32x16_bf16 v[80:95], a[16:19], v[244:247], v[96:111]
    v_exp_f32 v54, v54
    buffer_load_dwordx4 v6, s[16:19], s60 offen offset:1024 lds
    v_exp_f32 v55, v55
    v_cvt_pk_bf16_f32 v208, v48, v49
    v_cvt_pk_bf16_f32 v209, v50, v51
    v_cvt_pk_bf16_f32 v210, v52, v53
    v_cvt_pk_bf16_f32 v211, v54, v55
    v_exp_f32 v56, v56
    v_exp_f32 v57, v57
    v_mfma_f32_32x32x16_bf16 v[168:183], a[64:67], v[208:211], v[168:183]
    v_exp_f32 v58, v58
    v_exp_f32 v59, v59
    buffer_load_dwordx4 v7, s[16:19], s60 offen offset:2048 lds
    v_exp_f32 v60, v60
    v_exp_f32 v61, v61
    v_exp_f32 v62, v62
    buffer_load_dwordx4 v8, s[16:19], s60 offen offset:3072 lds
    v_exp_f32 v63, v63
    v_cvt_pk_bf16_f32 v212, v56, v57
    v_cvt_pk_bf16_f32 v213, v58, v59
    v_cvt_pk_bf16_f32 v214, v60, v61
    v_cvt_pk_bf16_f32 v215, v62, v63
    s_add_u32 m0, s53, 4096
    s_add_u32 s60, s96, 114688
    v_exp_f32 v64, v64
    v_exp_f32 v65, v65
    v_mfma_f32_32x32x16_bf16 v[168:183], a[68:71], v[212:215], v[168:183]
    v_exp_f32 v66, v66
    v_exp_f32 v67, v67
    buffer_load_dwordx4 v5, s[16:19], s60 offen offset:0 lds
    v_exp_f32 v68, v68
    v_exp_f32 v69, v69
    v_mfma_f32_32x32x16_bf16 v[32:47], a[16:19], v[248:251], v[112:127]
    v_exp_f32 v70, v70
    buffer_load_dwordx4 v6, s[16:19], s60 offen offset:1024 lds
    v_exp_f32 v71, v71
    v_cvt_pk_bf16_f32 v200, v64, v65
    v_cvt_pk_bf16_f32 v201, v66, v67
    v_cvt_pk_bf16_f32 v202, v68, v69
    v_cvt_pk_bf16_f32 v203, v70, v71
    v_exp_f32 v72, v72
    v_exp_f32 v73, v73
    v_mfma_f32_32x32x16_bf16 v[184:199], a[64:67], v[200:203], v[184:199]
    v_exp_f32 v74, v74
    v_exp_f32 v75, v75
    buffer_load_dwordx4 v7, s[16:19], s60 offen offset:2048 lds
    v_exp_f32 v76, v76
    v_exp_f32 v77, v77
    v_exp_f32 v78, v78
    buffer_load_dwordx4 v8, s[16:19], s60 offen offset:3072 lds
    v_exp_f32 v79, v79
    v_cvt_pk_bf16_f32 v204, v72, v73
    v_cvt_pk_bf16_f32 v205, v74, v75
    v_cvt_pk_bf16_f32 v206, v76, v77
    v_cvt_pk_bf16_f32 v207, v78, v79
    s_cmp_eq_u32 s57, 3
    s_nop 0
    v_mfma_f32_32x32x16_bf16 v[184:199], a[68:71], v[204:207], v[184:199]
    s_cbranch_scc1 L_p2exit_6
    s_add_u32 m0, s53, 32768
    s_add_u32 s60, s96, 458752
    v_exp_f32 v80, v80
    v_exp_f32 v81, v81
    v_exp_f32 v82, v82
    v_exp_f32 v83, v83
    buffer_load_dwordx4 v5, s[16:19], s60 offen offset:0 lds
    v_exp_f32 v84, v84
    v_exp_f32 v85, v85
    v_mfma_f32_32x32x16_bf16 v[48:63], a[20:23], v[244:247], v[96:111]
    v_exp_f32 v86, v86
    buffer_load_dwordx4 v6, s[16:19], s60 offen offset:1024 lds
    v_exp_f32 v87, v87
    v_cvt_pk_bf16_f32 v208, v80, v81
    v_cvt_pk_bf16_f32 v209, v82, v83
    v_cvt_pk_bf16_f32 v210, v84, v85
    v_cvt_pk_bf16_f32 v211, v86, v87
    v_exp_f32 v88, v88
    v_exp_f32 v89, v89
    v_mfma_f32_32x32x16_bf16 v[168:183], a[72:75], v[208:211], v[168:183]
    v_exp_f32 v90, v90
    v_exp_f32 v91, v91
    buffer_load_dwordx4 v7, s[16:19], s60 offen offset:2048 lds
    v_exp_f32 v92, v92
    v_exp_f32 v93, v93
    v_exp_f32 v94, v94
    buffer_load_dwordx4 v8, s[16:19], s60 offen offset:3072 lds
    v_exp_f32 v95, v95
    v_cvt_pk_bf16_f32 v212, v88, v89
    v_cvt_pk_bf16_f32 v213, v90, v91
    v_cvt_pk_bf16_f32 v214, v92, v93
    v_cvt_pk_bf16_f32 v215, v94, v95
    v_exp_f32 v32, v32
    v_exp_f32 v33, v33
    v_mfma_f32_32x32x16_bf16 v[168:183], a[76:79], v[212:215], v[168:183]
    v_exp_f32 v34, v34
    v_exp_f32 v35, v35
    s_cmp_eq_u32 s40, 0
    s_cselect_b64 exec, s[100:101], 0
    buffer_load_dwordx2 v[230:231], v9, s[24:27], 0 offen sc1
    s_mov_b64 exec, -1
    v_exp_f32 v36, v36
    v_exp_f32 v37, v37
    v_mfma_f32_32x32x16_bf16 v[64:79], a[20:23], v[248:251], v[112:127]
    v_exp_f32 v38, v38
    v_exp_f32 v39, v39
    v_cvt_pk_bf16_f32 v200, v32, v33
    v_cvt_pk_bf16_f32 v201, v34, v35
    v_cvt_pk_bf16_f32 v202, v36, v37
    v_cvt_pk_bf16_f32 v203, v38, v39
    v_exp_f32 v40, v40
    v_exp_f32 v41, v41
    v_mfma_f32_32x32x16_bf16 v[184:199], a[72:75], v[200:203], v[184:199]
    v_exp_f32 v42, v42
    v_exp_f32 v43, v43
    v_exp_f32 v44, v44
    v_exp_f32 v45, v45
    v_exp_f32 v46, v46
    v_exp_f32 v47, v47
    v_cvt_pk_bf16_f32 v204, v40, v41
    v_cvt_pk_bf16_f32 v205, v42, v43
    v_cvt_pk_bf16_f32 v206, v44, v45
    v_cvt_pk_bf16_f32 v207, v46, v47
    v_exp_f32 v48, v48
    v_exp_f32 v49, v49
    v_mfma_f32_32x32x16_bf16 v[184:199], a[76:79], v[204:207], v[184:199]
    v_exp_f32 v50, v50
    v_exp_f32 v51, v51
    v_exp_f32 v52, v52
    v_exp_f32 v53, v53
    v_mfma_f32_32x32x16_bf16 v[80:95], a[24:27], v[244:247], v[96:111]
    v_exp_f32 v54, v54
    v_exp_f32 v55, v55
    v_cvt_pk_bf16_f32 v208, v48, v49
    v_cvt_pk_bf16_f32 v209, v50, v51
    v_cvt_pk_bf16_f32 v210, v52, v53
    v_cvt_pk_bf16_f32 v211, v54, v55
    v_exp_f32 v56, v56
    v_exp_f32 v57, v57
    v_mfma_f32_32x32x16_bf16 v[168:183], a[80:83], v[208:211], v[168:183]
    v_exp_f32 v58, v58
    v_exp_f32 v59, v59
    v_exp_f32 v60, v60
    v_exp_f32 v61, v61
    v_exp_f32 v62, v62
    v_exp_f32 v63, v63
    v_cvt_pk_bf16_f32 v212, v56, v57
    v_cvt_pk_bf16_f32 v213, v58, v59
    v_cvt_pk_bf16_f32 v214, v60, v61
    v_cvt_pk_bf16_f32 v215, v62, v63
    v_exp_f32 v64, v64
    v_exp_f32 v65, v65
    v_mfma_f32_32x32x16_bf16 v[168:183], a[84:87], v[212:215], v[168:183]
    v_exp_f32 v66, v66
    v_exp_f32 v67, v67
    v_exp_f32 v68, v68
    v_exp_f32 v69, v69
    v_mfma_f32_32x32x16_bf16 v[32:47], a[24:27], v[248:251], v[112:127]
    v_exp_f32 v70, v70
    v_exp_f32 v71, v71
    v_cvt_pk_bf16_f32 v200, v64, v65
    v_cvt_pk_bf16_f32 v201, v66, v67
    v_cvt_pk_bf16_f32 v202, v68, v69
    v_cvt_pk_bf16_f32 v203, v70, v71
    v_exp_f32 v72, v72
    v_exp_f32 v73, v73
    v_mfma_f32_32x32x16_bf16 v[184:199], a[80:83], v[200:203], v[184:199]
    v_exp_f32 v74, v74
    v_exp_f32 v75, v75
    v_exp_f32 v76, v76
    v_exp_f32 v77, v77
    v_exp_f32 v78, v78
    v_exp_f32 v79, v79
    v_cvt_pk_bf16_f32 v204, v72, v73
    v_cvt_pk_bf16_f32 v205, v74, v75
    v_cvt_pk_bf16_f32 v206, v76, v77
    v_cvt_pk_bf16_f32 v207, v78, v79
    s_cmp_eq_u32 s57, 5
    s_nop 0
    v_mfma_f32_32x32x16_bf16 v[184:199], a[84:87], v[204:207], v[184:199]
    s_cbranch_scc1 L_p2exit_7
    v_exp_f32 v80, v80
    v_exp_f32 v81, v81
    v_exp_f32 v82, v82
    v_exp_f32 v83, v83
    v_exp_f32 v84, v84
    v_exp_f32 v85, v85
    v_mfma_f32_32x32x16_bf16 v[48:63], a[28:31], v[244:247], v[96:111]
    v_exp_f32 v86, v86
    v_exp_f32 v87, v87
    v_cvt_pk_bf16_f32 v208, v80, v81
    v_cvt_pk_bf16_f32 v209, v82, v83
    v_cvt_pk_bf16_f32 v210, v84, v85
    v_cvt_pk_bf16_f32 v211, v86, v87
    v_exp_f32 v88, v88
    v_exp_f32 v89, v89
    v_mfma_f32_32x32x16_bf16 v[168:183], a[88:91], v[208:211], v[168:183]
    v_exp_f32 v90, v90
    v_exp_f32 v91, v91
    v_exp_f32 v92, v92
    v_exp_f32 v93, v93
    v_exp_f32 v94, v94
    v_exp_f32 v95, v95
    v_cvt_pk_bf16_f32 v212, v88, v89
    v_cvt_pk_bf16_f32 v213, v90, v91
    v_cvt_pk_bf16_f32 v214, v92, v93
    v_cvt_pk_bf16_f32 v215, v94, v95
    v_exp_f32 v32, v32
    v_exp_f32 v33, v33
    v_mfma_f32_32x32x16_bf16 v[168:183], a[92:95], v[212:215], v[168:183]
    v_exp_f32 v34, v34
    v_exp_f32 v35, v35
    v_exp_f32 v36, v36
    v_exp_f32 v37, v37
    v_mfma_f32_32x32x16_bf16 v[64:79], a[28:31], v[248:251], v[112:127]
    v_exp_f32 v38, v38
    v_exp_f32 v39, v39
    v_cvt_pk_bf16_f32 v200, v32, v33
    v_cvt_pk_bf16_f32 v201, v34, v35
    v_cvt_pk_bf16_f32 v202, v36, v37
    v_cvt_pk_bf16_f32 v203, v38, v39
    v_exp_f32 v40, v40
    v_exp_f32 v41, v41
    v_mfma_f32_32x32x16_bf16 v[184:199], a[88:91], v[200:203], v[184:199]
    v_exp_f32 v42, v42
    v_exp_f32 v43, v43
    v_exp_f32 v44, v44
    v_exp_f32 v45, v45
    v_exp_f32 v46, v46
    v_exp_f32 v47, v47
    v_cvt_pk_bf16_f32 v204, v40, v41
    v_cvt_pk_bf16_f32 v205, v42, v43
    v_cvt_pk_bf16_f32 v206, v44, v45
    v_cvt_pk_bf16_f32 v207, v46, v47
    v_exp_f32 v48, v48
    v_exp_f32 v49, v49
    v_mfma_f32_32x32x16_bf16 v[184:199], a[92:95], v[204:207], v[184:199]
    v_exp_f32 v50, v50
    v_exp_f32 v51, v51
    v_exp_f32 v52, v52
    v_exp_f32 v53, v53
    v_mfma_f32_32x32x16_bf16 v[80:95], a[32:35], v[244:247], v[96:111]
    v_exp_f32 v54, v54
    v_exp_f32 v55, v55
    v_cvt_pk_bf16_f32 v208, v48, v49
    v_cvt_pk_bf16_f32 v209, v50, v51
    v_cvt_pk_bf16_f32 v210, v52, v53
    v_cvt_pk_bf16_f32 v211, v54, v55
    v_exp_f32 v56, v56
    v_exp_f32 v57, v57
    v_mfma_f32_32x32x16_bf16 v[168:183], a[96:99], v[208:211], v[168:183]
    v_exp_f32 v58, v58
    v_exp_f32 v59, v59
    v_exp_f32 v60, v60
    v_exp_f32 v61, v61
    v_exp_f32 v62, v62
    v_exp_f32 v63, v63
    v_cvt_pk_bf16_f32 v212, v56, v57
    v_cvt_pk_bf16_f32 v213, v58, v59
    v_cvt_pk_bf16_f32 v214, v60, v61
    v_cvt_pk_bf16_f32 v215, v62, v63
    v_exp_f32 v64, v64
    v_exp_f32 v65, v65
    v_mfma_f32_32x32x16_bf16 v[168:183], a[100:103], v[212:215], v[168:183]
    v_exp_f32 v66, v66
    v_exp_f32 v67, v67
    v_exp_f32 v68, v68
    v_exp_f32 v69, v69
    v_mfma_f32_32x32x16_bf16 v[32:47], a[32:35], v[248:251], v[112:127]
    v_exp_f32 v70, v70
    v_exp_f32 v71, v71
    v_cvt_pk_bf16_f32 v200, v64, v65
    v_cvt_pk_bf16_f32 v201, v66, v67
    v_cvt_pk_bf16_f32 v202, v68, v69
    v_cvt_pk_bf16_f32 v203, v70, v71
    v_exp_f32 v72, v72
    v_exp_f32 v73, v73
    v_mfma_f32_32x32x16_bf16 v[184:199], a[96:99], v[200:203], v[184:199]
    v_exp_f32 v74, v74
    v_exp_f32 v75, v75
    v_exp_f32 v76, v76
    v_exp_f32 v77, v77
    v_exp_f32 v78, v78
    v_exp_f32 v79, v79
    v_cvt_pk_bf16_f32 v204, v72, v73
    v_cvt_pk_bf16_f32 v205, v74, v75
    v_cvt_pk_bf16_f32 v206, v76, v77
    v_cvt_pk_bf16_f32 v207, v78, v79
    s_cmp_eq_u32 s57, 7
    s_nop 0
    v_mfma_f32_32x32x16_bf16 v[184:199], a[100:103], v[204:207], v[184:199]
    s_cbranch_scc1 L_p2exit_8
    v_exp_f32 v80, v80
    v_exp_f32 v81, v81
    v_exp_f32 v82, v82
    v_exp_f32 v83, v83
    v_exp_f32 v84, v84
    v_exp_f32 v85, v85
    v_mfma_f32_32x32x16_bf16 v[48:63], a[36:39], v[244:247], v[96:111]
    v_exp_f32 v86, v86
    v_exp_f32 v87, v87
    v_cvt_pk_bf16_f32 v208, v80, v81
    v_cvt_pk_bf16_f32 v209, v82, v83
    v_cvt_pk_bf16_f32 v210, v84, v85
    v_cvt_pk_bf16_f32 v211, v86, v87
    v_exp_f32 v88, v88
    v_exp_f32 v89, v89
    v_mfma_f32_32x32x16_bf16 v[168:183], a[104:107], v[208:211], v[168:183]
    v_exp_f32 v90, v90
    v_exp_f32 v91, v91
    v_exp_f32 v92, v92
    v_exp_f32 v93, v93
    v_exp_f32 v94, v94
    v_exp_f32 v95, v95
    v_cvt_pk_bf16_f32 v212, v88, v89
    v_cvt_pk_bf16_f32 v213, v90, v91
    v_cvt_pk_bf16_f32 v214, v92, v93
    v_cvt_pk_bf16_f32 v215, v94, v95
    v_exp_f32 v32, v32
    v_exp_f32 v33, v33
    v_mfma_f32_32x32x16_bf16 v[168:183], a[108:111], v[212:215], v[168:183]
    v_exp_f32 v34, v34
    v_exp_f32 v35, v35
    v_exp_f32 v36, v36
    v_exp_f32 v37, v37
    v_exp_f32 v38, v38
    v_exp_f32 v39, v39
    v_cvt_pk_bf16_f32 v200, v32, v33
    v_cvt_pk_bf16_f32 v201, v34, v35
    v_cvt_pk_bf16_f32 v202, v36, v37
    v_cvt_pk_bf16_f32 v203, v38, v39
    v_bfi_b32 v200, v160, 0, v200
    v_bfi_b32 v201, v161, 0, v201
    v_bfi_b32 v202, v162, 0, v202
    v_bfi_b32 v203, v163, 0, v203
    v_exp_f32 v40, v40
    v_exp_f32 v41, v41
    v_mfma_f32_32x32x16_bf16 v[184:199], a[104:107], v[200:203], v[184:199]
    v_exp_f32 v42, v42
    v_exp_f32 v43, v43
    v_exp_f32 v44, v44
    v_exp_f32 v45, v45
    v_exp_f32 v46, v46
    v_exp_f32 v47, v47
    v_cvt_pk_bf16_f32 v204, v40, v41
    v_cvt_pk_bf16_f32 v205, v42, v43
    v_cvt_pk_bf16_f32 v206, v44, v45
    v_cvt_pk_bf16_f32 v207, v46, v47
    v_bfi_b32 v204, v164, 0, v204
    v_bfi_b32 v205, v165, 0, v205
    v_bfi_b32 v206, v166, 0, v206
    v_bfi_b32 v207, v167, 0, v207
    v_exp_f32 v48, v48
    v_exp_f32 v49, v49
    v_mfma_f32_32x32x16_bf16 v[184:199], a[108:111], v[204:207], v[184:199]
    v_exp_f32 v50, v50
    v_exp_f32 v51, v51
    v_exp_f32 v52, v52
    v_exp_f32 v53, v53
    v_exp_f32 v54, v54
    v_exp_f32 v55, v55
    v_cvt_pk_bf16_f32 v208, v48, v49
    v_cvt_pk_bf16_f32 v209, v50, v51
    v_cvt_pk_bf16_f32 v210, v52, v53
    v_cvt_pk_bf16_f32 v211, v54, v55
    v_bfi_b32 v208, v160, 0, v208
    v_bfi_b32 v209, v161, 0, v209
    v_bfi_b32 v210, v162, 0, v210
    v_bfi_b32 v211, v163, 0, v211
    v_exp_f32 v56, v56
    v_exp_f32 v57, v57
    v_mfma_f32_32x32x16_bf16 v[168:183], a[112:115], v[208:211], v[168:183]
    v_exp_f32 v58, v58
    v_exp_f32 v59, v59
    v_exp_f32 v60, v60
    v_exp_f32 v61, v61
    v_exp_f32 v62, v62
    v_exp_f32 v63, v63
    v_cvt_pk_bf16_f32 v212, v56, v57
    v_cvt_pk_bf16_f32 v213, v58, v59
    v_cvt_pk_bf16_f32 v214, v60, v61
    v_cvt_pk_bf16_f32 v215, v62, v63
    v_bfi_b32 v212, v164, 0, v212
    v_bfi_b32 v213, v165, 0, v213
    v_bfi_b32 v214, v166, 0, v214
    v_bfi_b32 v215, v167, 0, v215
    s_nop 0
    s_nop 0
    v_mfma_f32_32x32x16_bf16 v[168:183], a[116:119], v[212:215], v[168:183]
L_p2done:
    s_add_u32 s58, s89, 8388608
    s_sub_u32 s59, s58, 65536
    v_rcp_f32 v20, v192
    s_nop 0
    v_pk_mul_f32 v[184:185], v[184:185], v[20:21] op_sel_hi:[1,0]
    v_pk_mul_f32 v[186:187], v[186:187], v[20:21] op_sel_hi:[1,0]
    v_pk_mul_f32 v[188:189], v[188:189], v[20:21] op_sel_hi:[1,0]
    v_pk_mul_f32 v[190:191], v[190:191], v[20:21] op_sel_hi:[1,0]
    v_cvt_pk_bf16_f32 v36, v184, v185
    v_cvt_pk_bf16_f32 v37, v186, v187
    v_cvt_pk_bf16_f32 v38, v188, v189
    v_cvt_pk_bf16_f32 v39, v190, v191
    v_rcp_f32 v18, v176
    buffer_store_dwordx4 v[36:39], v1, s[24:27], s58 offen sc1
    v_pk_mul_f32 v[168:169], v[168:169], v[18:19] op_sel_hi:[1,0]
    v_pk_mul_f32 v[170:171], v[170:171], v[18:19] op_sel_hi:[1,0]
    v_pk_mul_f32 v[172:173], v[172:173], v[18:19] op_sel_hi:[1,0]
    v_pk_mul_f32 v[174:175], v[174:175], v[18:19] op_sel_hi:[1,0]
    v_cvt_pk_bf16_f32 v32, v168, v169
    v_cvt_pk_bf16_f32 v33, v170, v171
    v_cvt_pk_bf16_f32 v34, v172, v173
    v_cvt_pk_bf16_f32 v35, v174, v175
    buffer_store_dwordx4 v[32:35], v1, s[24:27], s59 offen sc1
    v_fma_f32 v23, v184, 0, v192
    v_fma_f32 v22, v168, 0, v176
    v_fma_f32 v23, v185, 0, v23
    v_fma_f32 v22, v169, 0, v22
    v_fma_f32 v23, v186, 0, v23
    v_fma_f32 v22, v170, 0, v22
    v_fma_f32 v23, v187, 0, v23
    v_fma_f32 v22, v171, 0, v22
    v_fma_f32 v23, v188, 0, v23
    v_fma_f32 v22, v172, 0, v22
    v_fma_f32 v23, v189, 0, v23
    v_fma_f32 v22, v173, 0, v22
    v_fma_f32 v23, v190, 0, v23
    v_fma_f32 v22, v174, 0, v22
    v_fma_f32 v23, v191, 0, v23
    v_fma_f32 v22, v175, 0, v22
    v_subrev_u32 v23, 0x2b800000, v23
    v_subrev_u32 v22, 0x2b800000, v22
    v_max_u32 v22, v22, v23
    v_cmp_le_u32 vcc, 0x28000000, v22
    s_cbranch_vccnz L_fb
L_p2ok:
    s_add_u32 s58, s41, 2
    s_add_u32 s44, s42, s58
    s_mov_b32 s45, s43
    v_mov_b32 v18, s44
    v_mov_b32 v19, s45
    s_cmp_lg_u32 s36, 0
    s_waitcnt vmcnt(0)
    s_barrier
    s_cbranch_scc1 L_w123_9
    s_mov_b64 exec, 1
    buffer_store_dwordx2 v[18:19], off, s[24:27], s88 sc1
    s_mov_b64 exec, -1
    s_branch L_join_10
L_w123_9:
    s_cmp_lg_u32 s36, 1
    s_cbranch_scc1 L_t0_11
    s_add_u32 m0, s53, 28672
    s_add_u32 s60, s96, 344064
    buffer_load_dwordx4 v5, s[16:19], s60 offen offset:0 lds
    buffer_load_dwordx4 v6, s[16:19], s60 offen offset:1024 lds
    buffer_load_dwordx4 v7, s[16:19], s60 offen offset:2048 lds
    buffer_load_dwordx4 v8, s[16:19], s60 offen offset:3072 lds
    s_add_u32 m0, s53, 57344
    s_add_u32 s60, s96, 688128
    buffer_load_dwordx4 v5, s[16:19], s60 offen offset:0 lds
    buffer_load_dwordx4 v6, s[16:19], s60 offen offset:1024 lds
    buffer_load_dwordx4 v7, s[16:19], s60 offen offset:2048 lds
    buffer_load_dwordx4 v8, s[16:19], s60 offen offset:3072 lds
    s_add_u32 m0, s53, 61440
    s_add_u32 s60, s96, 802816
    buffer_load_dwordx4 v5, s[16:19], s60 offen offset:0 lds
    buffer_load_dwordx4 v6, s[16:19], s60 offen offset:1024 lds
    buffer_load_dwordx4 v7, s[16:19], s60 offen offset:2048 lds
    buffer_load_dwordx4 v8, s[16:19], s60 offen offset:3072 lds
L_t0_11:
    s_add_u32 m0, s53, 36864
    s_add_u32 s60, s96, 573440
    buffer_load_dwordx4 v5, s[16:19], s60 offen offset:0 lds
    buffer_load_dwordx4 v6, s[16:19], s60 offen offset:1024 lds
    buffer_load_dwordx4 v7, s[16:19], s60 offen offset:2048 lds
    buffer_load_dwordx4 v8, s[16:19], s60 offen offset:3072 lds
    s_add_u32 m0, s53, 65536
    s_add_u32 s60, s96, 917504
    buffer_load_dwordx4 v5, s[16:19], s60 offen offset:0 lds
    buffer_load_dwordx4 v6, s[16:19], s60 offen offset:1024 lds
    buffer_load_dwordx4 v7, s[16:19], s60 offen offset:2048 lds
    buffer_load_dwordx4 v8, s[16:19], s60 offen offset:3072 lds
    s_add_u32 m0, s53, 69632
    s_add_u32 s60, s96, 1032192
    buffer_load_dwordx4 v5, s[16:19], s60 offen offset:0 lds
    buffer_load_dwordx4 v6, s[16:19], s60 offen offset:1024 lds
    buffer_load_dwordx4 v7, s[16:19], s60 offen offset:2048 lds
    buffer_load_dwordx4 v8, s[16:19], s60 offen offset:3072 lds
L_join_10:
    v_accvgpr_read_b32 v64, a248
    v_accvgpr_read_b32 v65, a249
    v_accvgpr_read_b32 v66, a250
    v_accvgpr_read_b32 v67, a251
    v_accvgpr_read_b32 v68, a252
    v_accvgpr_read_b32 v69, a253
    v_accvgpr_read_b32 v70, a254
    v_accvgpr_read_b32 v71, a255
    v_lshlrev_b32 v32, 16, v64
    v_and_b32 v33, s56, v64
    v_lshlrev_b32 v34, 16, v65
    v_and_b32 v35, s56, v65
    v_lshlrev_b32 v36, 16, v66
    v_and_b32 v37, s56, v66
    v_lshlrev_b32 v38, 16, v67
    v_and_b32 v39, s56, v67
    v_lshlrev_b32 v40, 16, v68
    v_and_b32 v41, s56, v68
    v_lshlrev_b32 v42, 16, v69
    v_and_b32 v43, s56, v69
    v_lshlrev_b32 v44, 16, v70
    v_and_b32 v45, s56, v70
    v_lshlrev_b32 v46, 16, v71
    v_and_b32 v47, s56, v71
    v_bfe_u32 v21, v0, 2, 2
    v_lshrrev_b32 v22, 5, v0
    v_lshl_add_u32 v21, v22, 4, v21
    v_bfe_u32 v22, v0, 4, 1
    v_lshl_add_u32 v21, v22, 2, v21
    v_and_b32 v22, 24, v0
    v_lshlrev_b32 v22, 2, v22
    v_and_b32 v23, 3, v0
    v_lshl_add_u32 v22, v23, 3, v22
    s_lshl_b32 s58, s63, 6
    s_lshl_b32 s59, s63, 14
    v_xor_b32 v22, s58, v22
    s_add_u32 s59, s59, 131072
    v_lshlrev_b32 v21, 7, v21
    v_add3_u32 v28, v21, v22, s59
    v_xor_b32 v29, 32, v28
    v_xor_b32 v30, 64, v28
    v_xor_b32 v31, 96, v28
    s_lshl_b32 s93, s49, 16
    s_add_u32 s93, s93, 8388608
    s_lshl_b32 s59, s63, 15
    s_add_u32 s93, s93, s59
    s_add_u32 s93, s93, s39
    s_cmp_lg_u32 s36, 0
    s_cbranch_scc1 L_nopoll_12
L_poll_13:
    buffer_load_dwordx2 v[26:27], v13, s[24:27], 0 offen sc1
    s_sub_u32 s62, s62, 1
    s_waitcnt vmcnt(0)
    v_cmp_ge_u64 vcc, v[26:27], s[44:45]
    v_cmp_le_u64 s[84:85], v[26:27], s[46:47]
    s_cmp_le_i32 s62, 0
    s_cbranch_scc1 L_nopoll_12
    s_and_b64 vcc, vcc, s[84:85]
    s_cmp_eq_u64 vcc, -1
    s_cbranch_scc0 L_poll_13
L_nopoll_12:
    s_barrier
    s_add_u32 s59, s93, 0
    buffer_load_dwordx4 a[0:3], v254, s[24:27], s59 offen offset:0 sc1
    buffer_load_dwordx4 a[4:7], v254, s[24:27], s59 offen offset:256 sc1
    buffer_load_dwordx4 a[8:11], v254, s[24:27], s59 offen offset:2048 sc1
    buffer_load_dwordx4 a[12:15], v254, s[24:27], s59 offen offset:2304 sc1
    s_add_u32 s59, s93, 4096
    buffer_load_dwordx4 a[16:19], v254, s[24:27], s59 offen offset:0 sc1
    buffer_load_dwordx4 a[20:23], v254, s[24:27], s59 offen offset:256 sc1
    buffer_load_dwordx4 a[24:27], v254, s[24:27], s59 offen offset:2048 sc1
    buffer_load_dwordx4 a[28:31], v254, s[24:27], s59 offen offset:2304 sc1
    s_add_u32 s59, s93, 16384
    buffer_load_dwordx4 a[32:35], v254, s[24:27], s59 offen offset:0 sc1
    buffer_load_dwordx4 a[36:39], v254, s[24:27], s59 offen offset:256 sc1
    ds_read_b64_tr_b16 v[64:65], v28 offset:0
    ds_read_b64_tr_b16 v[66:67], v30 offset:1024
    ds_read_b64_tr_b16 v[68:69], v29 offset:0
    ds_read_b64_tr_b16 v[70:71], v31 offset:1024
    ds_read_b64_tr_b16 v[72:73], v30 offset:0
    ds_read_b64_tr_b16 v[74:75], v28 offset:1024
    ds_read_b64_tr_b16 v[76:77], v31 offset:0
    ds_read_b64_tr_b16 v[78:79], v29 offset:1024
    s_waitcnt vmcnt(8) lgkmcnt(4)
    v_mfma_f32_16x16x32_bf16 v[32:35], v[64:67], a[0:3], v[32:35]
    ds_read_b64_tr_b16 v[80:81], v28 offset:4096
    v_mfma_f32_16x16x32_bf16 v[40:43], v[64:67], a[4:7], v[40:43]
    ds_read_b64_tr_b16 v[82:83], v30 offset:5120
    buffer_load_dwordx4 a[40:43], v254, s[24:27], s59 offen offset:2048 sc1
    v_mfma_f32_16x16x32_bf16 v[36:39], v[68:71], a[0:3], v[36:39]
    ds_read_b64_tr_b16 v[84:85], v29 offset:4096
    v_mfma_f32_16x16x32_bf16 v[44:47], v[68:71], a[4:7], v[44:47]
    ds_read_b64_tr_b16 v[86:87], v31 offset:5120
    s_waitcnt lgkmcnt(4)
    v_mfma_f32_16x16x32_bf16 v[48:51], v[72:75], a[0:3], 0
    ds_read_b64_tr_b16 v[88:89], v30 offset:4096
    v_mfma_f32_16x16x32_bf16 v[56:59], v[72:75], a[4:7], 0
    ds_read_b64_tr_b16 v[90:91], v28 offset:5120
    buffer_load_dwordx4 a[44:47], v254, s[24:27], s59 offen offset:2304 sc1
    v_mfma_f32_16x16x32_bf16 v[52:55], v[76:79], a[0:3], 0
    ds_read_b64_tr_b16 v[92:93], v31 offset:4096
    v_mfma_f32_16x16x32_bf16 v[60:63], v[76:79], a[4:7], 0
    ds_read_b64_tr_b16 v[94:95], v29 offset:5120
    s_waitcnt vmcnt(8) lgkmcnt(4)
    v_mfma_f32_16x16x32_bf16 v[32:35], v[80:83], a[8:11], v[32:35]
    ds_read_b64_tr_b16 v[64:65], v28 offset:8192
    s_add_u32 s59, s93, 20480
    v_mfma_f32_16x16x32_bf16 v[40:43], v[80:83], a[12:15], v[40:43]
    ds_read_b64_tr_b16 v[66:67], v30 offset:9216
    buffer_load_dwordx4 a[48:51], v254, s[24:27], s59 offen offset:0 sc1
    v_mfma_f32_16x16x32_bf16 v[36:39], v[84:87], a[8:11], v[36:39]
    ds_read_b64_tr_b16 v[68:69], v29 offset:8192
    v_mfma_f32_16x16x32_bf16 v[44:47], v[84:87], a[12:15], v[44:47]
    ds_read_b64_tr_b16 v[70:71], v31 offset:9216
    s_waitcnt lgkmcnt(4)
    v_mfma_f32_16x16x32_bf16 v[48:51], v[88:91], a[8:11], v[48:51]
    ds_read_b64_tr_b16 v[72:73], v30 offset:8192
    v_mfma_f32_16x16x32_bf16 v[56:59], v[88:91], a[12:15], v[56:59]
    ds_read_b64_tr_b16 v[74:75], v28 offset:9216
    buffer_load_dwordx4 a[52:55], v254, s[24:27], s59 offen offset:256 sc1
    v_mfma_f32_16x16x32_bf16 v[52:55], v[92:95], a[8:11], v[52:55]
    ds_read_b64_tr_b16 v[76:77], v31 offset:8192
    v_mfma_f32_16x16x32_bf16 v[60:63], v[92:95], a[12:15], v[60:63]
    ds_read_b64_tr_b16 v[78:79], v29 offset:9216
    s_waitcnt vmcnt(8) lgkmcnt(4)
    v_mfma_f32_16x16x32_bf16 v[32:35], v[64:67], a[16:19], v[32:35]
    ds_read_b64_tr_b16 v[80:81], v28 offset:12288
    ds_read_b64_tr_b16 v[82:83], v30 offset:13312
    v_mfma_f32_16x16x32_bf16 v[40:43], v[64:67], a[20:23], v[40:43]
    ds_read_b64_tr_b16 v[84:85], v29 offset:12288
    ds_read_b64_tr_b16 v[86:87], v31 offset:13312
    v_mfma_f32_16x16x32_bf16 v[36:39], v[68:71], a[16:19], v[36:39]
    ds_read_b64_tr_b16 v[88:89], v30 offset:12288
    ds_read_b64_tr_b16 v[90:91], v28 offset:13312
    v_mfma_f32_16x16x32_bf16 v[44:47], v[68:71], a[20:23], v[44:47]
    ds_read_b64_tr_b16 v[92:93], v31 offset:12288
    s_waitcnt lgkmcnt(7)
    v_mfma_f32_16x16x32_bf16 v[48:51], v[72:75], a[16:19], v[48:51]
    ds_read_b64_tr_b16 v[94:95], v29 offset:13312
    buffer_load_dwordx4 a[56:59], v254, s[24:27], s59 offen offset:2048 sc1
    v_mfma_f32_16x16x32_bf16 v[56:59], v[72:75], a[20:23], v[56:59]
    buffer_load_dwordx4 a[60:63], v254, s[24:27], s59 offen offset:2304 sc1
    v_mfma_f32_16x16x32_bf16 v[52:55], v[76:79], a[16:19], v[52:55]
    v_mfma_f32_16x16x32_bf16 v[60:63], v[76:79], a[20:23], v[60:63]
    s_waitcnt lgkmcnt(0)
    s_barrier
    v_add_u32 v28, 4294934528, v28
    v_add_u32 v30, 4294934528, v30
    s_waitcnt vmcnt(8)
    v_mfma_f32_16x16x32_bf16 v[32:35], v[80:83], a[24:27], v[32:35]
    ds_read_b64_tr_b16 v[64:65], v28 offset:0
    v_add_u32 v29, 4294934528, v29
    v_mfma_f32_16x16x32_bf16 v[40:43], v[80:83], a[28:31], v[40:43]
    ds_read_b64_tr_b16 v[66:67], v30 offset:1024
    v_add_u32 v31, 4294934528, v31
    v_mfma_f32_16x16x32_bf16 v[36:39], v[84:87], a[24:27], v[36:39]
    ds_read_b64_tr_b16 v[68:69], v29 offset:0
    s_lshl2_add_u32 s98, s0, s1
    v_mfma_f32_16x16x32_bf16 v[44:47], v[84:87], a[28:31], v[44:47]
    ds_read_b64_tr_b16 v[70:71], v31 offset:1024
    v_mfma_f32_16x16x32_bf16 v[48:51], v[88:91], a[24:27], v[48:51]
    ds_read_b64_tr_b16 v[72:73], v30 offset:0
    s_mul_i32 s98, s98, 1536
    v_mfma_f32_16x16x32_bf16 v[56:59], v[88:91], a[28:31], v[56:59]
    ds_read_b64_tr_b16 v[74:75], v28 offset:1024
    s_add_u32 s98, s98, 104857600
    v_mfma_f32_16x16x32_bf16 v[52:55], v[92:95], a[24:27], v[52:55]
    ds_read_b64_tr_b16 v[76:77], v31 offset:0
    v_lshlrev_b32 v255, 7, v0
    v_mfma_f32_16x16x32_bf16 v[60:63], v[92:95], a[28:31], v[60:63]
    ds_read_b64_tr_b16 v[78:79], v29 offset:1024
    s_waitcnt vmcnt(6) lgkmcnt(4)
    v_mfma_f32_16x16x32_bf16 v[32:35], v[64:67], a[32:35], v[32:35]
    ds_read_b64_tr_b16 v[80:81], v28 offset:4096
    v_mfma_f32_16x16x32_bf16 v[40:43], v[64:67], a[36:39], v[40:43]
    ds_read_b64_tr_b16 v[82:83], v30 offset:5120
    v_mfma_f32_16x16x32_bf16 v[36:39], v[68:71], a[32:35], v[36:39]
    ds_read_b64_tr_b16 v[84:85], v29 offset:4096
    v_mfma_f32_16x16x32_bf16 v[44:47], v[68:71], a[36:39], v[44:47]
    ds_read_b64_tr_b16 v[86:87], v31 offset:5120
    s_waitcnt lgkmcnt(4)
    v_mfma_f32_16x16x32_bf16 v[48:51], v[72:75], a[32:35], v[48:51]
    ds_read_b64_tr_b16 v[88:89], v30 offset:4096
    v_mfma_f32_16x16x32_bf16 v[56:59], v[72:75], a[36:39], v[56:59]
    ds_read_b64_tr_b16 v[90:91], v28 offset:5120
    v_mfma_f32_16x16x32_bf16 v[52:55], v[76:79], a[32:35], v[52:55]
    ds_read_b64_tr_b16 v[92:93], v31 offset:4096
    v_mfma_f32_16x16x32_bf16 v[60:63], v[76:79], a[36:39], v[60:63]
    ds_read_b64_tr_b16 v[94:95], v29 offset:5120
    s_waitcnt vmcnt(4) lgkmcnt(4)
    v_mfma_f32_16x16x32_bf16 v[32:35], v[80:83], a[40:43], v[32:35]
    ds_read_b64_tr_b16 v[64:65], v28 offset:8192
    v_mfma_f32_16x16x32_bf16 v[40:43], v[80:83], a[44:47], v[40:43]
    ds_read_b64_tr_b16 v[66:67], v30 offset:9216
    v_mfma_f32_16x16x32_bf16 v[36:39], v[84:87], a[40:43], v[36:39]
    ds_read_b64_tr_b16 v[68:69], v29 offset:8192
    v_mfma_f32_16x16x32_bf16 v[44:47], v[84:87], a[44:47], v[44:47]
    ds_read_b64_tr_b16 v[70:71], v31 offset:9216
    s_waitcnt lgkmcnt(4)
    v_mfma_f32_16x16x32_bf16 v[48:51], v[88:91], a[40:43], v[48:51]
    ds_read_b64_tr_b16 v[72:73], v30 offset:8192
    v_mfma_f32_16x16x32_bf16 v[56:59], v[88:91], a[44:47], v[56:59]
    ds_read_b64_tr_b16 v[74:75], v28 offset:9216
    v_mfma_f32_16x16x32_bf16 v[52:55], v[92:95], a[40:43], v[52:55]
    ds_read_b64_tr_b16 v[76:77], v31 offset:8192
    v_mfma_f32_16x16x32_bf16 v[60:63], v[92:95], a[44:47], v[60:63]
    ds_read_b64_tr_b16 v[78:79], v29 offset:9216
    s_waitcnt vmcnt(2) lgkmcnt(4)
    v_mfma_f32_16x16x32_bf16 v[32:35], v[64:67], a[48:51], v[32:35]
    ds_read_b64_tr_b16 v[80:81], v28 offset:12288
    v_mfma_f32_16x16x32_bf16 v[40:43], v[64:67], a[52:55], v[40:43]
    ds_read_b64_tr_b16 v[82:83], v30 offset:13312
    v_mfma_f32_16x16x32_bf16 v[36:39], v[68:71], a[48:51], v[36:39]
    ds_read_b64_tr_b16 v[84:85], v29 offset:12288
    v_mfma_f32_16x16x32_bf16 v[44:47], v[68:71], a[52:55], v[44:47]
    ds_read_b64_tr_b16 v[86:87], v31 offset:13312
    s_waitcnt lgkmcnt(4)
    v_mfma_f32_16x16x32_bf16 v[48:51], v[72:75], a[48:51], v[48:51]
    ds_read_b64_tr_b16 v[88:89], v30 offset:12288
    v_mfma_f32_16x16x32_bf16 v[56:59], v[72:75], a[52:55], v[56:59]
    ds_read_b64_tr_b16 v[90:91], v28 offset:13312
    v_mfma_f32_16x16x32_bf16 v[52:55], v[76:79], a[48:51], v[52:55]
    ds_read_b64_tr_b16 v[92:93], v31 offset:12288
    v_mfma_f32_16x16x32_bf16 v[60:63], v[76:79], a[52:55], v[60:63]
    ds_read_b64_tr_b16 v[94:95], v29 offset:13312
    s_waitcnt vmcnt(0) lgkmcnt(4)
    v_mfma_f32_16x16x32_bf16 v[32:35], v[80:83], a[56:59], v[32:35]
    s_mov_b32 exec_lo, 0x88888888
    s_mov_b32 exec_hi, 0x8888
    buffer_load_dword v255, v255, s[24:27], s98 offen offset:0
    s_mov_b64 exec, -1
    v_mfma_f32_16x16x32_bf16 v[40:43], v[80:83], a[60:63], v[40:43]
    v_mfma_f32_16x16x32_bf16 v[36:39], v[84:87], a[56:59], v[36:39]
    v_mfma_f32_16x16x32_bf16 v[44:47], v[84:87], a[60:63], v[44:47]
    s_waitcnt lgkmcnt(0)
    v_mfma_f32_16x16x32_bf16 v[48:51], v[88:91], a[56:59], v[48:51]
    v_mfma_f32_16x16x32_bf16 v[56:59], v[88:91], a[60:63], v[56:59]
    v_mfma_f32_16x16x32_bf16 v[52:55], v[92:95], a[56:59], v[52:55]
    v_mfma_f32_16x16x32_bf16 v[60:63], v[92:95], a[60:63], v[60:63]
    s_xor_b32 s58, s36, 2
    s_lshl_b32 s58, s58, 12
    s_add_u32 s58, s58, 131072
    v_add_u32 v30, s58, v1
    s_lshl_b32 s58, s36, 12
    s_add_u32 s58, s58, 131072
    v_add_u32 v31, s58, v1
    s_lshl_b32 s61, s49, 16
    s_add_u32 s61, s61, s39
    s_lshl_b32 s59, s50, 8
    s_lshl_b32 s58, s50, 11
    s_add_u32 s59, s59, s61
    ds_write_b128 v30, v[48:51] offset:0
    ds_write_b128 v30, v[52:55] offset:1024
    ds_write_b128 v30, v[56:59] offset:2048
    ds_write_b128 v30, v[60:63] offset:3072
    s_add_u32 s61, s61, s58
    s_and_b32 s58, s58, -8192
    s_add_u32 s58, s58, s61
    s_add_u32 s58, s58, 12582912
    s_add_u32 s59, s59, 21004288
    s_waitcnt lgkmcnt(0)
    s_barrier
    ds_read_b128 v[64:67], v31 offset:0
    ds_read_b128 v[68:71], v31 offset:1024
    ds_read_b128 v[72:75], v31 offset:2048
    ds_read_b128 v[76:79], v31 offset:3072
    s_waitcnt lgkmcnt(3)
    v_pk_add_f32 v[32:33], v[32:33], v[64:65]
    v_pk_add_f32 v[34:35], v[34:35], v[66:67]
    v_cvt_pk_bf16_f32 v48, v32, v33
    v_cvt_pk_bf16_f32 v49, v34, v35
    s_waitcnt lgkmcnt(2)
    v_pk_add_f32 v[36:37], v[36:37], v[68:69]
    v_pk_add_f32 v[38:39], v[38:39], v[70:71]
    v_cvt_pk_bf16_f32 v50, v36, v37
    v_cvt_pk_bf16_f32 v51, v38, v39
    s_waitcnt lgkmcnt(1)
    v_pk_add_f32 v[40:41], v[40:41], v[72:73]
    v_pk_add_f32 v[42:43], v[42:43], v[74:75]
    v_cvt_pk_bf16_f32 v52, v40, v41
    v_cvt_pk_bf16_f32 v53, v42, v43
    s_waitcnt lgkmcnt(0)
    v_pk_add_f32 v[44:45], v[44:45], v[76:77]
    v_pk_add_f32 v[46:47], v[46:47], v[78:79]
    v_cvt_pk_bf16_f32 v54, v44, v45
    v_cvt_pk_bf16_f32 v55, v46, v47
    buffer_store_dwordx4 v[48:51], v1, s[24:27], s58 offen sc1
    buffer_store_dwordx4 v[52:55], v1, s[24:27], s58 offen offset:1024 sc1
    v_dot2_f32_bf16 v56, v48, s90, 0
    v_dot2_f32_bf16 v57, v48, v48, 0
    v_dot2_f32_bf16 v58, v52, s90, 0
    v_dot2_f32_bf16 v59, v52, v52, 0
    v_dot2_f32_bf16 v56, v49, s90, v56
    v_dot2_f32_bf16 v57, v49, v49, v57
    v_dot2_f32_bf16 v58, v53, s90, v58
    v_dot2_f32_bf16 v59, v53, v53, v59
    v_dot2_f32_bf16 v56, v50, s90, v56
    v_dot2_f32_bf16 v57, v50, v50, v57
    v_dot2_f32_bf16 v58, v54, s90, v58
    v_dot2_f32_bf16 v59, v54, v54, v59
    v_dot2_f32_bf16 v56, v51, s90, v56
    v_dot2_f32_bf16 v57, v51, v51, v57
    v_dot2_f32_bf16 v58, v55, s90, v58
    v_dot2_f32_bf16 v59, v55, v55, v59
    v_lshlrev_b32 v60, 3, v0
    s_nop 1
    v_permlane16_swap_b32 v56, v58
    v_permlane16_swap_b32 v57, v59
    v_add_f32 v56, v56, v58
    v_add_f32 v57, v57, v59
    v_mov_b32 v58, v56
    v_mov_b32 v59, v57
    s_nop 1
    v_permlane32_swap_b32 v56, v58
    v_permlane32_swap_b32 v57, v59
    v_add_f32 v56, v56, v58
    v_add_f32 v57, v57, v59
    s_mov_b32 exec_hi, 0
    buffer_store_dwordx2 v[56:57], v60, s[24:27], s59 offen sc1
    s_mov_b32 exec_hi, -1
    s_cmp_lg_u32 s40, 0
    s_cbranch_scc1 L_pk_14
    s_add_u32 s44, s42, 1
    v_mov_b32 v26, v230
    v_mov_b32 v27, v231
    s_mov_b64 exec, s[100:101]
    v_cmp_ge_u64 vcc, v[26:27], s[44:45]
    v_cmp_le_u64 s[84:85], v[26:27], s[46:47]
    s_mov_b64 exec, -1
    s_and_b64 vcc, vcc, s[84:85]
    s_cmp_eq_u64 vcc, s[100:101]
    s_cbranch_scc1 L_back_16
L_spin_15:
    buffer_load_dwordx2 v[26:27], v9, s[24:27], 0 offen sc1
    s_sub_u32 s62, s62, 1
    s_waitcnt vmcnt(0)
    v_cmp_ge_u64 vcc, v[26:27], s[44:45]
    v_cmp_le_u64 s[84:85], v[26:27], s[46:47]
    s_cmp_le_i32 s62, 0
    s_cbranch_scc1 L_back_16
    s_and_b64 vcc, vcc, s[84:85]
    s_cmp_eq_u64 vcc, -1
    s_cbranch_scc0 L_spin_15
L_back_16:
L_pk_14:
    s_add_u32 s58, s41, 3
    s_add_u32 s44, s42, s58
    s_mov_b32 s45, s43
    v_mov_b32 v18, s44
    v_mov_b32 v19, s45
    s_cmp_lg_u32 s36, 0
    s_waitcnt vmcnt(1)
    s_barrier
    s_cbranch_scc1 L_w123_17
    s_mov_b64 exec, 1
    buffer_store_dwordx2 v[18:19], off, s[24:27], s88 sc1
    s_mov_b64 exec, -1
    s_branch L_join_18
L_w123_17:
    s_cmp_lg_u32 s36, 1
    s_cbranch_scc1 L_t0_19
    s_add_u32 m0, s53, 90112
    s_add_u32 s60, s96, 1146880
    buffer_load_dwordx4 v5, s[16:19], s60 offen offset:0 lds
    buffer_load_dwordx4 v6, s[16:19], s60 offen offset:1024 lds
    buffer_load_dwordx4 v7, s[16:19], s60 offen offset:2048 lds
    buffer_load_dwordx4 v8, s[16:19], s60 offen offset:3072 lds
    s_add_u32 m0, s53, 94208
    s_add_u32 s60, s96, 1261568
    buffer_load_dwordx4 v5, s[16:19], s60 offen offset:0 lds
    buffer_load_dwordx4 v6, s[16:19], s60 offen offset:1024 lds
    buffer_load_dwordx4 v7, s[16:19], s60 offen offset:2048 lds
    buffer_load_dwordx4 v8, s[16:19], s60 offen offset:3072 lds
    s_add_u32 m0, s52, 124928
    s_add_u32 s60, s94, -6144
    buffer_load_dwordx4 v1, s[24:27], s60 offen offset:0 sc1 lds
    buffer_load_dwordx4 v1, s[24:27], s60 offen offset:1024 sc1 lds
    buffer_load_dwordx4 v1, s[24:27], s60 offen offset:2048 sc1 lds
    buffer_load_dwordx4 v1, s[24:27], s60 offen offset:3072 sc1 lds
    s_add_u32 m0, s52, 129024
    s_add_u32 s60, s94, -2048
    buffer_load_dwordx4 v1, s[24:27], s60 offen offset:0 sc1 lds
    buffer_load_dwordx4 v1, s[24:27], s60 offen offset:1024 sc1 lds
L_t0_19:
    s_add_u32 m0, s53, 98304
    s_add_u32 s60, s96, 1376256
    buffer_load_dwordx4 v5, s[16:19], s60 offen offset:0 lds
    buffer_load_dwordx4 v6, s[16:19], s60 offen offset:1024 lds
    buffer_load_dwordx4 v7, s[16:19], s60 offen offset:2048 lds
    buffer_load_dwordx4 v8, s[16:19], s60 offen offset:3072 lds
    s_add_u32 m0, s53, 102400
    s_add_u32 s60, s96, 1490944
    buffer_load_dwordx4 v5, s[16:19], s60 offen offset:0 lds
    buffer_load_dwordx4 v6, s[16:19], s60 offen offset:1024 lds
    buffer_load_dwordx4 v7, s[16:19], s60 offen offset:2048 lds
    buffer_load_dwordx4 v8, s[16:19], s60 offen offset:3072 lds
    s_add_u32 m0, s52, 131072
    s_add_u32 s60, s94, 0
    buffer_load_dwordx4 v1, s[24:27], s60 offen offset:0 sc1 lds
    buffer_load_dwordx4 v1, s[24:27], s60 offen offset:1024 sc1 lds
    buffer_load_dwordx4 v1, s[24:27], s60 offen offset:2048 sc1 lds
    buffer_load_dwordx4 v1, s[24:27], s60 offen offset:3072 sc1 lds
    s_add_u32 m0, s52, 135168
    s_add_u32 s60, s94, 4096
    buffer_load_dwordx4 v1, s[24:27], s60 offen offset:0 sc1 lds
    buffer_load_dwordx4 v1, s[24:27], s60 offen offset:1024 sc1 lds
L_join_18:
    v_and_b32 v22, 15, v0
    v_lshrrev_b32 v23, 2, v0
    v_lshrrev_b32 v24, 5, v0
    v_lshlrev_b32 v24, 6, v24
    v_lshl_add_u32 v192, v22, 2, v24
    v_and_b32 v24, 3, v22
    v_lshlrev_b32 v24, 3, v24
    v_mul_u32_u24 v25, 96, v23
    v_lshl_add_u32 v28, v23, 7, v24
    s_lshl_b32 s58, s36, 1
    s_lshr_b32 s92, 0x924, s58
    s_bfe_u32 s58, s92, 0x20000
    s_lshl_b32 s58, s58, 5
    s_add_u32 s58, s58, 131072
    v_add3_u32 v188, v25, v24, s58
    s_bfe_u32 s58, s92, 0x20002
    s_lshl_b32 s58, s58, 5
    s_add_u32 s58, s58, 131072
    v_add3_u32 v189, v25, v24, s58
    s_bfe_u32 s58, s92, 0x20004
    s_lshl_b32 s58, s58, 5
    s_add_u32 s58, s58, 131072
    v_add3_u32 v190, v25, v24, s58
    v_and_b32 v22, 24, v0
    v_lshlrev_b32 v22, 2, v22
    s_lshl_b32 s58, s36, 5
    v_xor_b32 v22, s58, v22
    v_add_u32 v28, v28, v22
    v_xor_b32 v29, 32, v28
    v_xor_b32 v30, 64, v28
    v_xor_b32 v31, 96, v28
    v_lshrrev_b32 v20, 5, v0
    v_and_b32 v21, 31, v0
    v_lshlrev_b32 v20, 11, v20
    s_lshl_b32 s93, s48, 16
    v_lshl_add_u32 v20, v21, 3, v20
    s_add_u32 s93, s93, s39
    s_add_u32 s93, s93, 21004288
    s_lshl_b32 s61, s48, 16
    s_add_u32 s61, s61, s39
    s_add_u32 s61, s61, 12582912
    ds_read_b64_tr_b16 a[48:49], v28 offset:0
    ds_read_b64_tr_b16 a[50:51], v28 offset:2048
    ds_read_b64_tr_b16 a[52:53], v28 offset:16384
    ds_read_b64_tr_b16 a[54:55], v28 offset:18432
    ds_read_b64_tr_b16 a[0:1], v29 offset:0
    ds_read_b64_tr_b16 a[2:3], v29 offset:2048
    ds_read_b64_tr_b16 a[4:5], v29 offset:16384
    ds_read_b64_tr_b16 a[6:7], v29 offset:18432
    ds_read_b64_tr_b16 a[8:9], v30 offset:0
    ds_read_b64_tr_b16 a[10:11], v30 offset:2048
    ds_read_b64_tr_b16 a[12:13], v30 offset:16384
    ds_read_b64_tr_b16 a[14:15], v30 offset:18432
    ds_read_b64_tr_b16 a[16:17], v31 offset:0
    ds_read_b64_tr_b16 a[18:19], v31 offset:2048
    ds_read_b64_tr_b16 a[20:21], v31 offset:16384
    ds_read_b64_tr_b16 a[22:23], v31 offset:18432
    s_add_u32 s34, s34, s61
    s_cmp_lg_u32 s40, 0
    s_cbranch_scc1 L_l0_20
    v_mov_b32 v160, -1
    v_mov_b32 v161, -1
    v_mov_b32 v162, -1
    v_mov_b32 v163, -1
    s_add_u32 s35, s34, 4194304
    buffer_store_dwordx4 v[160:163], v1, s[24:27], s35 offen offset:0 sc1
    buffer_store_dwordx4 v[160:163], v1, s[24:27], s35 offen offset:1024 sc1
L_l0_20:
    s_lshl_b32 s58, s36, 18
    s_add_u32 s58, s58, s4
    s_add_u32 s58, s58, s39
    s_and_b32 s59, s6, 1
    s_lshl_b32 s59, s59, 16
    s_add_u32 s58, s58, s59
    s_and_b32 s59, s6, 0
    s_lshl_b32 s59, s59, 11
    s_add_u32 s58, s58, s59
    s_add_u32 s58, s58, 131072
    s_and_b32 s59, s6, 0
    s_lshr_b32 s59, 0x24924924, s59
    s_bfe_u32 s89, s59, 0x20000
    s_lshl_b32 s89, s89, 14
    s_add_u32 s89, s89, s58
    s_bfe_u32 s81, s59, 0x20002
    s_lshl_b32 s81, s81, 14
    s_add_u32 s81, s81, s58
    s_bfe_u32 s82, s59, 0x20004
    s_lshl_b32 s82, s82, 14
    s_add_u32 s82, s82, s58
    s_and_b32 s58, s5, -64
    s_xor_b32 s59, s5, 64
    v_and_b32 v221, 7, v0
    v_lshl_add_u32 v221, v221, 3, s58
    s_and_b32 s58, s5, -128
    v_and_b32 v220, 15, v0
    v_lshl_add_u32 v220, v220, 3, s58
    s_cmp_lg_u32 s40, 0
    s_cbranch_scc1 L_nocs_21
    v_add_u32 v22, 65536, v28
    ds_read_b64_tr_b16 a[80:81], v28 offset:0
    ds_read_b64_tr_b16 a[82:83], v28 offset:2048
    ds_read_b64_tr_b16 a[84:85], v28 offset:16384
    ds_read_b64_tr_b16 a[86:87], v28 offset:18432
    ds_read_b64_tr_b16 a[88:89], v28 offset:4096
    ds_read_b64_tr_b16 a[90:91], v28 offset:6144
    ds_read_b64_tr_b16 a[92:93], v28 offset:20480
    ds_read_b64_tr_b16 a[94:95], v28 offset:22528
    ds_read_b64_tr_b16 a[96:97], v28 offset:8192
    ds_read_b64_tr_b16 a[98:99], v28 offset:10240
    ds_read_b64_tr_b16 a[100:101], v28 offset:24576
    ds_read_b64_tr_b16 a[102:103], v28 offset:26624
    s_waitcnt lgkmcnt(8)
    v_mfma_f32_16x16x32_bf16 a[208:211], v[236:239], a[80:83], 0
    ds_read_b64_tr_b16 a[104:105], v28 offset:12288
    ds_read_b64_tr_b16 a[106:107], v28 offset:14336
    v_mfma_f32_16x16x32_bf16 a[212:215], v[236:239], a[84:87], 0
    ds_read_b64_tr_b16 a[108:109], v28 offset:28672
    ds_read_b64_tr_b16 a[110:111], v28 offset:30720
    s_waitcnt lgkmcnt(8)
    v_mfma_f32_16x16x32_bf16 a[208:211], v[236:239], a[88:91], a[208:211]
    ds_read_b64_tr_b16 a[112:113], v28 offset:32768
    ds_read_b64_tr_b16 a[114:115], v28 offset:34816
    v_mfma_f32_16x16x32_bf16 a[212:215], v[236:239], a[92:95], a[212:215]
    ds_read_b64_tr_b16 a[116:117], v28 offset:49152
    ds_read_b64_tr_b16 a[118:119], v28 offset:51200
    s_waitcnt lgkmcnt(8)
    v_mfma_f32_16x16x32_bf16 a[208:211], v[236:239], a[96:99], a[208:211]
    ds_read_b64_tr_b16 a[120:121], v28 offset:36864
    ds_read_b64_tr_b16 a[122:123], v28 offset:38912
    v_mfma_f32_16x16x32_bf16 a[212:215], v[236:239], a[100:103], a[212:215]
    ds_read_b64_tr_b16 a[124:125], v28 offset:53248
    ds_read_b64_tr_b16 a[126:127], v28 offset:55296
    s_waitcnt lgkmcnt(8)
    v_mfma_f32_16x16x32_bf16 a[208:211], v[236:239], a[104:107], a[208:211]
    ds_read_b64_tr_b16 a[128:129], v28 offset:40960
    ds_read_b64_tr_b16 a[130:131], v28 offset:43008
    v_mfma_f32_16x16x32_bf16 a[212:215], v[236:239], a[108:111], a[212:215]
    ds_read_b64_tr_b16 a[132:133], v28 offset:57344
    ds_read_b64_tr_b16 a[134:135], v28 offset:59392
    s_waitcnt lgkmcnt(8)
    v_mfma_f32_16x16x32_bf16 a[208:211], v[236:239], a[112:115], a[208:211]
    ds_read_b64_tr_b16 a[136:137], v28 offset:45056
    ds_read_b64_tr_b16 a[138:139], v28 offset:47104
    v_mfma_f32_16x16x32_bf16 a[212:215], v[236:239], a[116:119], a[212:215]
    ds_read_b64_tr_b16 a[140:141], v28 offset:61440
    ds_read_b64_tr_b16 a[142:143], v28 offset:63488
    s_waitcnt lgkmcnt(8)
    v_mfma_f32_16x16x32_bf16 a[208:211], v[236:239], a[120:123], a[208:211]
    ds_read_b64_tr_b16 a[144:145], v22 offset:0
    ds_read_b64_tr_b16 a[146:147], v22 offset:2048
    v_mfma_f32_16x16x32_bf16 a[212:215], v[236:239], a[124:127], a[212:215]
    ds_read_b64_tr_b16 a[148:149], v22 offset:16384
    ds_read_b64_tr_b16 a[150:151], v22 offset:18432
    s_waitcnt lgkmcnt(8)
    v_mfma_f32_16x16x32_bf16 a[208:211], v[236:239], a[128:131], a[208:211]
    ds_read_b64_tr_b16 a[152:153], v22 offset:4096
    ds_read_b64_tr_b16 a[154:155], v22 offset:6144
    v_mfma_f32_16x16x32_bf16 a[212:215], v[236:239], a[132:135], a[212:215]
    ds_read_b64_tr_b16 a[156:157], v22 offset:20480
    ds_read_b64_tr_b16 a[158:159], v22 offset:22528
    s_waitcnt lgkmcnt(8)
    v_mfma_f32_16x16x32_bf16 a[208:211], v[236:239], a[136:139], a[208:211]
    ds_read_b64_tr_b16 a[160:161], v22 offset:8192
    ds_read_b64_tr_b16 a[162:163], v22 offset:10240
    v_mfma_f32_16x16x32_bf16 a[212:215], v[236:239], a[140:143], a[212:215]
    ds_read_b64_tr_b16 a[164:165], v22 offset:24576
    ds_read_b64_tr_b16 a[166:167], v22 offset:26624
    s_waitcnt lgkmcnt(8)
    v_mfma_f32_16x16x32_bf16 a[208:211], v[236:239], a[144:147], a[208:211]
    ds_read_b64_tr_b16 a[168:169], v22 offset:12288
    ds_read_b64_tr_b16 a[170:171], v22 offset:14336
    v_mfma_f32_16x16x32_bf16 a[212:215], v[236:239], a[148:151], a[212:215]
    ds_read_b64_tr_b16 a[172:173], v22 offset:28672
    ds_read_b64_tr_b16 a[174:175], v22 offset:30720
    s_waitcnt lgkmcnt(8)
    v_mfma_f32_16x16x32_bf16 a[208:211], v[236:239], a[152:155], a[208:211]
    v_mfma_f32_16x16x32_bf16 a[212:215], v[236:239], a[156:159], a[212:215]
    s_waitcnt lgkmcnt(4)
    v_mfma_f32_16x16x32_bf16 a[208:211], v[236:239], a[160:163], a[208:211]
    v_mfma_f32_16x16x32_bf16 a[212:215], v[236:239], a[164:167], a[212:215]
    s_waitcnt lgkmcnt(0)
    v_mfma_f32_16x16x32_bf16 a[208:211], v[236:239], a[168:171], a[208:211]
    v_mfma_f32_16x16x32_bf16 a[212:215], v[236:239], a[172:175], a[212:215]
L_nocs_21:
    s_cmp_lg_u32 s36, 0
    s_cbranch_scc1 L_nopoll_22
L_poll_23:
    buffer_load_dwordx2 v[26:27], v13, s[24:27], 0 offen sc1
    s_sub_u32 s62, s62, 1
    s_waitcnt vmcnt(0)
    v_cmp_ge_u64 vcc, v[26:27], s[44:45]
    v_cmp_le_u64 s[84:85], v[26:27], s[46:47]
    s_cmp_le_i32 s62, 0
    s_cbranch_scc1 L_nopoll_22
    s_and_b64 vcc, vcc, s[84:85]
    s_cmp_eq_u64 vcc, -1
    s_cbranch_scc0 L_poll_23
L_nopoll_22:
    s_barrier
    s_add_u32 s59, s61, 0
    buffer_load_dwordx4 a[80:83], v1, s[24:27], s59 offen offset:0 sc1
    buffer_load_dwordx4 a[84:87], v1, s[24:27], s59 offen offset:1024 sc1
    buffer_load_dwordx4 a[88:91], v1, s[24:27], s59 offen offset:2048 sc1
    buffer_load_dwordx4 a[92:95], v1, s[24:27], s59 offen offset:3072 sc1
    s_add_u32 s59, s61, 4096
    buffer_load_dwordx4 a[96:99], v1, s[24:27], s59 offen offset:0 sc1
    buffer_load_dwordx4 a[100:103], v1, s[24:27], s59 offen offset:1024 sc1
    buffer_load_dwordx4 a[104:107], v1, s[24:27], s59 offen offset:2048 sc1
    buffer_load_dwordx4 a[108:111], v1, s[24:27], s59 offen offset:3072 sc1
    s_waitcnt vmcnt(6) lgkmcnt(8)
    v_mfma_f32_16x16x32_bf16 v[32:35], a[48:51], a[80:83], 0
    ds_read_b64_tr_b16 a[56:57], v28 offset:4096
    v_mfma_f32_16x16x32_bf16 v[36:39], a[48:51], a[84:87], 0
    ds_read_b64_tr_b16 a[58:59], v28 offset:6144
    s_add_u32 s59, s61, 16384
    v_mfma_f32_16x16x32_bf16 v[40:43], a[52:55], a[80:83], 0
    ds_read_b64_tr_b16 a[60:61], v28 offset:20480
    buffer_load_dwordx4 a[112:115], v1, s[24:27], s59 offen offset:0 sc1
    v_mfma_f32_16x16x32_bf16 v[44:47], a[52:55], a[84:87], 0
    ds_read_b64_tr_b16 a[62:63], v28 offset:22528
    v_mfma_f32_16x16x32_bf16 v[48:51], a[0:3], a[80:83], 0
    ds_read_b64_tr_b16 a[24:25], v29 offset:4096
    v_mfma_f32_16x16x32_bf16 v[52:55], a[0:3], a[84:87], 0
    ds_read_b64_tr_b16 a[26:27], v29 offset:6144
    buffer_load_dwordx2 v[144:145], v20, s[24:27], s93 offen offset:0 sc1
    v_mfma_f32_16x16x32_bf16 v[56:59], a[4:7], a[80:83], 0
    ds_read_b64_tr_b16 a[28:29], v29 offset:20480
    buffer_load_dwordx4 a[116:119], v1, s[24:27], s59 offen offset:1024 sc1
    v_mfma_f32_16x16x32_bf16 v[60:63], a[4:7], a[84:87], 0
    ds_read_b64_tr_b16 a[30:31], v29 offset:22528
    s_waitcnt lgkmcnt(8)
    v_mfma_f32_16x16x32_bf16 v[64:67], a[8:11], a[80:83], 0
    ds_read_b64_tr_b16 a[32:33], v30 offset:4096
    v_mfma_f32_16x16x32_bf16 v[68:71], a[8:11], a[84:87], 0
    ds_read_b64_tr_b16 a[34:35], v30 offset:6144
    v_mfma_f32_16x16x32_bf16 v[72:75], a[12:15], a[80:83], 0
    ds_read_b64_tr_b16 a[36:37], v30 offset:20480
    buffer_load_dwordx4 a[120:123], v1, s[24:27], s59 offen offset:2048 sc1
    v_mfma_f32_16x16x32_bf16 v[76:79], a[12:15], a[84:87], 0
    ds_read_b64_tr_b16 a[38:39], v30 offset:22528
    v_mfma_f32_16x16x32_bf16 v[80:83], a[16:19], a[80:83], 0
    ds_read_b64_tr_b16 a[40:41], v31 offset:4096
    v_mfma_f32_16x16x32_bf16 v[84:87], a[16:19], a[84:87], 0
    ds_read_b64_tr_b16 a[42:43], v31 offset:6144
    buffer_load_dwordx2 v[146:147], v20, s[24:27], s93 offen offset:256 sc1
    v_mfma_f32_16x16x32_bf16 v[88:91], a[20:23], a[80:83], 0
    ds_read_b64_tr_b16 a[44:45], v31 offset:20480
    buffer_load_dwordx4 a[124:127], v1, s[24:27], s59 offen offset:3072 sc1
    v_mfma_f32_16x16x32_bf16 v[92:95], a[20:23], a[84:87], 0
    ds_read_b64_tr_b16 a[46:47], v31 offset:22528
    s_waitcnt vmcnt(10) lgkmcnt(8)
    v_mfma_f32_16x16x32_bf16 v[32:35], a[56:59], a[88:91], v[32:35]
    ds_read_b64_tr_b16 a[64:65], v28 offset:8192
    v_mfma_f32_16x16x32_bf16 v[36:39], a[56:59], a[92:95], v[36:39]
    ds_read_b64_tr_b16 a[66:67], v28 offset:10240
    s_add_u32 s59, s61, 20480
    v_mfma_f32_16x16x32_bf16 v[40:43], a[60:63], a[88:91], v[40:43]
    ds_read_b64_tr_b16 a[68:69], v28 offset:24576
    buffer_load_dwordx4 a[128:131], v1, s[24:27], s59 offen offset:0 sc1
    v_mfma_f32_16x16x32_bf16 v[44:47], a[60:63], a[92:95], v[44:47]
    ds_read_b64_tr_b16 a[70:71], v28 offset:26624
    v_mfma_f32_16x16x32_bf16 v[48:51], a[24:27], a[88:91], v[48:51]
    ds_read_b64_tr_b16 a[0:1], v29 offset:8192
    v_mfma_f32_16x16x32_bf16 v[52:55], a[24:27], a[92:95], v[52:55]
    ds_read_b64_tr_b16 a[2:3], v29 offset:10240
    buffer_load_dwordx2 v[148:149], v20, s[24:27], s93 offen offset:512 sc1
    v_mfma_f32_16x16x32_bf16 v[56:59], a[28:31], a[88:91], v[56:59]
    ds_read_b64_tr_b16 a[4:5], v29 offset:24576
    buffer_load_dwordx4 a[132:135], v1, s[24:27], s59 offen offset:1024 sc1
    v_mfma_f32_16x16x32_bf16 v[60:63], a[28:31], a[92:95], v[60:63]
    ds_read_b64_tr_b16 a[6:7], v29 offset:26624
    s_waitcnt lgkmcnt(8)
    v_mfma_f32_16x16x32_bf16 v[64:67], a[32:35], a[88:91], v[64:67]
    ds_read_b64_tr_b16 a[8:9], v30 offset:8192
    v_mfma_f32_16x16x32_bf16 v[68:71], a[32:35], a[92:95], v[68:71]
    ds_read_b64_tr_b16 a[10:11], v30 offset:10240
    v_mfma_f32_16x16x32_bf16 v[72:75], a[36:39], a[88:91], v[72:75]
    ds_read_b64_tr_b16 a[12:13], v30 offset:24576
    buffer_load_dwordx4 a[136:139], v1, s[24:27], s59 offen offset:2048 sc1
    v_mfma_f32_16x16x32_bf16 v[76:79], a[36:39], a[92:95], v[76:79]
    ds_read_b64_tr_b16 a[14:15], v30 offset:26624
    v_mfma_f32_16x16x32_bf16 v[80:83], a[40:43], a[88:91], v[80:83]
    ds_read_b64_tr_b16 a[16:17], v31 offset:8192
    v_mfma_f32_16x16x32_bf16 v[84:87], a[40:43], a[92:95], v[84:87]
    ds_read_b64_tr_b16 a[18:19], v31 offset:10240
    buffer_load_dwordx2 v[150:151], v20, s[24:27], s93 offen offset:768 sc1
    v_mfma_f32_16x16x32_bf16 v[88:91], a[44:47], a[88:91], v[88:91]
    ds_read_b64_tr_b16 a[20:21], v31 offset:24576
    buffer_load_dwordx4 a[140:143], v1, s[24:27], s59 offen offset:3072 sc1
    v_mfma_f32_16x16x32_bf16 v[92:95], a[44:47], a[92:95], v[92:95]
    ds_read_b64_tr_b16 a[22:23], v31 offset:26624
    s_waitcnt vmcnt(14) lgkmcnt(8)
    v_mfma_f32_16x16x32_bf16 v[32:35], a[64:67], a[96:99], v[32:35]
    ds_read_b64_tr_b16 a[72:73], v28 offset:12288
    ds_read_b64_tr_b16 a[74:75], v28 offset:14336
    v_mfma_f32_16x16x32_bf16 v[36:39], a[64:67], a[100:103], v[36:39]
    ds_read_b64_tr_b16 a[76:77], v28 offset:28672
    ds_read_b64_tr_b16 a[78:79], v28 offset:30720
    v_mfma_f32_16x16x32_bf16 v[40:43], a[68:71], a[96:99], v[40:43]
    ds_read_b64_tr_b16 a[24:25], v29 offset:12288
    ds_read_b64_tr_b16 a[26:27], v29 offset:14336
    v_mfma_f32_16x16x32_bf16 v[44:47], a[68:71], a[100:103], v[44:47]
    ds_read_b64_tr_b16 a[28:29], v29 offset:28672
    ds_read_b64_tr_b16 a[30:31], v29 offset:30720
    v_mfma_f32_16x16x32_bf16 v[48:51], a[0:3], a[96:99], v[48:51]
    ds_read_b64_tr_b16 a[32:33], v30 offset:12288
    ds_read_b64_tr_b16 a[34:35], v30 offset:14336
    v_mfma_f32_16x16x32_bf16 v[52:55], a[0:3], a[100:103], v[52:55]
    ds_read_b64_tr_b16 a[36:37], v30 offset:28672
    ds_read_b64_tr_b16 a[38:39], v30 offset:30720
    v_mfma_f32_16x16x32_bf16 v[56:59], a[4:7], a[96:99], v[56:59]
    ds_read_b64_tr_b16 a[40:41], v31 offset:12288
    s_add_u32 s59, s61, 32768
    v_mfma_f32_16x16x32_bf16 v[60:63], a[4:7], a[100:103], v[60:63]
    ds_read_b64_tr_b16 a[42:43], v31 offset:14336
    s_waitcnt lgkmcnt(14)
    v_mfma_f32_16x16x32_bf16 v[64:67], a[8:11], a[96:99], v[64:67]
    ds_read_b64_tr_b16 a[44:45], v31 offset:28672
    buffer_load_dwordx4 a[144:147], v1, s[24:27], s59 offen offset:0 sc1
    v_mfma_f32_16x16x32_bf16 v[68:71], a[8:11], a[100:103], v[68:71]
    ds_read_b64_tr_b16 a[46:47], v31 offset:30720
    buffer_load_dwordx4 a[148:151], v1, s[24:27], s59 offen offset:1024 sc1
    v_mfma_f32_16x16x32_bf16 v[72:75], a[12:15], a[96:99], v[72:75]
    buffer_load_dwordx4 a[152:155], v1, s[24:27], s59 offen offset:2048 sc1
    v_mfma_f32_16x16x32_bf16 v[76:79], a[12:15], a[100:103], v[76:79]
    buffer_load_dwordx2 v[152:153], v20, s[24:27], s93 offen offset:1024 sc1
    v_mfma_f32_16x16x32_bf16 v[80:83], a[16:19], a[96:99], v[80:83]
    v_mfma_f32_16x16x32_bf16 v[84:87], a[16:19], a[100:103], v[84:87]
    buffer_load_dwordx2 v[154:155], v20, s[24:27], s93 offen offset:1280 sc1
    v_mfma_f32_16x16x32_bf16 v[88:91], a[20:23], a[96:99], v[88:91]
    buffer_load_dwordx4 a[156:159], v1, s[24:27], s59 offen offset:3072 sc1
    v_mfma_f32_16x16x32_bf16 v[92:95], a[20:23], a[100:103], v[92:95]
    s_waitcnt lgkmcnt(0)
    s_barrier
    v_add_u32 v28, 32768, v28
    s_waitcnt vmcnt(18)
    v_mfma_f32_16x16x32_bf16 v[32:35], a[72:75], a[104:107], v[32:35]
    ds_read_b64_tr_b16 a[48:49], v28 offset:0
    v_mfma_f32_16x16x32_bf16 v[36:39], a[72:75], a[108:111], v[36:39]
    ds_read_b64_tr_b16 a[50:51], v28 offset:2048
    s_add_u32 s59, s61, 36864
    v_mfma_f32_16x16x32_bf16 v[40:43], a[76:79], a[104:107], v[40:43]
    ds_read_b64_tr_b16 a[52:53], v28 offset:16384
    v_add_u32 v29, 32768, v29
    v_mfma_f32_16x16x32_bf16 v[44:47], a[76:79], a[108:111], v[44:47]
    ds_read_b64_tr_b16 a[54:55], v28 offset:18432
    buffer_load_dwordx4 a[160:163], v1, s[24:27], s59 offen offset:0 sc1
    v_mfma_f32_16x16x32_bf16 v[48:51], a[24:27], a[104:107], v[48:51]
    ds_read_b64_tr_b16 a[0:1], v29 offset:0
    v_mfma_f32_16x16x32_bf16 v[52:55], a[24:27], a[108:111], v[52:55]
    ds_read_b64_tr_b16 a[2:3], v29 offset:2048
    buffer_load_dwordx2 v[156:157], v20, s[24:27], s93 offen offset:1536 sc1
    v_mfma_f32_16x16x32_bf16 v[56:59], a[28:31], a[104:107], v[56:59]
    ds_read_b64_tr_b16 a[4:5], v29 offset:16384
    v_add_u32 v30, 32768, v30
    v_mfma_f32_16x16x32_bf16 v[60:63], a[28:31], a[108:111], v[60:63]
    ds_read_b64_tr_b16 a[6:7], v29 offset:18432
    v_mfma_f32_16x16x32_bf16 v[64:67], a[32:35], a[104:107], v[64:67]
    ds_read_b64_tr_b16 a[8:9], v30 offset:0
    buffer_load_dwordx4 a[164:167], v1, s[24:27], s59 offen offset:1024 sc1
    v_mfma_f32_16x16x32_bf16 v[68:71], a[32:35], a[108:111], v[68:71]
    ds_read_b64_tr_b16 a[10:11], v30 offset:2048
    v_mfma_f32_16x16x32_bf16 v[72:75], a[36:39], a[104:107], v[72:75]
    ds_read_b64_tr_b16 a[12:13], v30 offset:16384
    v_add_u32 v31, 32768, v31
    v_mfma_f32_16x16x32_bf16 v[76:79], a[36:39], a[108:111], v[76:79]
    ds_read_b64_tr_b16 a[14:15], v30 offset:18432
    buffer_load_dwordx4 a[168:171], v1, s[24:27], s59 offen offset:2048 sc1
    v_mfma_f32_16x16x32_bf16 v[80:83], a[40:43], a[104:107], v[80:83]
    ds_read_b64_tr_b16 a[16:17], v31 offset:0
    v_mfma_f32_16x16x32_bf16 v[84:87], a[40:43], a[108:111], v[84:87]
    ds_read_b64_tr_b16 a[18:19], v31 offset:2048
    buffer_load_dwordx2 v[158:159], v20, s[24:27], s93 offen offset:1792 sc1
    v_mfma_f32_16x16x32_bf16 v[88:91], a[44:47], a[104:107], v[88:91]
    ds_read_b64_tr_b16 a[20:21], v31 offset:16384
    buffer_load_dwordx4 a[172:175], v1, s[24:27], s59 offen offset:3072 sc1
    v_mfma_f32_16x16x32_bf16 v[92:95], a[44:47], a[108:111], v[92:95]
    ds_read_b64_tr_b16 a[22:23], v31 offset:18432
    s_waitcnt vmcnt(21) lgkmcnt(8)
    v_mfma_f32_16x16x32_bf16 v[32:35], a[48:51], a[112:115], v[32:35]
    ds_read_b64_tr_b16 a[56:57], v28 offset:4096
    v_mfma_f32_16x16x32_bf16 v[36:39], a[48:51], a[116:119], v[36:39]
    ds_read_b64_tr_b16 a[58:59], v28 offset:6144
    s_add_u32 s59, s61, 49152
    v_mfma_f32_16x16x32_bf16 v[40:43], a[52:55], a[112:115], v[40:43]
    ds_read_b64_tr_b16 a[60:61], v28 offset:20480
    buffer_load_dwordx4 a[176:179], v1, s[24:27], s59 offen offset:0 sc1
    v_mfma_f32_16x16x32_bf16 v[44:47], a[52:55], a[116:119], v[44:47]
    ds_read_b64_tr_b16 a[62:63], v28 offset:22528
    v_mfma_f32_16x16x32_bf16 v[48:51], a[0:3], a[112:115], v[48:51]
    ds_read_b64_tr_b16 a[24:25], v29 offset:4096
    v_mfma_f32_16x16x32_bf16 v[52:55], a[0:3], a[116:119], v[52:55]
    ds_read_b64_tr_b16 a[26:27], v29 offset:6144
    v_mfma_f32_16x16x32_bf16 v[56:59], a[4:7], a[112:115], v[56:59]
    ds_read_b64_tr_b16 a[28:29], v29 offset:20480
    buffer_load_dwordx4 a[180:183], v1, s[24:27], s59 offen offset:1024 sc1
    v_mfma_f32_16x16x32_bf16 v[60:63], a[4:7], a[116:119], v[60:63]
    ds_read_b64_tr_b16 a[30:31], v29 offset:22528
    s_waitcnt lgkmcnt(8)
    v_mfma_f32_16x16x32_bf16 v[64:67], a[8:11], a[112:115], v[64:67]
    ds_read_b64_tr_b16 a[32:33], v30 offset:4096
    v_mfma_f32_16x16x32_bf16 v[68:71], a[8:11], a[116:119], v[68:71]
    ds_read_b64_tr_b16 a[34:35], v30 offset:6144
    v_mfma_f32_16x16x32_bf16 v[72:75], a[12:15], a[112:115], v[72:75]
    ds_read_b64_tr_b16 a[36:37], v30 offset:20480
    buffer_load_dwordx4 a[184:187], v1, s[24:27], s59 offen offset:2048 sc1
    v_mfma_f32_16x16x32_bf16 v[76:79], a[12:15], a[116:119], v[76:79]
    ds_read_b64_tr_b16 a[38:39], v30 offset:22528
    v_mfma_f32_16x16x32_bf16 v[80:83], a[16:19], a[112:115], v[80:83]
    ds_read_b64_tr_b16 a[40:41], v31 offset:4096
    v_mfma_f32_16x16x32_bf16 v[84:87], a[16:19], a[116:119], v[84:87]
    ds_read_b64_tr_b16 a[42:43], v31 offset:6144
    v_mfma_f32_16x16x32_bf16 v[88:91], a[20:23], a[112:115], v[88:91]
    ds_read_b64_tr_b16 a[44:45], v31 offset:20480
    buffer_load_dwordx4 a[188:191], v1, s[24:27], s59 offen offset:3072 sc1
    v_mfma_f32_16x16x32_bf16 v[92:95], a[20:23], a[116:119], v[92:95]
    ds_read_b64_tr_b16 a[46:47], v31 offset:22528
    s_waitcnt vmcnt(22) lgkmcnt(8)
    v_mfma_f32_16x16x32_bf16 v[32:35], a[56:59], a[120:123], v[32:35]
    ds_read_b64_tr_b16 a[64:65], v28 offset:8192
    v_mfma_f32_16x16x32_bf16 v[36:39], a[56:59], a[124:127], v[36:39]
    ds_read_b64_tr_b16 a[66:67], v28 offset:10240
    s_add_u32 s59, s61, 53248
    v_mfma_f32_16x16x32_bf16 v[40:43], a[60:63], a[120:123], v[40:43]
    ds_read_b64_tr_b16 a[68:69], v28 offset:24576
    buffer_load_dwordx4 a[192:195], v1, s[24:27], s59 offen offset:0 sc1
    v_mfma_f32_16x16x32_bf16 v[44:47], a[60:63], a[124:127], v[44:47]
    ds_read_b64_tr_b16 a[70:71], v28 offset:26624
    v_mfma_f32_16x16x32_bf16 v[48:51], a[24:27], a[120:123], v[48:51]
    ds_read_b64_tr_b16 a[0:1], v29 offset:8192
    v_mfma_f32_16x16x32_bf16 v[52:55], a[24:27], a[124:127], v[52:55]
    ds_read_b64_tr_b16 a[2:3], v29 offset:10240
    v_mfma_f32_16x16x32_bf16 v[56:59], a[28:31], a[120:123], v[56:59]
    ds_read_b64_tr_b16 a[4:5], v29 offset:24576
    buffer_load_dwordx4 a[196:199], v1, s[24:27], s59 offen offset:1024 sc1
    v_mfma_f32_16x16x32_bf16 v[60:63], a[28:31], a[124:127], v[60:63]
    ds_read_b64_tr_b16 a[6:7], v29 offset:26624
    s_waitcnt lgkmcnt(8)
    v_mfma_f32_16x16x32_bf16 v[64:67], a[32:35], a[120:123], v[64:67]
    ds_read_b64_tr_b16 a[8:9], v30 offset:8192
    v_mfma_f32_16x16x32_bf16 v[68:71], a[32:35], a[124:127], v[68:71]
    ds_read_b64_tr_b16 a[10:11], v30 offset:10240
    v_mfma_f32_16x16x32_bf16 v[72:75], a[36:39], a[120:123], v[72:75]
    ds_read_b64_tr_b16 a[12:13], v30 offset:24576
    buffer_load_dwordx4 a[200:203], v1, s[24:27], s59 offen offset:2048 sc1
    v_mfma_f32_16x16x32_bf16 v[76:79], a[36:39], a[124:127], v[76:79]
    ds_read_b64_tr_b16 a[14:15], v30 offset:26624
    v_mfma_f32_16x16x32_bf16 v[80:83], a[40:43], a[120:123], v[80:83]
    ds_read_b64_tr_b16 a[16:17], v31 offset:8192
    v_mfma_f32_16x16x32_bf16 v[84:87], a[40:43], a[124:127], v[84:87]
    ds_read_b64_tr_b16 a[18:19], v31 offset:10240
    v_mfma_f32_16x16x32_bf16 v[88:91], a[44:47], a[120:123], v[88:91]
    ds_read_b64_tr_b16 a[20:21], v31 offset:24576
    buffer_load_dwordx4 a[204:207], v1, s[24:27], s59 offen offset:3072 sc1
    v_mfma_f32_16x16x32_bf16 v[92:95], a[44:47], a[124:127], v[92:95]
    ds_read_b64_tr_b16 a[22:23], v31 offset:26624
    s_waitcnt vmcnt(23) lgkmcnt(8)
    v_mfma_f32_16x16x32_bf16 v[32:35], a[64:67], a[128:131], v[32:35]
    ds_read_b64_tr_b16 a[72:73], v28 offset:12288
    ds_read_b64_tr_b16 a[74:75], v28 offset:14336
    v_mfma_f32_16x16x32_bf16 v[36:39], a[64:67], a[132:135], v[36:39]
    ds_read_b64_tr_b16 a[76:77], v28 offset:28672
    ds_read_b64_tr_b16 a[78:79], v28 offset:30720
    v_mfma_f32_16x16x32_bf16 v[40:43], a[68:71], a[128:131], v[40:43]
    ds_read_b64_tr_b16 a[24:25], v29 offset:12288
    ds_read_b64_tr_b16 a[26:27], v29 offset:14336
    v_mfma_f32_16x16x32_bf16 v[44:47], a[68:71], a[132:135], v[44:47]
    ds_read_b64_tr_b16 a[28:29], v29 offset:28672
    ds_read_b64_tr_b16 a[30:31], v29 offset:30720
    v_mfma_f32_16x16x32_bf16 v[48:51], a[0:3], a[128:131], v[48:51]
    ds_read_b64_tr_b16 a[32:33], v30 offset:12288
    ds_read_b64_tr_b16 a[34:35], v30 offset:14336
    v_mfma_f32_16x16x32_bf16 v[52:55], a[0:3], a[132:135], v[52:55]
    ds_read_b64_tr_b16 a[36:37], v30 offset:28672
    ds_read_b64_tr_b16 a[38:39], v30 offset:30720
    v_mfma_f32_16x16x32_bf16 v[56:59], a[4:7], a[128:131], v[56:59]
    ds_read_b64_tr_b16 a[40:41], v31 offset:12288
    buffer_load_dwordx4 v[204:207], v1, s[24:27], s34 offen offset:0 sc1
    v_mfma_f32_16x16x32_bf16 v[60:63], a[4:7], a[132:135], v[60:63]
    ds_read_b64_tr_b16 a[42:43], v31 offset:14336
    s_waitcnt lgkmcnt(14)
    v_mfma_f32_16x16x32_bf16 v[64:67], a[8:11], a[128:131], v[64:67]
    ds_read_b64_tr_b16 a[44:45], v31 offset:28672
    buffer_load_dwordx4 v[212:215], v1, s[24:27], s34 offen offset:1024 sc1
    v_mfma_f32_16x16x32_bf16 v[68:71], a[8:11], a[132:135], v[68:71]
    ds_read_b64_tr_b16 a[46:47], v31 offset:30720
    s_add_u32 m0, s52, 0
    v_mfma_f32_16x16x32_bf16 v[72:75], a[12:15], a[128:131], v[72:75]
    s_add_u32 s60, s94, 12288
    buffer_load_dwordx4 v1, s[24:27], s60 offen offset:0 sc1 lds
    v_mfma_f32_16x16x32_bf16 v[76:79], a[12:15], a[132:135], v[76:79]
    s_waitcnt vmcnt(12)
    v_add_f32 v144, v144, v152
    v_mfma_f32_16x16x32_bf16 v[80:83], a[16:19], a[128:131], v[80:83]
    v_add_f32 v145, v145, v153
    v_add_f32 v146, v146, v154
    v_mfma_f32_16x16x32_bf16 v[84:87], a[16:19], a[132:135], v[84:87]
    v_add_f32 v147, v147, v155
    v_add_f32 v148, v148, v156
    v_mfma_f32_16x16x32_bf16 v[88:91], a[20:23], a[128:131], v[88:91]
    v_add_f32 v149, v149, v157
    v_add_f32 v150, v150, v158
    v_mfma_f32_16x16x32_bf16 v[92:95], a[20:23], a[132:135], v[92:95]
    v_add_f32 v151, v151, v159
    s_waitcnt lgkmcnt(0)
    s_barrier
    v_add_u32 v28, 32768, v28
    v_mfma_f32_16x16x32_bf16 v[32:35], a[72:75], a[136:139], v[32:35]
    ds_read_b64_tr_b16 a[48:49], v28 offset:0
    v_add_f32 v144, v144, v148
    v_mfma_f32_16x16x32_bf16 v[36:39], a[72:75], a[140:143], v[36:39]
    ds_read_b64_tr_b16 a[50:51], v28 offset:2048
    v_add_f32 v145, v145, v149
    v_mfma_f32_16x16x32_bf16 v[40:43], a[76:79], a[136:139], v[40:43]
    ds_read_b64_tr_b16 a[52:53], v28 offset:16384
    v_add_u32 v29, 32768, v29
    v_mfma_f32_16x16x32_bf16 v[44:47], a[76:79], a[140:143], v[44:47]
    ds_read_b64_tr_b16 a[54:55], v28 offset:18432
    buffer_load_dwordx4 v1, s[24:27], s60 offen offset:1024 sc1 lds
    v_mfma_f32_16x16x32_bf16 v[48:51], a[24:27], a[136:139], v[48:51]
    ds_read_b64_tr_b16 a[0:1], v29 offset:0
    v_add_f32 v146, v146, v150
    v_mfma_f32_16x16x32_bf16 v[52:55], a[24:27], a[140:143], v[52:55]
    ds_read_b64_tr_b16 a[2:3], v29 offset:2048
    v_add_f32 v147, v147, v151
    v_mfma_f32_16x16x32_bf16 v[56:59], a[28:31], a[136:139], v[56:59]
    ds_read_b64_tr_b16 a[4:5], v29 offset:16384
    v_add_u32 v30, 32768, v30
    v_mfma_f32_16x16x32_bf16 v[60:63], a[28:31], a[140:143], v[60:63]
    ds_read_b64_tr_b16 a[6:7], v29 offset:18432
    v_mfma_f32_16x16x32_bf16 v[64:67], a[32:35], a[136:139], v[64:67]
    ds_read_b64_tr_b16 a[8:9], v30 offset:0
    v_add_f32 v144, v144, v146
    v_mfma_f32_16x16x32_bf16 v[68:71], a[32:35], a[140:143], v[68:71]
    ds_read_b64_tr_b16 a[10:11], v30 offset:2048
    v_add_f32 v145, v145, v147
    v_mfma_f32_16x16x32_bf16 v[72:75], a[36:39], a[136:139], v[72:75]
    ds_read_b64_tr_b16 a[12:13], v30 offset:16384
    v_add_u32 v31, 32768, v31
    v_mfma_f32_16x16x32_bf16 v[76:79], a[36:39], a[140:143], v[76:79]
    ds_read_b64_tr_b16 a[14:15], v30 offset:18432
    buffer_load_dwordx4 v1, s[24:27], s60 offen offset:2048 sc1 lds
    v_mfma_f32_16x16x32_bf16 v[80:83], a[40:43], a[136:139], v[80:83]
    ds_read_b64_tr_b16 a[16:17], v31 offset:0
    v_cmp_u_f32 vcc, v144, v145
    s_cbranch_vccnz L_ssp_st1
L_sbk_st1:
    v_mfma_f32_16x16x32_bf16 v[84:87], a[40:43], a[140:143], v[84:87]
    ds_read_b64_tr_b16 a[18:19], v31 offset:2048
    v_mov_b32 v22, v144
    v_mfma_f32_16x16x32_bf16 v[88:91], a[44:47], a[136:139], v[88:91]
    ds_read_b64_tr_b16 a[20:21], v31 offset:16384
    v_mov_b32 v23, v145
    v_mfma_f32_16x16x32_bf16 v[92:95], a[44:47], a[140:143], v[92:95]
    ds_read_b64_tr_b16 a[22:23], v31 offset:18432
    s_waitcnt lgkmcnt(8)
    v_mfma_f32_16x16x32_bf16 v[32:35], a[48:51], a[144:147], v[32:35]
    ds_read_b64_tr_b16 a[56:57], v28 offset:4096
    s_nop 1
    v_mfma_f32_16x16x32_bf16 v[36:39], a[48:51], a[148:151], v[36:39]
    ds_read_b64_tr_b16 a[58:59], v28 offset:6144
    v_permlane32_swap_b32 v144, v22
    v_mfma_f32_16x16x32_bf16 v[40:43], a[52:55], a[144:147], v[40:43]
    ds_read_b64_tr_b16 a[60:61], v28 offset:20480
    buffer_load_dwordx4 v1, s[24:27], s60 offen offset:3072 sc1 lds
    v_mfma_f32_16x16x32_bf16 v[44:47], a[52:55], a[148:151], v[44:47]
    ds_read_b64_tr_b16 a[62:63], v28 offset:22528
    v_permlane32_swap_b32 v145, v23
    v_mfma_f32_16x16x32_bf16 v[48:51], a[0:3], a[144:147], v[48:51]
    ds_read_b64_tr_b16 a[24:25], v29 offset:4096
    v_add_f32 v144, v144, v22
    v_mfma_f32_16x16x32_bf16 v[52:55], a[0:3], a[148:151], v[52:55]
    ds_read_b64_tr_b16 a[26:27], v29 offset:6144
    v_add_f32 v145, v145, v23
    v_mfma_f32_16x16x32_bf16 v[56:59], a[4:7], a[144:147], v[56:59]
    ds_read_b64_tr_b16 a[28:29], v29 offset:20480
    v_mul_f32 v232, 0xbb000000, v144
    v_mfma_f32_16x16x32_bf16 v[60:63], a[4:7], a[148:151], v[60:63]
    ds_read_b64_tr_b16 a[30:31], v29 offset:22528
    s_waitcnt lgkmcnt(8)
    v_mfma_f32_16x16x32_bf16 v[64:67], a[8:11], a[144:147], v[64:67]
    ds_read_b64_tr_b16 a[32:33], v30 offset:4096
    s_add_u32 m0, s52, 4096
    v_mfma_f32_16x16x32_bf16 v[68:71], a[8:11], a[148:151], v[68:71]
    ds_read_b64_tr_b16 a[34:35], v30 offset:6144
    s_add_u32 s60, s94, 16384
    v_mfma_f32_16x16x32_bf16 v[72:75], a[12:15], a[144:147], v[72:75]
    ds_read_b64_tr_b16 a[36:37], v30 offset:20480
    buffer_load_dwordx4 v1, s[24:27], s60 offen offset:0 sc1 lds
    v_mfma_f32_16x16x32_bf16 v[76:79], a[12:15], a[148:151], v[76:79]
    ds_read_b64_tr_b16 a[38:39], v30 offset:22528
    v_mul_f32 v145, 0x3b000000, v145
    v_mfma_f32_16x16x32_bf16 v[80:83], a[16:19], a[144:147], v[80:83]
    ds_read_b64_tr_b16 a[40:41], v31 offset:4096
    v_fma_f32 v145, -v232, v232, v145
    v_mfma_f32_16x16x32_bf16 v[84:87], a[16:19], a[148:151], v[84:87]
    ds_read_b64_tr_b16 a[42:43], v31 offset:6144
    v_max_f32 v145, 0, v145
    v_mfma_f32_16x16x32_bf16 v[88:91], a[20:23], a[144:147], v[88:91]
    ds_read_b64_tr_b16 a[44:45], v31 offset:20480
    v_add_f32 v145, 0x3727c5ac, v145
    v_mfma_f32_16x16x32_bf16 v[92:95], a[20:23], a[148:151], v[92:95]
    ds_read_b64_tr_b16 a[46:47], v31 offset:22528
    s_waitcnt lgkmcnt(8)
    v_mfma_f32_16x16x32_bf16 v[32:35], a[56:59], a[152:155], v[32:35]
    ds_read_b64_tr_b16 a[64:65], v28 offset:8192
    v_rsq_f32 v240, v145
    v_mfma_f32_16x16x32_bf16 v[36:39], a[56:59], a[156:159], v[36:39]
    ds_read_b64_tr_b16 a[66:67], v28 offset:10240
    s_nop 0
    v_mfma_f32_16x16x32_bf16 v[40:43], a[60:63], a[152:155], v[40:43]
    ds_read_b64_tr_b16 a[68:69], v28 offset:24576
    buffer_load_dwordx4 v1, s[24:27], s60 offen offset:1024 sc1 lds
    v_mfma_f32_16x16x32_bf16 v[44:47], a[60:63], a[156:159], v[44:47]
    ds_read_b64_tr_b16 a[70:71], v28 offset:26624
    v_mul_f32 v242, v240, v240
    v_mfma_f32_16x16x32_bf16 v[48:51], a[24:27], a[152:155], v[48:51]
    ds_read_b64_tr_b16 a[0:1], v29 offset:8192
    v_mul_f32 v240, v240, v240
    v_mfma_f32_16x16x32_bf16 v[52:55], a[24:27], a[156:159], v[52:55]
    ds_read_b64_tr_b16 a[2:3], v29 offset:10240
    s_nop 1
    v_mfma_f32_16x16x32_bf16 v[56:59], a[28:31], a[152:155], v[56:59]
    ds_read_b64_tr_b16 a[4:5], v29 offset:24576
    v_permlane16_swap_b32 v242, v240
    v_mfma_f32_16x16x32_bf16 v[60:63], a[28:31], a[156:159], v[60:63]
    ds_read_b64_tr_b16 a[6:7], v29 offset:26624
    s_waitcnt lgkmcnt(8)
    v_mfma_f32_16x16x32_bf16 v[64:67], a[32:35], a[152:155], v[64:67]
    ds_read_b64_tr_b16 a[8:9], v30 offset:8192
    s_add_u32 m0, s52, 32768
    v_mfma_f32_16x16x32_bf16 v[68:71], a[32:35], a[156:159], v[68:71]
    ds_read_b64_tr_b16 a[10:11], v30 offset:10240
    s_add_u32 s60, s94, 24576
    v_mfma_f32_16x16x32_bf16 v[72:75], a[36:39], a[152:155], v[72:75]
    ds_read_b64_tr_b16 a[12:13], v30 offset:24576
    buffer_load_dwordx4 v1, s[24:27], s60 offen offset:0 sc1 lds
    v_mfma_f32_16x16x32_bf16 v[76:79], a[36:39], a[156:159], v[76:79]
    ds_read_b64_tr_b16 a[14:15], v30 offset:26624
    v_mfma_f32_16x16x32_bf16 v[80:83], a[40:43], a[152:155], v[80:83]
    ds_read_b64_tr_b16 a[16:17], v31 offset:8192
    v_mfma_f32_16x16x32_bf16 v[84:87], a[40:43], a[156:159], v[84:87]
    ds_read_b64_tr_b16 a[18:19], v31 offset:10240
    v_mfma_f32_16x16x32_bf16 v[88:91], a[44:47], a[152:155], v[88:91]
    ds_read_b64_tr_b16 a[20:21], v31 offset:24576
    v_mfma_f32_16x16x32_bf16 v[92:95], a[44:47], a[156:159], v[92:95]
    ds_read_b64_tr_b16 a[22:23], v31 offset:26624
    s_waitcnt lgkmcnt(8)
    v_mfma_f32_16x16x32_bf16 v[32:35], a[64:67], a[160:163], v[32:35]
    ds_read_b64_tr_b16 a[72:73], v28 offset:12288
    ds_read_b64_tr_b16 a[74:75], v28 offset:14336
    v_mfma_f32_16x16x32_bf16 v[36:39], a[64:67], a[164:167], v[36:39]
    ds_read_b64_tr_b16 a[76:77], v28 offset:28672
    ds_read_b64_tr_b16 a[78:79], v28 offset:30720
    v_mfma_f32_16x16x32_bf16 v[40:43], a[68:71], a[160:163], v[40:43]
    ds_read_b64_tr_b16 a[24:25], v29 offset:12288
    ds_read_b64_tr_b16 a[26:27], v29 offset:14336
    v_mfma_f32_16x16x32_bf16 v[44:47], a[68:71], a[164:167], v[44:47]
    ds_read_b64_tr_b16 a[28:29], v29 offset:28672
    ds_read_b64_tr_b16 a[30:31], v29 offset:30720
    v_mfma_f32_16x16x32_bf16 v[48:51], a[0:3], a[160:163], v[48:51]
    ds_read_b64_tr_b16 a[32:33], v30 offset:12288
    ds_read_b64_tr_b16 a[34:35], v30 offset:14336
    v_mfma_f32_16x16x32_bf16 v[52:55], a[0:3], a[164:167], v[52:55]
    ds_read_b64_tr_b16 a[36:37], v30 offset:28672
    ds_read_b64_tr_b16 a[38:39], v30 offset:30720
    v_mfma_f32_16x16x32_bf16 v[56:59], a[4:7], a[160:163], v[56:59]
    ds_read_b64_tr_b16 a[40:41], v31 offset:12288
    buffer_load_dwordx4 v1, s[24:27], s60 offen offset:1024 sc1 lds
    v_mfma_f32_16x16x32_bf16 v[60:63], a[4:7], a[164:167], v[60:63]
    ds_read_b64_tr_b16 a[42:43], v31 offset:14336
    s_waitcnt lgkmcnt(14)
    v_mfma_f32_16x16x32_bf16 v[64:67], a[8:11], a[160:163], v[64:67]
    ds_read_b64_tr_b16 a[44:45], v31 offset:28672
    v_mfma_f32_16x16x32_bf16 v[68:71], a[8:11], a[164:167], v[68:71]
    ds_read_b64_tr_b16 a[46:47], v31 offset:30720
    s_lshl_b32 s98, s0, 2
    s_add_u32 s98, s98, s1
    s_lshl_b32 s98, s98, 10
    v_lshlrev_b32 v24, 9, v0
    s_mov_b32 exec_lo, 0xff
    s_mov_b32 exec_hi, 0x0
    buffer_load_dword v255, v24, s[20:23], s98 offen offset:384
    s_mov_b64 exec, -1
    s_lshl_b32 s98, s0, 2
    s_add_u32 s98, s98, s1
    s_mul_i32 s98, s98, 768
    s_add_u32 s98, s98, 1048576
    s_mov_b32 exec_lo, 0x3f
    s_mov_b32 exec_hi, 0x0
    buffer_load_dword v255, v24, s[20:23], s98 offen offset:384
    s_mov_b64 exec, -1
    v_mfma_f32_16x16x32_bf16 v[72:75], a[12:15], a[160:163], v[72:75]
    buffer_load_dwordx4 v1, s[24:27], s60 offen offset:2048 sc1 lds
    v_mfma_f32_16x16x32_bf16 v[76:79], a[12:15], a[164:167], v[76:79]
    s_lshl_b32 s58, s36, 7
    s_add_u32 s58, s58, 160256
    v_mfma_f32_16x16x32_bf16 v[80:83], a[16:19], a[160:163], v[80:83]
    v_add_u32 v193, s58, v192
    v_xor_b32 v194, 128, v193
    v_mfma_f32_16x16x32_bf16 v[84:87], a[16:19], a[164:167], v[84:87]
    v_xor_b32 v195, 256, v193
    v_xor_b32 v196, 384, v193
    v_mfma_f32_16x16x32_bf16 v[88:91], a[20:23], a[160:163], v[88:91]
    s_mov_b32 exec_lo, 0x88888888
    s_mov_b32 exec_hi, 0x8888
    buffer_load_dword v255, v241, s[8:11], s3 offen offset:0
    s_mov_b64 exec, -1
    v_mfma_f32_16x16x32_bf16 v[92:95], a[20:23], a[164:167], v[92:95]
    s_waitcnt lgkmcnt(0)
    s_barrier
    v_add_u32 v28, 32768, v28
    s_waitcnt vmcnt(22)
    v_mfma_f32_16x16x32_bf16 v[32:35], a[72:75], a[168:171], v[32:35]
    ds_read_b64_tr_b16 a[48:49], v28 offset:0
    v_mov_b32 v160, -1
    v_mfma_f32_16x16x32_bf16 v[36:39], a[72:75], a[172:175], v[36:39]
    ds_read_b64_tr_b16 a[50:51], v28 offset:2048
    v_mov_b32 v161, -1
    v_mfma_f32_16x16x32_bf16 v[40:43], a[76:79], a[168:171], v[40:43]
    ds_read_b64_tr_b16 a[52:53], v28 offset:16384
    v_add_u32 v29, 32768, v29
    v_mfma_f32_16x16x32_bf16 v[44:47], a[76:79], a[172:175], v[44:47]
    ds_read_b64_tr_b16 a[54:55], v28 offset:18432
    buffer_load_dwordx4 v1, s[24:27], s60 offen offset:3072 sc1 lds
    v_mfma_f32_16x16x32_bf16 v[48:51], a[24:27], a[168:171], v[48:51]
    ds_read_b64_tr_b16 a[0:1], v29 offset:0
    v_mov_b32 v162, -1
    v_mfma_f32_16x16x32_bf16 v[52:55], a[24:27], a[172:175], v[52:55]
    ds_read_b64_tr_b16 a[2:3], v29 offset:2048
    v_mov_b32 v163, -1
    v_mfma_f32_16x16x32_bf16 v[56:59], a[28:31], a[168:171], v[56:59]
    ds_read_b64_tr_b16 a[4:5], v29 offset:16384
    v_add_u32 v30, 32768, v30
    v_mfma_f32_16x16x32_bf16 v[60:63], a[28:31], a[172:175], v[60:63]
    ds_read_b64_tr_b16 a[6:7], v29 offset:18432
    v_mfma_f32_16x16x32_bf16 v[64:67], a[32:35], a[168:171], v[64:67]
    ds_read_b64_tr_b16 a[8:9], v30 offset:0
    s_add_u32 m0, s52, 36864
    v_mfma_f32_16x16x32_bf16 v[68:71], a[32:35], a[172:175], v[68:71]
    ds_read_b64_tr_b16 a[10:11], v30 offset:2048
    s_add_u32 s60, s94, 28672
    v_mfma_f32_16x16x32_bf16 v[72:75], a[36:39], a[168:171], v[72:75]
    ds_read_b64_tr_b16 a[12:13], v30 offset:16384
    v_add_u32 v31, 32768, v31
    v_mfma_f32_16x16x32_bf16 v[76:79], a[36:39], a[172:175], v[76:79]
    ds_read_b64_tr_b16 a[14:15], v30 offset:18432
    buffer_load_dwordx4 v1, s[24:27], s60 offen offset:0 sc1 lds
    v_mfma_f32_16x16x32_bf16 v[80:83], a[40:43], a[168:171], v[80:83]
    ds_read_b64_tr_b16 a[16:17], v31 offset:0
    s_lshl_b32 s98, s36, 18
    v_mfma_f32_16x16x32_bf16 v[84:87], a[40:43], a[172:175], v[84:87]
    ds_read_b64_tr_b16 a[18:19], v31 offset:2048
    s_add_u32 s98, s98, s4
    v_mfma_f32_16x16x32_bf16 v[88:91], a[44:47], a[168:171], v[88:91]
    ds_read_b64_tr_b16 a[20:21], v31 offset:16384
    s_add_u32 s98, s98, s39
    v_mfma_f32_16x16x32_bf16 v[92:95], a[44:47], a[172:175], v[92:95]
    ds_read_b64_tr_b16 a[22:23], v31 offset:18432
    s_waitcnt vmcnt(22) lgkmcnt(8)
    v_mfma_f32_16x16x32_bf16 v[32:35], a[48:51], a[176:179], v[32:35]
    ds_read_b64_tr_b16 a[56:57], v28 offset:4096
    s_mul_i32 s99, s38, 3
    v_mfma_f32_16x16x32_bf16 v[36:39], a[48:51], a[180:183], v[36:39]
    ds_read_b64_tr_b16 a[58:59], v28 offset:6144
    s_and_b32 s35, s38, 8
    v_mfma_f32_16x16x32_bf16 v[40:43], a[52:55], a[176:179], v[40:43]
    ds_read_b64_tr_b16 a[60:61], v28 offset:20480
    buffer_load_dwordx4 v1, s[24:27], s60 offen offset:1024 sc1 lds
    v_mfma_f32_16x16x32_bf16 v[44:47], a[52:55], a[180:183], v[44:47]
    ds_read_b64_tr_b16 a[62:63], v28 offset:22528
    s_add_u32 s99, s99, s35
    v_mfma_f32_16x16x32_bf16 v[48:51], a[0:3], a[176:179], v[48:51]
    ds_read_b64_tr_b16 a[24:25], v29 offset:4096
    s_lshl_b32 s99, s99, 10
    v_mfma_f32_16x16x32_bf16 v[52:55], a[0:3], a[180:183], v[52:55]
    ds_read_b64_tr_b16 a[26:27], v29 offset:6144
    s_add_u32 s99, s99, 65536
    v_mfma_f32_16x16x32_bf16 v[56:59], a[4:7], a[176:179], v[56:59]
    ds_read_b64_tr_b16 a[28:29], v29 offset:20480
    s_and_b32 s35, s99, -8192
    v_mfma_f32_16x16x32_bf16 v[60:63], a[4:7], a[180:183], v[60:63]
    ds_read_b64_tr_b16 a[30:31], v29 offset:22528
    s_waitcnt lgkmcnt(8)
    v_mfma_f32_16x16x32_bf16 v[64:67], a[8:11], a[176:179], v[64:67]
    ds_read_b64_tr_b16 a[32:33], v30 offset:4096
    s_add_u32 m0, s52, 65536
    v_mfma_f32_16x16x32_bf16 v[68:71], a[8:11], a[180:183], v[68:71]
    ds_read_b64_tr_b16 a[34:35], v30 offset:6144
    s_add_u32 s60, s94, 36864
    v_mfma_f32_16x16x32_bf16 v[72:75], a[12:15], a[176:179], v[72:75]
    ds_read_b64_tr_b16 a[36:37], v30 offset:20480
    buffer_load_dwordx4 v1, s[24:27], s60 offen offset:0 sc1 lds
    v_mfma_f32_16x16x32_bf16 v[76:79], a[12:15], a[180:183], v[76:79]
    ds_read_b64_tr_b16 a[38:39], v30 offset:22528
    s_add_u32 s35, s35, s99
    v_mfma_f32_16x16x32_bf16 v[80:83], a[16:19], a[176:179], v[80:83]
    ds_read_b64_tr_b16 a[40:41], v31 offset:4096
    s_add_u32 s35, s35, s98
    v_mfma_f32_16x16x32_bf16 v[84:87], a[16:19], a[180:183], v[84:87]
    ds_read_b64_tr_b16 a[42:43], v31 offset:6144
    s_add_u32 s99, s99, 1024
    v_mfma_f32_16x16x32_bf16 v[88:91], a[20:23], a[176:179], v[88:91]
    ds_read_b64_tr_b16 a[44:45], v31 offset:20480
    buffer_store_dwordx4 v[160:163], v1, s[24:27], s35 offen sc1
    v_mfma_f32_16x16x32_bf16 v[92:95], a[20:23], a[180:183], v[92:95]
    ds_read_b64_tr_b16 a[46:47], v31 offset:22528
    s_waitcnt vmcnt(23) lgkmcnt(8)
    v_mfma_f32_16x16x32_bf16 v[32:35], a[56:59], a[184:187], v[32:35]
    ds_read_b64_tr_b16 a[64:65], v28 offset:8192
    s_and_b32 s35, s99, -8192
    v_mfma_f32_16x16x32_bf16 v[36:39], a[56:59], a[188:191], v[36:39]
    ds_read_b64_tr_b16 a[66:67], v28 offset:10240
    s_add_u32 s35, s35, s99
    v_mfma_f32_16x16x32_bf16 v[40:43], a[60:63], a[184:187], v[40:43]
    ds_read_b64_tr_b16 a[68:69], v28 offset:24576
    buffer_load_dwordx4 v1, s[24:27], s60 offen offset:1024 sc1 lds
    v_mfma_f32_16x16x32_bf16 v[44:47], a[60:63], a[188:191], v[44:47]
    ds_read_b64_tr_b16 a[70:71], v28 offset:26624
    s_add_u32 s35, s35, s98
    v_mfma_f32_16x16x32_bf16 v[48:51], a[24:27], a[184:187], v[48:51]
    ds_read_b64_tr_b16 a[0:1], v29 offset:8192
    s_add_u32 s99, s99, 1024
    v_mfma_f32_16x16x32_bf16 v[52:55], a[24:27], a[188:191], v[52:55]
    ds_read_b64_tr_b16 a[2:3], v29 offset:10240
    buffer_store_dwordx4 v[160:163], v1, s[24:27], s35 offen sc1
    v_mfma_f32_16x16x32_bf16 v[56:59], a[28:31], a[184:187], v[56:59]
    ds_read_b64_tr_b16 a[4:5], v29 offset:24576
    s_and_b32 s35, s99, -8192
    v_mfma_f32_16x16x32_bf16 v[60:63], a[28:31], a[188:191], v[60:63]
    ds_read_b64_tr_b16 a[6:7], v29 offset:26624
    s_waitcnt lgkmcnt(8)
    v_mfma_f32_16x16x32_bf16 v[64:67], a[32:35], a[184:187], v[64:67]
    ds_read_b64_tr_b16 a[8:9], v30 offset:8192
    s_add_u32 s35, s35, s99
    v_mfma_f32_16x16x32_bf16 v[68:71], a[32:35], a[188:191], v[68:71]
    ds_read_b64_tr_b16 a[10:11], v30 offset:10240
    s_add_u32 s35, s35, s98
    v_mfma_f32_16x16x32_bf16 v[72:75], a[36:39], a[184:187], v[72:75]
    ds_read_b64_tr_b16 a[12:13], v30 offset:24576
    buffer_load_dwordx4 v1, s[24:27], s60 offen offset:2048 sc1 lds
    v_mfma_f32_16x16x32_bf16 v[76:79], a[36:39], a[188:191], v[76:79]
    ds_read_b64_tr_b16 a[14:15], v30 offset:26624
    buffer_store_dwordx4 v[160:163], v1, s[24:27], s35 offen sc1
    v_mfma_f32_16x16x32_bf16 v[80:83], a[40:43], a[184:187], v[80:83]
    ds_read_b64_tr_b16 a[16:17], v31 offset:8192
    v_mfma_f32_16x16x32_bf16 v[84:87], a[40:43], a[188:191], v[84:87]
    ds_read_b64_tr_b16 a[18:19], v31 offset:10240
    v_mfma_f32_16x16x32_bf16 v[88:91], a[44:47], a[184:187], v[88:91]
    ds_read_b64_tr_b16 a[20:21], v31 offset:24576
    v_mfma_f32_16x16x32_bf16 v[92:95], a[44:47], a[188:191], v[92:95]
    ds_read_b64_tr_b16 a[22:23], v31 offset:26624
    s_waitcnt vmcnt(25) lgkmcnt(8)
    v_mfma_f32_16x16x32_bf16 v[32:35], a[64:67], a[192:195], v[32:35]
    ds_read_b64_tr_b16 a[72:73], v28 offset:12288
    ds_read_b64_tr_b16 a[74:75], v28 offset:14336
    v_mfma_f32_16x16x32_bf16 v[36:39], a[64:67], a[196:199], v[36:39]
    ds_read_b64_tr_b16 a[76:77], v28 offset:28672
    ds_read_b64_tr_b16 a[78:79], v28 offset:30720
    v_mfma_f32_16x16x32_bf16 v[40:43], a[68:71], a[192:195], v[40:43]
    ds_read_b64_tr_b16 a[24:25], v29 offset:12288
    ds_read_b64_tr_b16 a[26:27], v29 offset:14336
    v_mfma_f32_16x16x32_bf16 v[44:47], a[68:71], a[196:199], v[44:47]
    ds_read_b64_tr_b16 a[28:29], v29 offset:28672
    ds_read_b64_tr_b16 a[30:31], v29 offset:30720
    v_mfma_f32_16x16x32_bf16 v[48:51], a[0:3], a[192:195], v[48:51]
    ds_read_b64_tr_b16 a[32:33], v30 offset:12288
    ds_read_b64_tr_b16 a[34:35], v30 offset:14336
    v_mfma_f32_16x16x32_bf16 v[52:55], a[0:3], a[196:199], v[52:55]
    ds_read_b64_tr_b16 a[36:37], v30 offset:28672
    ds_read_b64_tr_b16 a[38:39], v30 offset:30720
    v_mfma_f32_16x16x32_bf16 v[56:59], a[4:7], a[192:195], v[56:59]
    ds_read_b64_tr_b16 a[40:41], v31 offset:12288
    buffer_load_dwordx4 v1, s[24:27], s60 offen offset:3072 sc1 lds
    v_mfma_f32_16x16x32_bf16 v[60:63], a[4:7], a[196:199], v[60:63]
    ds_read_b64_tr_b16 a[42:43], v31 offset:14336
    s_waitcnt lgkmcnt(14)
    v_mfma_f32_16x16x32_bf16 v[64:67], a[8:11], a[192:195], v[64:67]
    ds_read_b64_tr_b16 a[44:45], v31 offset:28672
    s_add_u32 m0, s52, 69632
    v_mfma_f32_16x16x32_bf16 v[68:71], a[8:11], a[196:199], v[68:71]
    ds_read_b64_tr_b16 a[46:47], v31 offset:30720
    s_add_u32 s60, s94, 40960
    v_mfma_f32_16x16x32_bf16 v[72:75], a[12:15], a[192:195], v[72:75]
    buffer_load_dwordx4 v1, s[24:27], s60 offen offset:0 sc1 lds
    v_mfma_f32_16x16x32_bf16 v[76:79], a[12:15], a[196:199], v[76:79]
    v_mfma_f32_16x16x32_bf16 v[80:83], a[16:19], a[192:195], v[80:83]
    v_mfma_f32_16x16x32_bf16 v[84:87], a[16:19], a[196:199], v[84:87]
    v_mfma_f32_16x16x32_bf16 v[88:91], a[20:23], a[192:195], v[88:91]
    v_mfma_f32_16x16x32_bf16 v[92:95], a[20:23], a[196:199], v[92:95]
    s_cmp_lg_u32 s40, 0
    s_cbranch_scc1 L_cs_25
    s_waitcnt lgkmcnt(0)
    v_mfma_f32_16x16x32_bf16 a[208:211], v[236:239], a[48:51], a[208:211]
    v_mfma_f32_16x16x32_bf16 a[212:215], v[236:239], a[52:55], a[212:215]
    v_mfma_f32_16x16x32_bf16 a[208:211], v[236:239], a[56:59], a[208:211]
    v_mfma_f32_16x16x32_bf16 a[212:215], v[236:239], a[60:63], a[212:215]
    v_mfma_f32_16x16x32_bf16 a[208:211], v[236:239], a[64:67], a[208:211]
    v_mfma_f32_16x16x32_bf16 a[212:215], v[236:239], a[68:71], a[212:215]
    v_mfma_f32_16x16x32_bf16 a[208:211], v[236:239], a[72:75], a[208:211]
    v_mfma_f32_16x16x32_bf16 a[212:215], v[236:239], a[76:79], a[212:215]
    s_nop 6
    v_accvgpr_read_b32 v184, a208
    v_accvgpr_read_b32 v185, a212
    v_cndmask_b32 v184, v184, v185, s[86:87]
    ds_write_b32 v193, v184
    s_waitcnt lgkmcnt(0)
L_cs_25:
    s_waitcnt lgkmcnt(0)
    s_barrier
    s_waitcnt vmcnt(25)
    v_mfma_f32_16x16x32_bf16 v[32:35], a[72:75], a[200:203], v[32:35]
    ds_read_b64_tr_b16 a[48:49], v188 offset:0
    v_mfma_f32_16x16x32_bf16 v[36:39], a[72:75], a[204:207], v[36:39]
    ds_read_b64_tr_b16 a[50:51], v188 offset:1536
    v_mfma_f32_16x16x32_bf16 v[40:43], a[76:79], a[200:203], v[40:43]
    buffer_load_dwordx4 v1, s[24:27], s60 offen offset:1024 sc1 lds
    v_mfma_f32_16x16x32_bf16 v[44:47], a[76:79], a[204:207], v[44:47]
    ds_read_b64_tr_b16 a[52:53], v188 offset:12416
    v_mfma_f32_16x16x32_bf16 v[48:51], a[24:27], a[200:203], v[48:51]
    ds_read_b64_tr_b16 a[54:55], v188 offset:13952
    v_mfma_f32_16x16x32_bf16 v[52:55], a[24:27], a[204:207], v[52:55]
    ds_read_b64_tr_b16 a[0:1], v189 offset:0
    v_mfma_f32_16x16x32_bf16 v[56:59], a[28:31], a[200:203], v[56:59]
    ds_read_b64_tr_b16 a[2:3], v189 offset:1536
    v_mfma_f32_16x16x32_bf16 v[60:63], a[28:31], a[204:207], v[60:63]
    ds_read_b64_tr_b16 a[4:5], v189 offset:12416
    v_mfma_f32_16x16x32_bf16 v[64:67], a[32:35], a[200:203], v[64:67]
    ds_read_b64_tr_b16 a[6:7], v189 offset:13952
    s_add_u32 m0, s33, 98304
    v_mfma_f32_16x16x32_bf16 v[68:71], a[32:35], a[204:207], v[68:71]
    ds_read_b64_tr_b16 a[8:9], v190 offset:0
    s_xor_b32 s60, s55, 393216
    v_mfma_f32_16x16x32_bf16 v[72:75], a[36:39], a[200:203], v[72:75]
    buffer_load_dwordx4 v12, s[20:23], s60 offen offset:0 lds
    v_mfma_f32_16x16x32_bf16 v[76:79], a[36:39], a[204:207], v[76:79]
    ds_read_b64_tr_b16 a[10:11], v190 offset:1536
    v_mfma_f32_16x16x32_bf16 v[80:83], a[40:43], a[200:203], v[80:83]
    ds_read_b64_tr_b16 a[12:13], v190 offset:12416
    s_cmp_eq_u32 s40, 0
    s_cselect_b64 exec, -1, 0
    ds_read_b32 a228, v193
    ds_read_b32 a229, v194
    ds_read_b32 a230, v195
    ds_read_b32 a231, v196
    s_mov_b64 exec, -1
    v_mfma_f32_16x16x32_bf16 v[84:87], a[40:43], a[204:207], v[84:87]
    ds_read_b64_tr_b16 a[14:15], v190 offset:13952
    v_mfma_f32_16x16x32_bf16 v[88:91], a[44:47], a[200:203], v[88:91]
    v_mfma_f32_16x16x32_bf16 v[92:95], a[44:47], a[204:207], v[92:95]
    s_waitcnt lgkmcnt(1)
    s_nop 3
    v_mfma_f32_16x16x1_4b_f32 v[32:47], a228, v232, v[32:47]
    v_mfma_f32_16x16x1_4b_f32 v[48:63], a229, v232, v[48:63]
    v_mfma_f32_16x16x1_4b_f32 v[64:79], a230, v232, v[64:79]
    v_mfma_f32_16x16x1_4b_f32 v[80:95], a231, v232, v[80:95]
    s_lshl_b32 s85, s36, 18
    s_add_u32 s85, s85, s4
    s_add_u32 s85, s85, s39
    s_mul_i32 s99, s38, 4
    s_add_u32 s58, s99, s36
    s_lshl_b32 s58, s58, 10
    s_and_b32 s98, s58, -8192
    s_add_u32 s58, s58, s85
    s_add_u32 s58, s58, s98
    v_max_f32 v32, 0, v32
    v_max_f32 v33, 0, v33
    v_max_f32 v34, 0, v34
    v_max_f32 v35, 0, v35
    v_max_f32 v36, 0, v36
    v_max_f32 v37, 0, v37
    v_max_f32 v38, 0, v38
    v_max_f32 v39, 0, v39
    v_pk_mul_f32 v[40:41], v[40:41], v[242:243] op_sel_hi:[1,0]
    v_pk_mul_f32 v[42:43], v[42:43], v[242:243] op_sel_hi:[1,0]
    v_pk_mul_f32 v[44:45], v[44:45], v[240:241] op_sel_hi:[1,0]
    v_pk_mul_f32 v[46:47], v[46:47], v[240:241] op_sel_hi:[1,0]
    v_pk_mul_f32 v[32:33], v[32:33], v[40:41]
    v_pk_mul_f32 v[34:35], v[34:35], v[42:43]
    v_pk_mul_f32 v[36:37], v[36:37], v[44:45]
    v_pk_mul_f32 v[38:39], v[38:39], v[46:47]
    v_cvt_pk_bf16_f32 v160, v32, v33
    v_cvt_pk_bf16_f32 v162, v36, v37
    v_cvt_pk_bf16_f32 v161, v34, v35
    v_cvt_pk_bf16_f32 v163, v38, v39
    v_max_f32 v48, 0, v48
    v_max_f32 v49, 0, v49
    v_permlane16_swap_b32 v160, v162
    v_max_f32 v50, 0, v50
    v_permlane16_swap_b32 v161, v163
    v_max_f32 v51, 0, v51
    buffer_store_dwordx4 v[160:163], v1, s[24:27], s58 offen sc1
    v_max_f32 v52, 0, v52
    v_max_f32 v53, 0, v53
    v_max_f32 v54, 0, v54
    v_max_f32 v55, 0, v55
    v_pk_mul_f32 v[56:57], v[56:57], v[242:243] op_sel_hi:[1,0]
    v_pk_mul_f32 v[58:59], v[58:59], v[242:243] op_sel_hi:[1,0]
    v_pk_mul_f32 v[60:61], v[60:61], v[240:241] op_sel_hi:[1,0]
    v_pk_mul_f32 v[62:63], v[62:63], v[240:241] op_sel_hi:[1,0]
    v_pk_mul_f32 v[48:49], v[48:49], v[56:57]
    v_pk_mul_f32 v[50:51], v[50:51], v[58:59]
    v_pk_mul_f32 v[52:53], v[52:53], v[60:61]
    v_pk_mul_f32 v[54:55], v[54:55], v[62:63]
    v_cvt_pk_bf16_f32 v164, v48, v49
    v_cvt_pk_bf16_f32 v166, v52, v53
    v_cvt_pk_bf16_f32 v165, v50, v51
    v_cvt_pk_bf16_f32 v167, v54, v55
    v_max_f32 v64, 0, v64
    v_max_f32 v65, 0, v65
    s_xor_b32 s58, s58, 1024
    v_max_f32 v66, 0, v66
    v_permlane16_swap_b32 v164, v166
    v_max_f32 v67, 0, v67
    v_permlane16_swap_b32 v165, v167
    v_max_f32 v68, 0, v68
    buffer_store_dwordx4 v[164:167], v1, s[24:27], s58 offen sc1
    v_max_f32 v69, 0, v69
    v_max_f32 v70, 0, v70
    v_max_f32 v71, 0, v71
    v_pk_mul_f32 v[72:73], v[72:73], v[242:243] op_sel_hi:[1,0]
    v_pk_mul_f32 v[74:75], v[74:75], v[242:243] op_sel_hi:[1,0]
    v_pk_mul_f32 v[76:77], v[76:77], v[240:241] op_sel_hi:[1,0]
    v_pk_mul_f32 v[78:79], v[78:79], v[240:241] op_sel_hi:[1,0]
    v_pk_mul_f32 v[64:65], v[64:65], v[72:73]
    v_pk_mul_f32 v[66:67], v[66:67], v[74:75]
    v_pk_mul_f32 v[68:69], v[68:69], v[76:77]
    v_pk_mul_f32 v[70:71], v[70:71], v[78:79]
    v_cvt_pk_bf16_f32 v168, v64, v65
    v_cvt_pk_bf16_f32 v170, v68, v69
    v_cvt_pk_bf16_f32 v169, v66, v67
    v_cvt_pk_bf16_f32 v171, v70, v71
    v_max_f32 v80, 0, v80
    v_max_f32 v81, 0, v81
    s_xor_b32 s58, s58, 3072
    v_max_f32 v82, 0, v82
    v_permlane16_swap_b32 v168, v170
    v_max_f32 v83, 0, v83
    v_permlane16_swap_b32 v169, v171
    v_max_f32 v84, 0, v84
    buffer_store_dwordx4 v[168:171], v1, s[24:27], s58 offen sc1
    v_max_f32 v85, 0, v85
    v_max_f32 v86, 0, v86
    v_max_f32 v87, 0, v87
    v_pk_mul_f32 v[88:89], v[88:89], v[242:243] op_sel_hi:[1,0]
    v_pk_mul_f32 v[90:91], v[90:91], v[242:243] op_sel_hi:[1,0]
    v_pk_mul_f32 v[92:93], v[92:93], v[240:241] op_sel_hi:[1,0]
    v_pk_mul_f32 v[94:95], v[94:95], v[240:241] op_sel_hi:[1,0]
    v_pk_mul_f32 v[80:81], v[80:81], v[88:89]
    v_pk_mul_f32 v[82:83], v[82:83], v[90:91]
    v_pk_mul_f32 v[84:85], v[84:85], v[92:93]
    v_pk_mul_f32 v[86:87], v[86:87], v[94:95]
    v_cvt_pk_bf16_f32 v172, v80, v81
    v_cvt_pk_bf16_f32 v174, v84, v85
    v_cvt_pk_bf16_f32 v173, v82, v83
    v_cvt_pk_bf16_f32 v175, v86, v87
    s_nop 1
    s_xor_b32 s58, s58, 1024
    v_permlane16_swap_b32 v172, v174
    v_permlane16_swap_b32 v173, v175
    buffer_store_dwordx4 v[172:175], v1, s[24:27], s58 offen sc1
    v_mfma_f32_16x16x32_bf16 v[96:99], a[48:51], a[80:83], 0
    ds_read_b64_tr_b16 a[56:57], v188 offset:3072
    buffer_load_dwordx4 v14, s[20:23], s60 offen offset:1024 lds
    v_mfma_f32_16x16x32_bf16 v[100:103], a[48:51], a[84:87], 0
    ds_read_b64_tr_b16 a[58:59], v188 offset:4608
    s_lshl_b32 s93, s36, 18
    v_mfma_f32_16x16x32_bf16 v[104:107], a[52:55], a[80:83], 0
    ds_read_b64_tr_b16 a[60:61], v188 offset:15488
    s_add_u32 s93, s93, s4
    v_mfma_f32_16x16x32_bf16 v[108:111], a[52:55], a[84:87], 0
    ds_read_b64_tr_b16 a[62:63], v188 offset:17024
    s_add_u32 s93, s93, s39
    v_mfma_f32_16x16x32_bf16 v[112:115], a[0:3], a[80:83], 0
    ds_read_b64_tr_b16 a[24:25], v189 offset:3072
    s_and_b32 s35, s6, 1
    v_mfma_f32_16x16x32_bf16 v[116:119], a[0:3], a[84:87], 0
    ds_read_b64_tr_b16 a[26:27], v189 offset:4608
    s_waitcnt lgkmcnt(6)
    v_mfma_f32_16x16x32_bf16 v[120:123], a[4:7], a[80:83], 0
    ds_read_b64_tr_b16 a[28:29], v189 offset:15488
    buffer_load_dwordx4 v15, s[20:23], s60 offen offset:2048 lds
    v_mfma_f32_16x16x32_bf16 v[124:127], a[4:7], a[84:87], 0
    ds_read_b64_tr_b16 a[30:31], v189 offset:17024
    s_lshl_b32 s35, s35, 16
    v_mfma_f32_16x16x32_bf16 v[128:131], a[8:11], a[80:83], 0
    ds_read_b64_tr_b16 a[32:33], v190 offset:3072
    s_add_u32 s93, s93, s35
    v_mfma_f32_16x16x32_bf16 v[132:135], a[8:11], a[84:87], 0
    ds_read_b64_tr_b16 a[34:35], v190 offset:4608
    s_and_b32 s35, s6, 2
    v_mfma_f32_16x16x32_bf16 v[136:139], a[12:15], a[80:83], 0
    ds_read_b64_tr_b16 a[36:37], v190 offset:15488
    s_lshl_b32 s35, s35, 11
    v_mfma_f32_16x16x32_bf16 v[140:143], a[12:15], a[84:87], 0
    ds_read_b64_tr_b16 a[38:39], v190 offset:17024
    s_waitcnt lgkmcnt(6)
    v_mfma_f32_16x16x32_bf16 v[96:99], a[56:59], a[88:91], v[96:99]
    ds_read_b64_tr_b16 a[64:65], v188 offset:6144
    buffer_load_dwordx4 v228, s[20:23], s60 offen offset:3072 lds
    v_mfma_f32_16x16x32_bf16 v[100:103], a[56:59], a[92:95], v[100:103]
    ds_read_b64_tr_b16 a[66:67], v188 offset:7680
    s_add_u32 s93, s93, s35
    v_mfma_f32_16x16x32_bf16 v[104:107], a[60:63], a[88:91], v[104:107]
    ds_read_b64_tr_b16 a[68:69], v188 offset:18560
    s_add_u32 m0, s33, 114688
    v_mfma_f32_16x16x32_bf16 v[108:111], a[60:63], a[92:95], v[108:111]
    ds_read_b64_tr_b16 a[70:71], v188 offset:20096
    s_bfe_u32 s60, s89, 0x2000e
    v_mfma_f32_16x16x32_bf16 v[112:115], a[24:27], a[88:91], v[112:115]
    ds_read_b64_tr_b16 a[0:1], v189 offset:6144
    s_lshl_b32 s60, s60, 17
    v_mfma_f32_16x16x32_bf16 v[116:119], a[24:27], a[92:95], v[116:119]
    ds_read_b64_tr_b16 a[2:3], v189 offset:7680
    s_waitcnt lgkmcnt(6)
    v_mfma_f32_16x16x32_bf16 v[120:123], a[28:31], a[88:91], v[120:123]
    ds_read_b64_tr_b16 a[4:5], v189 offset:18560
    s_add_u32 s60, s60, s97
    v_mfma_f32_16x16x32_bf16 v[124:127], a[28:31], a[92:95], v[124:127]
    ds_read_b64_tr_b16 a[6:7], v189 offset:20096
    buffer_load_dwordx4 v12, s[20:23], s60 offen offset:0 lds
    v_mfma_f32_16x16x32_bf16 v[128:131], a[32:35], a[88:91], v[128:131]
    ds_read_b64_tr_b16 a[8:9], v190 offset:6144
    s_and_b32 s35, s6, 12
    v_mfma_f32_16x16x32_bf16 v[132:135], a[32:35], a[92:95], v[132:135]
    ds_read_b64_tr_b16 a[10:11], v190 offset:7680
    s_lshl_b32 s35, s35, 12
    v_mfma_f32_16x16x32_bf16 v[136:139], a[36:39], a[88:91], v[136:139]
    ds_read_b64_tr_b16 a[12:13], v190 offset:18560
    s_add_u32 s93, s93, s35
    v_mfma_f32_16x16x32_bf16 v[140:143], a[36:39], a[92:95], v[140:143]
    ds_read_b64_tr_b16 a[14:15], v190 offset:20096
    s_waitcnt lgkmcnt(6)
    v_mfma_f32_16x16x32_bf16 v[96:99], a[64:67], a[96:99], v[96:99]
    ds_read_b64_tr_b16 a[72:73], v188 offset:9216
    ds_read_b64_tr_b16 a[74:75], v188 offset:10752
    v_mfma_f32_16x16x32_bf16 v[100:103], a[64:67], a[100:103], v[100:103]
    ds_read_b64_tr_b16 a[76:77], v188 offset:21632
    ds_read_b64_tr_b16 a[78:79], v188 offset:23168
    s_add_u32 s44, s42, s41
    v_mfma_f32_16x16x32_bf16 v[104:107], a[68:71], a[96:99], v[104:107]
    ds_read_b64_tr_b16 a[24:25], v189 offset:9216
    ds_read_b64_tr_b16 a[26:27], v189 offset:10752
    s_mov_b32 s45, s43
    v_mfma_f32_16x16x32_bf16 v[108:111], a[68:71], a[100:103], v[108:111]
    ds_read_b64_tr_b16 a[28:29], v189 offset:21632
    ds_read_b64_tr_b16 a[30:31], v189 offset:23168
    s_add_u32 s44, s44, 4
    v_mfma_f32_16x16x32_bf16 v[112:115], a[0:3], a[96:99], v[112:115]
    ds_read_b64_tr_b16 a[32:33], v190 offset:9216
    ds_read_b64_tr_b16 a[34:35], v190 offset:10752
    v_mov_b32 v19, s45
    v_mfma_f32_16x16x32_bf16 v[116:119], a[0:3], a[100:103], v[116:119]
    ds_read_b64_tr_b16 a[36:37], v190 offset:21632
    ds_read_b64_tr_b16 a[38:39], v190 offset:23168
    v_mov_b32 v18, s44
    s_waitcnt lgkmcnt(12)
    v_mfma_f32_16x16x32_bf16 v[120:123], a[4:7], a[96:99], v[120:123]
    buffer_load_dwordx4 v14, s[20:23], s60 offen offset:1024 lds
    v_mfma_f32_16x16x32_bf16 v[124:127], a[4:7], a[100:103], v[124:127]
    s_waitcnt vmcnt(5)
    buffer_load_dwordx4 v15, s[20:23], s60 offen offset:2048 lds
    v_mfma_f32_16x16x32_bf16 v[128:131], a[8:11], a[96:99], v[128:131]
    v_add_u32 v192, 94720, v192
    s_bfe_u32 s58, s92, 0x20000
    v_mfma_f32_16x16x32_bf16 v[132:135], a[8:11], a[100:103], v[132:135]
    s_mov_b64 exec, 1
    buffer_store_dwordx2 v[18:19], off, s[24:27], s5 sc1
    s_mov_b64 exec, -1
    v_mfma_f32_16x16x32_bf16 v[136:139], a[12:15], a[96:99], v[136:139]
    s_lshl_b32 s58, s58, 7
    v_add_u32 v193, s58, v192
    v_mfma_f32_16x16x32_bf16 v[140:143], a[12:15], a[100:103], v[140:143]
    s_bfe_u32 s58, s92, 0x20002
    s_cmp_lg_u32 s40, 0
    s_cbranch_scc1 L_cs_27
    s_waitcnt lgkmcnt(0)
    v_mfma_f32_16x16x32_bf16 a[208:211], v[236:239], a[48:51], 0
    v_mfma_f32_16x16x32_bf16 a[212:215], v[236:239], a[52:55], 0
    v_mfma_f32_16x16x32_bf16 a[208:211], v[236:239], a[56:59], a[208:211]
    v_mfma_f32_16x16x32_bf16 a[212:215], v[236:239], a[60:63], a[212:215]
    v_mfma_f32_16x16x32_bf16 a[208:211], v[236:239], a[64:67], a[208:211]
    v_mfma_f32_16x16x32_bf16 a[212:215], v[236:239], a[68:71], a[212:215]
    v_mfma_f32_16x16x32_bf16 a[208:211], v[236:239], a[72:75], a[208:211]
    v_mfma_f32_16x16x32_bf16 a[212:215], v[236:239], a[76:79], a[212:215]
L_cs_27:
    s_waitcnt lgkmcnt(0)
    s_barrier
    v_add_u32 v188, 4294836224, v188
    v_mfma_f32_16x16x32_bf16 v[96:99], a[72:75], a[104:107], v[96:99]
    ds_read_b64_tr_b16 a[48:49], v188 offset:0
    buffer_load_dwordx4 v228, s[20:23], s60 offen offset:3072 lds
    v_mfma_f32_16x16x32_bf16 v[100:103], a[72:75], a[108:111], v[100:103]
    ds_read_b64_tr_b16 a[50:51], v188 offset:1536
    s_lshl_b32 s58, s58, 7
    v_mfma_f32_16x16x32_bf16 v[104:107], a[76:79], a[104:107], v[104:107]
    ds_read_b64_tr_b16 a[52:53], v188 offset:12416
    v_add_u32 v189, 4294836224, v189
    v_mfma_f32_16x16x32_bf16 v[108:111], a[76:79], a[108:111], v[108:111]
    ds_read_b64_tr_b16 a[54:55], v188 offset:13952
    s_add_u32 m0, s33, 131072
    v_mfma_f32_16x16x32_bf16 v[112:115], a[24:27], a[104:107], v[112:115]
    ds_read_b64_tr_b16 a[0:1], v189 offset:0
    s_bfe_u32 s60, s81, 0x2000e
    v_mfma_f32_16x16x32_bf16 v[116:119], a[24:27], a[108:111], v[116:119]
    ds_read_b64_tr_b16 a[2:3], v189 offset:1536
    v_mfma_f32_16x16x32_bf16 v[120:123], a[28:31], a[104:107], v[120:123]
    ds_read_b64_tr_b16 a[4:5], v189 offset:12416
    v_add_u32 v190, 4294836224, v190
    v_mfma_f32_16x16x32_bf16 v[124:127], a[28:31], a[108:111], v[124:127]
    ds_read_b64_tr_b16 a[6:7], v189 offset:13952
    s_lshl_b32 s60, s60, 17
    v_mfma_f32_16x16x32_bf16 v[128:131], a[32:35], a[104:107], v[128:131]
    ds_read_b64_tr_b16 a[8:9], v190 offset:0
    s_add_u32 s60, s60, s97
    v_mfma_f32_16x16x32_bf16 v[132:135], a[32:35], a[108:111], v[132:135]
    ds_read_b64_tr_b16 a[10:11], v190 offset:1536
    buffer_load_dwordx4 v12, s[20:23], s60 offen offset:0 lds
    v_mfma_f32_16x16x32_bf16 v[136:139], a[36:39], a[104:107], v[136:139]
    ds_read_b64_tr_b16 a[12:13], v190 offset:12416
    v_add_u32 v194, s58, v192
    v_mfma_f32_16x16x32_bf16 v[140:143], a[36:39], a[108:111], v[140:143]
    ds_read_b64_tr_b16 a[14:15], v190 offset:13952
    s_waitcnt lgkmcnt(6)
    v_mfma_f32_16x16x32_bf16 v[96:99], a[48:51], a[112:115], v[96:99]
    ds_read_b64_tr_b16 a[56:57], v188 offset:3072
    buffer_load_dwordx4 v14, s[20:23], s60 offen offset:1024 lds
    v_mfma_f32_16x16x32_bf16 v[100:103], a[48:51], a[116:119], v[100:103]
    ds_read_b64_tr_b16 a[58:59], v188 offset:4608
    s_bfe_u32 s58, s92, 0x20004
    v_mfma_f32_16x16x32_bf16 v[104:107], a[52:55], a[112:115], v[104:107]
    ds_read_b64_tr_b16 a[60:61], v188 offset:15488
    s_lshl_b32 s58, s58, 7
    v_mfma_f32_16x16x32_bf16 v[108:111], a[52:55], a[116:119], v[108:111]
    ds_read_b64_tr_b16 a[62:63], v188 offset:17024
    v_add_u32 v195, s58, v192
    v_mfma_f32_16x16x32_bf16 v[112:115], a[0:3], a[112:115], v[112:115]
    ds_read_b64_tr_b16 a[24:25], v189 offset:3072
    v_bfe_u32 v21, v0, 2, 2
    v_mfma_f32_16x16x32_bf16 v[116:119], a[0:3], a[116:119], v[116:119]
    ds_read_b64_tr_b16 a[26:27], v189 offset:4608
    s_waitcnt lgkmcnt(6)
    v_mfma_f32_16x16x32_bf16 v[120:123], a[4:7], a[112:115], v[120:123]
    ds_read_b64_tr_b16 a[28:29], v189 offset:15488
    buffer_load_dwordx4 v15, s[20:23], s60 offen offset:2048 lds
    v_mfma_f32_16x16x32_bf16 v[124:127], a[4:7], a[116:119], v[124:127]
    ds_read_b64_tr_b16 a[30:31], v189 offset:17024
    v_lshrrev_b32 v22, 4, v0
    v_mfma_f32_16x16x32_bf16 v[128:131], a[8:11], a[112:115], v[128:131]
    ds_read_b64_tr_b16 a[32:33], v190 offset:3072
    v_lshl_add_u32 v21, v22, 3, v21
    v_mfma_f32_16x16x32_bf16 v[132:135], a[8:11], a[116:119], v[132:135]
    ds_read_b64_tr_b16 a[34:35], v190 offset:4608
    v_and_b32 v22, 24, v0
    v_mfma_f32_16x16x32_bf16 v[136:139], a[12:15], a[112:115], v[136:139]
    ds_read_b64_tr_b16 a[36:37], v190 offset:15488
    v_lshlrev_b32 v22, 2, v22
    v_mfma_f32_16x16x32_bf16 v[140:143], a[12:15], a[116:119], v[140:143]
    ds_read_b64_tr_b16 a[38:39], v190 offset:17024
    s_waitcnt lgkmcnt(6)
    v_mfma_f32_16x16x32_bf16 v[96:99], a[56:59], a[120:123], v[96:99]
    ds_read_b64_tr_b16 a[64:65], v188 offset:6144
    buffer_load_dwordx4 v228, s[20:23], s60 offen offset:3072 lds
    v_mfma_f32_16x16x32_bf16 v[100:103], a[56:59], a[124:127], v[100:103]
    ds_read_b64_tr_b16 a[66:67], v188 offset:7680
    v_and_b32 v23, 3, v0
    v_mfma_f32_16x16x32_bf16 v[104:107], a[60:63], a[120:123], v[104:107]
    ds_read_b64_tr_b16 a[68:69], v188 offset:18560
    s_add_u32 m0, s33, 147456
    v_mfma_f32_16x16x32_bf16 v[108:111], a[60:63], a[124:127], v[108:111]
    ds_read_b64_tr_b16 a[70:71], v188 offset:20096
    s_bfe_u32 s60, s82, 0x2000e
    v_mfma_f32_16x16x32_bf16 v[112:115], a[24:27], a[120:123], v[112:115]
    ds_read_b64_tr_b16 a[0:1], v189 offset:6144
    s_lshl_b32 s60, s60, 17
    v_mfma_f32_16x16x32_bf16 v[116:119], a[24:27], a[124:127], v[116:119]
    ds_read_b64_tr_b16 a[2:3], v189 offset:7680
    s_waitcnt lgkmcnt(6)
    v_mfma_f32_16x16x32_bf16 v[120:123], a[28:31], a[120:123], v[120:123]
    ds_read_b64_tr_b16 a[4:5], v189 offset:18560
    s_add_u32 s60, s60, s97
    v_mfma_f32_16x16x32_bf16 v[124:127], a[28:31], a[124:127], v[124:127]
    ds_read_b64_tr_b16 a[6:7], v189 offset:20096
    buffer_load_dwordx4 v12, s[20:23], s60 offen offset:0 lds
    v_mfma_f32_16x16x32_bf16 v[128:131], a[32:35], a[120:123], v[128:131]
    ds_read_b64_tr_b16 a[8:9], v190 offset:6144
    v_lshl_add_u32 v22, v23, 3, v22
    v_mfma_f32_16x16x32_bf16 v[132:135], a[32:35], a[124:127], v[132:135]
    ds_read_b64_tr_b16 a[10:11], v190 offset:7680
    s_lshl_b32 s58, s6, 6
    v_mfma_f32_16x16x32_bf16 v[136:139], a[36:39], a[120:123], v[136:139]
    ds_read_b64_tr_b16 a[12:13], v190 offset:18560
    s_and_b32 s58, s58, 64
    v_mfma_f32_16x16x32_bf16 v[140:143], a[36:39], a[124:127], v[140:143]
    ds_read_b64_tr_b16 a[14:15], v190 offset:20096
    s_waitcnt lgkmcnt(6)
    v_mfma_f32_16x16x32_bf16 v[96:99], a[64:67], a[128:131], v[96:99]
    ds_read_b64_tr_b16 a[72:73], v188 offset:9216
    ds_read_b64_tr_b16 a[74:75], v188 offset:10752
    v_mfma_f32_16x16x32_bf16 v[100:103], a[64:67], a[132:135], v[100:103]
    ds_read_b64_tr_b16 a[76:77], v188 offset:21632
    ds_read_b64_tr_b16 a[78:79], v188 offset:23168
    v_mfma_f32_16x16x32_bf16 v[104:107], a[68:71], a[128:131], v[104:107]
    ds_read_b64_tr_b16 a[24:25], v189 offset:9216
    ds_read_b64_tr_b16 a[26:27], v189 offset:10752
    v_mfma_f32_16x16x32_bf16 v[108:111], a[68:71], a[132:135], v[108:111]
    ds_read_b64_tr_b16 a[28:29], v189 offset:21632
    ds_read_b64_tr_b16 a[30:31], v189 offset:23168
    v_mfma_f32_16x16x32_bf16 v[112:115], a[0:3], a[128:131], v[112:115]
    ds_read_b64_tr_b16 a[32:33], v190 offset:9216
    ds_read_b64_tr_b16 a[34:35], v190 offset:10752
    v_mfma_f32_16x16x32_bf16 v[116:119], a[0:3], a[132:135], v[116:119]
    ds_read_b64_tr_b16 a[36:37], v190 offset:21632
    ds_read_b64_tr_b16 a[38:39], v190 offset:23168
    s_waitcnt lgkmcnt(12)
    v_mfma_f32_16x16x32_bf16 v[120:123], a[4:7], a[128:131], v[120:123]
    buffer_load_dwordx4 v14, s[20:23], s60 offen offset:1024 lds
    v_mfma_f32_16x16x32_bf16 v[124:127], a[4:7], a[132:135], v[124:127]
    buffer_load_dwordx4 v15, s[20:23], s60 offen offset:2048 lds
    v_mfma_f32_16x16x32_bf16 v[128:131], a[8:11], a[128:131], v[128:131]
    v_xor_b32 v22, s58, v22
    v_lshl_add_u32 v28, v21, 7, v22
    v_mfma_f32_16x16x32_bf16 v[132:135], a[8:11], a[132:135], v[132:135]
    v_xor_b32 v29, 32, v28
    v_xor_b32 v30, 64, v28
    v_mfma_f32_16x16x32_bf16 v[136:139], a[12:15], a[128:131], v[136:139]
    v_xor_b32 v31, 96, v28
    v_add_u32 v216, 98304, v28
    v_mfma_f32_16x16x32_bf16 v[140:143], a[12:15], a[132:135], v[140:143]
    v_add_u32 v217, 98304, v29
    s_cmp_lg_u32 s40, 0
    s_cbranch_scc1 L_cs_29
    s_waitcnt lgkmcnt(0)
    v_mfma_f32_16x16x32_bf16 a[208:211], v[236:239], a[48:51], a[208:211]
    v_mfma_f32_16x16x32_bf16 a[212:215], v[236:239], a[52:55], a[212:215]
    v_mfma_f32_16x16x32_bf16 a[208:211], v[236:239], a[56:59], a[208:211]
    v_mfma_f32_16x16x32_bf16 a[212:215], v[236:239], a[60:63], a[212:215]
    v_mfma_f32_16x16x32_bf16 a[208:211], v[236:239], a[64:67], a[208:211]
    v_mfma_f32_16x16x32_bf16 a[212:215], v[236:239], a[68:71], a[212:215]
    v_mfma_f32_16x16x32_bf16 a[208:211], v[236:239], a[72:75], a[208:211]
    v_mfma_f32_16x16x32_bf16 a[212:215], v[236:239], a[76:79], a[212:215]
L_cs_29:
    s_waitcnt lgkmcnt(0)
    s_barrier
    v_add_u32 v188, 32768, v188
    v_mfma_f32_16x16x32_bf16 v[96:99], a[72:75], a[136:139], v[96:99]
    ds_read_b64_tr_b16 a[48:49], v188 offset:0
    buffer_load_dwordx4 v228, s[20:23], s60 offen offset:3072 lds
    v_mfma_f32_16x16x32_bf16 v[100:103], a[72:75], a[140:143], v[100:103]
    ds_read_b64_tr_b16 a[50:51], v188 offset:1536
    v_add_u32 v218, 98304, v30
    v_mfma_f32_16x16x32_bf16 v[104:107], a[76:79], a[136:139], v[104:107]
    ds_read_b64_tr_b16 a[52:53], v188 offset:12416
    v_add_u32 v189, 32768, v189
    v_mfma_f32_16x16x32_bf16 v[108:111], a[76:79], a[140:143], v[108:111]
    ds_read_b64_tr_b16 a[54:55], v188 offset:13952
    v_add_u32 v219, 98304, v31
    v_mfma_f32_16x16x32_bf16 v[112:115], a[24:27], a[136:139], v[112:115]
    ds_read_b64_tr_b16 a[0:1], v189 offset:0
    s_add_u32 m0, s33, 0
    v_mfma_f32_16x16x32_bf16 v[116:119], a[24:27], a[140:143], v[116:119]
    ds_read_b64_tr_b16 a[2:3], v189 offset:1536
    v_mfma_f32_16x16x32_bf16 v[120:123], a[28:31], a[136:139], v[120:123]
    ds_read_b64_tr_b16 a[4:5], v189 offset:12416
    v_add_u32 v190, 32768, v190
    v_mfma_f32_16x16x32_bf16 v[124:127], a[28:31], a[140:143], v[124:127]
    ds_read_b64_tr_b16 a[6:7], v189 offset:13952
    s_xor_b32 s60, s55, 0
    v_mfma_f32_16x16x32_bf16 v[128:131], a[32:35], a[136:139], v[128:131]
    ds_read_b64_tr_b16 a[8:9], v190 offset:0
    buffer_load_dwordx4 v12, s[20:23], s60 offen offset:0 lds
    v_mfma_f32_16x16x32_bf16 v[132:135], a[32:35], a[140:143], v[132:135]
    ds_read_b64_tr_b16 a[10:11], v190 offset:1536
    v_lshlrev_b32 v200, 16, v204
    v_mfma_f32_16x16x32_bf16 v[136:139], a[36:39], a[136:139], v[136:139]
    ds_read_b64_tr_b16 a[12:13], v190 offset:12416
    v_and_b32 v201, s56, v204
    v_mfma_f32_16x16x32_bf16 v[140:143], a[36:39], a[140:143], v[140:143]
    ds_read_b64_tr_b16 a[14:15], v190 offset:13952
    s_waitcnt lgkmcnt(6)
    v_mfma_f32_16x16x32_bf16 v[96:99], a[48:51], a[144:147], v[96:99]
    ds_read_b64_tr_b16 a[56:57], v188 offset:3072
    buffer_load_dwordx4 v14, s[20:23], s60 offen offset:1024 lds
    v_mfma_f32_16x16x32_bf16 v[100:103], a[48:51], a[148:151], v[100:103]
    ds_read_b64_tr_b16 a[58:59], v188 offset:4608
    v_lshlrev_b32 v202, 16, v205
    v_mfma_f32_16x16x32_bf16 v[104:107], a[52:55], a[144:147], v[104:107]
    ds_read_b64_tr_b16 a[60:61], v188 offset:15488
    v_and_b32 v203, s56, v205
    v_mfma_f32_16x16x32_bf16 v[108:111], a[52:55], a[148:151], v[108:111]
    ds_read_b64_tr_b16 a[62:63], v188 offset:17024
    v_lshlrev_b32 v204, 16, v206
    v_mfma_f32_16x16x32_bf16 v[112:115], a[0:3], a[144:147], v[112:115]
    ds_read_b64_tr_b16 a[24:25], v189 offset:3072
    v_and_b32 v205, s56, v206
    v_mfma_f32_16x16x32_bf16 v[116:119], a[0:3], a[148:151], v[116:119]
    ds_read_b64_tr_b16 a[26:27], v189 offset:4608
    s_waitcnt lgkmcnt(6)
    v_mfma_f32_16x16x32_bf16 v[120:123], a[4:7], a[144:147], v[120:123]
    ds_read_b64_tr_b16 a[28:29], v189 offset:15488
    buffer_load_dwordx4 v15, s[20:23], s60 offen offset:2048 lds
    v_mfma_f32_16x16x32_bf16 v[124:127], a[4:7], a[148:151], v[124:127]
    ds_read_b64_tr_b16 a[30:31], v189 offset:17024
    v_lshlrev_b32 v206, 16, v207
    v_mfma_f32_16x16x32_bf16 v[128:131], a[8:11], a[144:147], v[128:131]
    ds_read_b64_tr_b16 a[32:33], v190 offset:3072
    v_and_b32 v207, s56, v207
    v_mfma_f32_16x16x32_bf16 v[132:135], a[8:11], a[148:151], v[132:135]
    ds_read_b64_tr_b16 a[34:35], v190 offset:4608
    v_lshlrev_b32 v208, 16, v212
    v_mfma_f32_16x16x32_bf16 v[136:139], a[12:15], a[144:147], v[136:139]
    ds_read_b64_tr_b16 a[36:37], v190 offset:15488
    v_and_b32 v209, s56, v212
    v_mfma_f32_16x16x32_bf16 v[140:143], a[12:15], a[148:151], v[140:143]
    ds_read_b64_tr_b16 a[38:39], v190 offset:17024
    s_waitcnt lgkmcnt(6)
    v_mfma_f32_16x16x32_bf16 v[96:99], a[56:59], a[152:155], v[96:99]
    ds_read_b64_tr_b16 a[64:65], v188 offset:6144
    buffer_load_dwordx4 v228, s[20:23], s60 offen offset:3072 lds
    v_mfma_f32_16x16x32_bf16 v[100:103], a[56:59], a[156:159], v[100:103]
    ds_read_b64_tr_b16 a[66:67], v188 offset:7680
    v_lshlrev_b32 v210, 16, v213
    v_mfma_f32_16x16x32_bf16 v[104:107], a[60:63], a[152:155], v[104:107]
    ds_read_b64_tr_b16 a[68:69], v188 offset:18560
    v_and_b32 v211, s56, v213
    v_mfma_f32_16x16x32_bf16 v[108:111], a[60:63], a[156:159], v[108:111]
    ds_read_b64_tr_b16 a[70:71], v188 offset:20096
    v_lshlrev_b32 v212, 16, v214
    v_mfma_f32_16x16x32_bf16 v[112:115], a[24:27], a[152:155], v[112:115]
    ds_read_b64_tr_b16 a[0:1], v189 offset:6144
    s_add_u32 m0, s33, 16384
    v_mfma_f32_16x16x32_bf16 v[116:119], a[24:27], a[156:159], v[116:119]
    ds_read_b64_tr_b16 a[2:3], v189 offset:7680
    s_waitcnt lgkmcnt(6)
    v_mfma_f32_16x16x32_bf16 v[120:123], a[28:31], a[152:155], v[120:123]
    ds_read_b64_tr_b16 a[4:5], v189 offset:18560
    s_xor_b32 s60, s55, 131072
    v_mfma_f32_16x16x32_bf16 v[124:127], a[28:31], a[156:159], v[124:127]
    ds_read_b64_tr_b16 a[6:7], v189 offset:20096
    buffer_load_dwordx4 v12, s[20:23], s60 offen offset:0 lds
    v_mfma_f32_16x16x32_bf16 v[128:131], a[32:35], a[152:155], v[128:131]
    ds_read_b64_tr_b16 a[8:9], v190 offset:6144
    v_and_b32 v213, s56, v214
    v_mfma_f32_16x16x32_bf16 v[132:135], a[32:35], a[156:159], v[132:135]
    ds_read_b64_tr_b16 a[10:11], v190 offset:7680
    v_lshlrev_b32 v214, 16, v215
    v_mfma_f32_16x16x32_bf16 v[136:139], a[36:39], a[152:155], v[136:139]
    ds_read_b64_tr_b16 a[12:13], v190 offset:18560
    v_and_b32 v215, s56, v215
    v_mfma_f32_16x16x32_bf16 v[140:143], a[36:39], a[156:159], v[140:143]
    ds_read_b64_tr_b16 a[14:15], v190 offset:20096
    s_waitcnt lgkmcnt(6)
    v_mfma_f32_16x16x32_bf16 v[96:99], a[64:67], a[160:163], v[96:99]
    ds_read_b64_tr_b16 a[72:73], v188 offset:9216
    ds_read_b64_tr_b16 a[74:75], v188 offset:10752
    buffer_load_dwordx2 v[26:27], v220, s[24:27], 0 offen sc1
    v_mfma_f32_16x16x32_bf16 v[100:103], a[64:67], a[164:167], v[100:103]
    ds_read_b64_tr_b16 a[76:77], v188 offset:21632
    ds_read_b64_tr_b16 a[78:79], v188 offset:23168
    v_mfma_f32_16x16x32_bf16 v[104:107], a[68:71], a[160:163], v[104:107]
    ds_read_b64_tr_b16 a[24:25], v189 offset:9216
    ds_read_b64_tr_b16 a[26:27], v189 offset:10752
    v_mfma_f32_16x16x32_bf16 v[108:111], a[68:71], a[164:167], v[108:111]
    ds_read_b64_tr_b16 a[28:29], v189 offset:21632
    ds_read_b64_tr_b16 a[30:31], v189 offset:23168
    v_mfma_f32_16x16x32_bf16 v[112:115], a[0:3], a[160:163], v[112:115]
    ds_read_b64_tr_b16 a[32:33], v190 offset:9216
    ds_read_b64_tr_b16 a[34:35], v190 offset:10752
    v_mfma_f32_16x16x32_bf16 v[116:119], a[0:3], a[164:167], v[116:119]
    ds_read_b64_tr_b16 a[36:37], v190 offset:21632
    ds_read_b64_tr_b16 a[38:39], v190 offset:23168
    s_waitcnt lgkmcnt(12)
    v_mfma_f32_16x16x32_bf16 v[120:123], a[4:7], a[160:163], v[120:123]
    buffer_load_dwordx4 v14, s[20:23], s60 offen offset:1024 lds
    v_mfma_f32_16x16x32_bf16 v[124:127], a[4:7], a[164:167], v[124:127]
    buffer_load_dwordx4 v15, s[20:23], s60 offen offset:2048 lds
    v_mfma_f32_16x16x32_bf16 v[128:131], a[8:11], a[160:163], v[128:131]
    v_and_b32 v224, 3, v0
    v_mad_u32_u24 v224, v224, 12, 4
    v_mfma_f32_16x16x32_bf16 v[132:135], a[8:11], a[164:167], v[132:135]
    v_lshrrev_b64 v[222:223], v224, s[42:43]
    v_mov_b32 v223, 0xfff
    v_mfma_f32_16x16x32_bf16 v[136:139], a[12:15], a[160:163], v[136:139]
    v_mfma_f32_16x16x32_bf16 v[140:143], a[12:15], a[164:167], v[140:143]
    s_cmp_lg_u32 s40, 0
    s_cbranch_scc1 L_cs_31
    s_waitcnt lgkmcnt(0)
    v_mfma_f32_16x16x32_bf16 a[208:211], v[236:239], a[48:51], a[208:211]
    v_mfma_f32_16x16x32_bf16 a[212:215], v[236:239], a[52:55], a[212:215]
    v_mfma_f32_16x16x32_bf16 a[208:211], v[236:239], a[56:59], a[208:211]
    v_mfma_f32_16x16x32_bf16 a[212:215], v[236:239], a[60:63], a[212:215]
    v_mfma_f32_16x16x32_bf16 a[208:211], v[236:239], a[64:67], a[208:211]
    v_mfma_f32_16x16x32_bf16 a[212:215], v[236:239], a[68:71], a[212:215]
    v_mfma_f32_16x16x32_bf16 a[208:211], v[236:239], a[72:75], a[208:211]
    v_mfma_f32_16x16x32_bf16 a[212:215], v[236:239], a[76:79], a[212:215]
L_cs_31:
    s_waitcnt lgkmcnt(0)
    s_barrier
    v_add_u32 v188, 32768, v188
    v_mfma_f32_16x16x32_bf16 v[96:99], a[72:75], a[168:171], v[96:99]
    ds_read_b64_tr_b16 a[48:49], v188 offset:0
    buffer_load_dwordx4 v228, s[20:23], s60 offen offset:3072 lds
    v_mfma_f32_16x16x32_bf16 v[100:103], a[72:75], a[172:175], v[100:103]
    ds_read_b64_tr_b16 a[50:51], v188 offset:1536
    v_mfma_f32_16x16x32_bf16 v[104:107], a[76:79], a[168:171], v[104:107]
    ds_read_b64_tr_b16 a[52:53], v188 offset:12416
    v_add_u32 v189, 32768, v189
    v_mfma_f32_16x16x32_bf16 v[108:111], a[76:79], a[172:175], v[108:111]
    ds_read_b64_tr_b16 a[54:55], v188 offset:13952
    v_mfma_f32_16x16x32_bf16 v[112:115], a[24:27], a[168:171], v[112:115]
    ds_read_b64_tr_b16 a[0:1], v189 offset:0
    s_add_u32 m0, s33, 32768
    v_mfma_f32_16x16x32_bf16 v[116:119], a[24:27], a[172:175], v[116:119]
    ds_read_b64_tr_b16 a[2:3], v189 offset:1536
    v_mfma_f32_16x16x32_bf16 v[120:123], a[28:31], a[168:171], v[120:123]
    ds_read_b64_tr_b16 a[4:5], v189 offset:12416
    v_add_u32 v190, 32768, v190
    v_mfma_f32_16x16x32_bf16 v[124:127], a[28:31], a[172:175], v[124:127]
    ds_read_b64_tr_b16 a[6:7], v189 offset:13952
    s_xor_b32 s60, s55, 262144
    v_mfma_f32_16x16x32_bf16 v[128:131], a[32:35], a[168:171], v[128:131]
    ds_read_b64_tr_b16 a[8:9], v190 offset:0
    buffer_load_dwordx4 v12, s[20:23], s60 offen offset:0 lds
    v_mfma_f32_16x16x32_bf16 v[132:135], a[32:35], a[172:175], v[132:135]
    ds_read_b64_tr_b16 a[10:11], v190 offset:1536
    v_mfma_f32_16x16x32_bf16 v[136:139], a[36:39], a[168:171], v[136:139]
    ds_read_b64_tr_b16 a[12:13], v190 offset:12416
    v_mfma_f32_16x16x32_bf16 v[140:143], a[36:39], a[172:175], v[140:143]
    ds_read_b64_tr_b16 a[14:15], v190 offset:13952
    s_waitcnt vmcnt(4)
    v_cmp_ge_u64 vcc, v[26:27], s[44:45]
    v_cmp_le_u64 s[84:85], v[26:27], s[46:47]
    s_and_b64 vcc, vcc, s[84:85]
    s_cmp_eq_u64 vcc, -1
    s_cbranch_scc1 L_back_33
L_spin_32:
    buffer_load_dwordx2 v[26:27], v220, s[24:27], 0 offen sc1
    s_sub_u32 s62, s62, 1
    s_waitcnt vmcnt(0)
    v_cmp_ge_u64 vcc, v[26:27], s[44:45]
    v_cmp_le_u64 s[84:85], v[26:27], s[46:47]
    s_cmp_le_i32 s62, 0
    s_cbranch_scc1 L_back_33
    s_and_b64 vcc, vcc, s[84:85]
    s_cmp_eq_u64 vcc, -1
    s_cbranch_scc0 L_spin_32
L_back_33:
    s_waitcnt lgkmcnt(6)
    v_mfma_f32_16x16x32_bf16 v[96:99], a[48:51], a[176:179], v[96:99]
    ds_read_b64_tr_b16 a[56:57], v188 offset:3072
    buffer_load_dwordx4 v14, s[20:23], s60 offen offset:1024 lds
    v_mfma_f32_16x16x32_bf16 v[100:103], a[48:51], a[180:183], v[100:103]
    ds_read_b64_tr_b16 a[58:59], v188 offset:4608
    s_xor_b32 s35, s93, 0
    v_mfma_f32_16x16x32_bf16 v[104:107], a[52:55], a[176:179], v[104:107]
    ds_read_b64_tr_b16 a[60:61], v188 offset:15488
    buffer_load_dwordx4 v[32:35], v254, s[24:27], s35 offen offset:0 sc1
    v_mfma_f32_16x16x32_bf16 v[108:111], a[52:55], a[180:183], v[108:111]
    ds_read_b64_tr_b16 a[62:63], v188 offset:17024
    v_mfma_f32_16x16x32_bf16 v[112:115], a[0:3], a[176:179], v[112:115]
    ds_read_b64_tr_b16 a[24:25], v189 offset:3072
    v_mfma_f32_16x16x32_bf16 v[116:119], a[0:3], a[180:183], v[116:119]
    ds_read_b64_tr_b16 a[26:27], v189 offset:4608
    s_waitcnt lgkmcnt(6)
    v_mfma_f32_16x16x32_bf16 v[120:123], a[4:7], a[176:179], v[120:123]
    ds_read_b64_tr_b16 a[28:29], v189 offset:15488
    buffer_load_dwordx4 v[36:39], v254, s[24:27], s35 offen offset:256 sc1
    v_mfma_f32_16x16x32_bf16 v[124:127], a[4:7], a[180:183], v[124:127]
    ds_read_b64_tr_b16 a[30:31], v189 offset:17024
    buffer_load_dwordx4 v15, s[20:23], s60 offen offset:2048 lds
    v_mfma_f32_16x16x32_bf16 v[128:131], a[8:11], a[176:179], v[128:131]
    ds_read_b64_tr_b16 a[32:33], v190 offset:3072
    v_mfma_f32_16x16x32_bf16 v[132:135], a[8:11], a[180:183], v[132:135]
    ds_read_b64_tr_b16 a[34:35], v190 offset:4608
    buffer_load_dwordx4 v[40:43], v254, s[24:27], s35 offen offset:2048 sc1
    v_mfma_f32_16x16x32_bf16 v[136:139], a[12:15], a[176:179], v[136:139]
    ds_read_b64_tr_b16 a[36:37], v190 offset:15488
    v_mfma_f32_16x16x32_bf16 v[140:143], a[12:15], a[180:183], v[140:143]
    ds_read_b64_tr_b16 a[38:39], v190 offset:17024
    s_waitcnt lgkmcnt(6)
    v_mfma_f32_16x16x32_bf16 v[96:99], a[56:59], a[184:187], v[96:99]
    ds_read_b64_tr_b16 a[64:65], v188 offset:6144
    buffer_load_dwordx4 v228, s[20:23], s60 offen offset:3072 lds
    v_mfma_f32_16x16x32_bf16 v[100:103], a[56:59], a[188:191], v[100:103]
    ds_read_b64_tr_b16 a[66:67], v188 offset:7680
    buffer_load_dwordx4 v[44:47], v254, s[24:27], s35 offen offset:2304 sc1
    v_mfma_f32_16x16x32_bf16 v[104:107], a[60:63], a[184:187], v[104:107]
    ds_read_b64_tr_b16 a[68:69], v188 offset:18560
    v_mfma_f32_16x16x32_bf16 v[108:111], a[60:63], a[188:191], v[108:111]
    ds_read_b64_tr_b16 a[70:71], v188 offset:20096
    v_mfma_f32_16x16x32_bf16 v[112:115], a[24:27], a[184:187], v[112:115]
    ds_read_b64_tr_b16 a[0:1], v189 offset:6144
    s_xor_b32 s35, s93, 4096
    v_mfma_f32_16x16x32_bf16 v[116:119], a[24:27], a[188:191], v[116:119]
    ds_read_b64_tr_b16 a[2:3], v189 offset:7680
    s_waitcnt lgkmcnt(6)
    v_mfma_f32_16x16x32_bf16 v[120:123], a[28:31], a[184:187], v[120:123]
    ds_read_b64_tr_b16 a[4:5], v189 offset:18560
    buffer_load_dwordx4 v[144:147], v254, s[24:27], s35 offen offset:0 sc1
    v_mfma_f32_16x16x32_bf16 v[124:127], a[28:31], a[188:191], v[124:127]
    ds_read_b64_tr_b16 a[6:7], v189 offset:20096
    v_mfma_f32_16x16x32_bf16 v[128:131], a[32:35], a[184:187], v[128:131]
    ds_read_b64_tr_b16 a[8:9], v190 offset:6144
    v_mfma_f32_16x16x32_bf16 v[132:135], a[32:35], a[188:191], v[132:135]
    ds_read_b64_tr_b16 a[10:11], v190 offset:7680
    buffer_load_dwordx4 v[148:151], v254, s[24:27], s35 offen offset:256 sc1
    v_mfma_f32_16x16x32_bf16 v[136:139], a[36:39], a[184:187], v[136:139]
    ds_read_b64_tr_b16 a[12:13], v190 offset:18560
    v_mfma_f32_16x16x32_bf16 v[140:143], a[36:39], a[188:191], v[140:143]
    ds_read_b64_tr_b16 a[14:15], v190 offset:20096
    s_waitcnt lgkmcnt(6)
    v_mfma_f32_16x16x32_bf16 v[96:99], a[64:67], a[192:195], v[96:99]
    ds_read_b64_tr_b16 a[72:73], v188 offset:9216
    v_mfma_f32_16x16x32_bf16 v[100:103], a[64:67], a[196:199], v[100:103]
    ds_read_b64_tr_b16 a[74:75], v188 offset:10752
    buffer_load_dwordx4 v[152:155], v254, s[24:27], s35 offen offset:2048 sc1
    v_mfma_f32_16x16x32_bf16 v[104:107], a[68:71], a[192:195], v[104:107]
    ds_read_b64_tr_b16 a[76:77], v188 offset:21632
    v_mfma_f32_16x16x32_bf16 v[108:111], a[68:71], a[196:199], v[108:111]
    ds_read_b64_tr_b16 a[78:79], v188 offset:23168
    v_mfma_f32_16x16x32_bf16 v[112:115], a[0:3], a[192:195], v[112:115]
    ds_read_b64_tr_b16 a[24:25], v189 offset:9216
    v_mfma_f32_16x16x32_bf16 v[116:119], a[0:3], a[196:199], v[116:119]
    ds_read_b64_tr_b16 a[26:27], v189 offset:10752
    s_waitcnt lgkmcnt(6)
    v_mfma_f32_16x16x32_bf16 v[120:123], a[4:7], a[192:195], v[120:123]
    ds_read_b64_tr_b16 a[28:29], v189 offset:21632
    buffer_load_dwordx4 v[156:159], v254, s[24:27], s35 offen offset:2304 sc1
    v_mfma_f32_16x16x32_bf16 v[124:127], a[4:7], a[196:199], v[124:127]
    ds_read_b64_tr_b16 a[30:31], v189 offset:23168
    v_mfma_f32_16x16x32_bf16 v[128:131], a[8:11], a[192:195], v[128:131]
    ds_read_b64_tr_b16 a[32:33], v190 offset:9216
    s_xor_b32 s35, s93, 16384
    v_mfma_f32_16x16x32_bf16 v[132:135], a[8:11], a[196:199], v[132:135]
    ds_read_b64_tr_b16 a[34:35], v190 offset:10752
    buffer_load_dwordx4 v[160:163], v254, s[24:27], s35 offen offset:0 sc1
    v_mfma_f32_16x16x32_bf16 v[136:139], a[12:15], a[192:195], v[136:139]
    ds_read_b64_tr_b16 a[36:37], v190 offset:21632
    v_mfma_f32_16x16x32_bf16 v[140:143], a[12:15], a[196:199], v[140:143]
    ds_read_b64_tr_b16 a[38:39], v190 offset:23168
    s_cmp_lg_u32 s40, 0
    s_cbranch_scc1 L_cs_35
    s_waitcnt lgkmcnt(0)
    v_mfma_f32_16x16x32_bf16 a[208:211], v[236:239], a[48:51], a[208:211]
    v_mfma_f32_16x16x32_bf16 a[212:215], v[236:239], a[52:55], a[212:215]
    v_mfma_f32_16x16x32_bf16 a[208:211], v[236:239], a[56:59], a[208:211]
    v_mfma_f32_16x16x32_bf16 a[212:215], v[236:239], a[60:63], a[212:215]
    v_mfma_f32_16x16x32_bf16 a[208:211], v[236:239], a[64:67], a[208:211]
    v_mfma_f32_16x16x32_bf16 a[212:215], v[236:239], a[68:71], a[212:215]
    v_mfma_f32_16x16x32_bf16 a[208:211], v[236:239], a[72:75], a[208:211]
    v_mfma_f32_16x16x32_bf16 a[212:215], v[236:239], a[76:79], a[212:215]
    s_nop 6
    v_accvgpr_read_b32 v184, a208
    v_accvgpr_read_b32 v185, a212
    v_cndmask_b32 v184, v184, v185, s[86:87]
    ds_write_b32 v193, v184
    s_waitcnt lgkmcnt(0)
L_cs_35:
    s_waitcnt lgkmcnt(6)
    v_mfma_f32_16x16x32_bf16 v[96:99], a[72:75], a[200:203], v[96:99]
    v_mfma_f32_16x16x32_bf16 v[100:103], a[72:75], a[204:207], v[100:103]
    buffer_load_dwordx4 v[164:167], v254, s[24:27], s35 offen offset:256 sc1
    v_mfma_f32_16x16x32_bf16 v[104:107], a[76:79], a[200:203], v[104:107]
    v_mfma_f32_16x16x32_bf16 v[108:111], a[76:79], a[204:207], v[108:111]
    v_mfma_f32_16x16x32_bf16 v[112:115], a[24:27], a[200:203], v[112:115]
    v_mfma_f32_16x16x32_bf16 v[116:119], a[24:27], a[204:207], v[116:119]
    buffer_load_dwordx4 v[168:171], v254, s[24:27], s35 offen offset:2048 sc1
    s_waitcnt lgkmcnt(0)
    v_mfma_f32_16x16x32_bf16 v[120:123], a[28:31], a[200:203], v[120:123]
    v_mfma_f32_16x16x32_bf16 v[124:127], a[28:31], a[204:207], v[124:127]
    v_mfma_f32_16x16x32_bf16 v[128:131], a[32:35], a[200:203], v[128:131]
    v_mfma_f32_16x16x32_bf16 v[132:135], a[32:35], a[204:207], v[132:135]
    buffer_load_dwordx4 v[172:175], v254, s[24:27], s35 offen offset:2304 sc1
    v_mfma_f32_16x16x32_bf16 v[136:139], a[36:39], a[200:203], v[136:139]
    v_mfma_f32_16x16x32_bf16 v[140:143], a[36:39], a[204:207], v[140:143]
    s_waitcnt vmcnt(9)
    s_barrier
    s_cmp_eq_u32 s40, 0
    s_cselect_b64 exec, -1, 0
    ds_read_b32 a232, v193
    ds_read_b32 a233, v194
    ds_read_b32 a234, v195
    s_mov_b64 exec, -1
    s_xor_b32 s35, s93, 20480
    buffer_load_dwordx4 a[216:219], v254, s[24:27], s35 offen offset:0 sc1
    buffer_load_dwordx4 a[220:223], v254, s[24:27], s35 offen offset:256 sc1
    buffer_load_dwordx4 a[236:239], v254, s[24:27], s35 offen offset:2048 sc1
    buffer_load_dwordx4 a[240:243], v254, s[24:27], s35 offen offset:2304 sc1
    s_waitcnt lgkmcnt(0)
    v_mfma_f32_16x16x1_4b_f32 v[96:111], a232, v232, v[96:111]
    v_mfma_f32_16x16x1_4b_f32 v[112:127], a233, v232, v[112:127]
    v_mfma_f32_16x16x1_4b_f32 v[128:143], a234, v232, v[128:143]
    s_lshl_b32 s85, s36, 18
    s_add_u32 s85, s85, s4
    s_add_u32 s85, s85, s39
    s_mul_i32 s99, s38, 3
    s_and_b32 s58, s38, 8
    s_add_u32 s99, s99, s58
    s_add_u32 s99, s99, 64
    s_bfe_u32 s58, s92, 0x20000
    s_add_u32 s58, s58, s99
    s_lshl_b32 s58, s58, 10
    s_bfe_u32 s61, s92, 0x20002
    s_add_u32 s61, s61, s99
    s_lshl_b32 s61, s61, 10
    s_bfe_u32 s84, s92, 0x20004
    s_add_u32 s84, s84, s99
    s_lshl_b32 s84, s84, 10
    s_and_b32 s98, s58, -8192
    s_add_u32 s58, s58, s85
    s_add_u32 s58, s58, s98
    s_and_b32 s98, s61, -8192
    s_add_u32 s61, s61, s85
    s_add_u32 s61, s61, s98
    s_and_b32 s98, s84, -8192
    s_add_u32 s84, s84, s85
    s_add_u32 s84, s84, s98
    ds_read_b64_tr_b16 a[0:1], v28 offset:0
    ds_read_b64_tr_b16 a[2:3], v30 offset:512
    ds_read_b64_tr_b16 a[4:5], v29 offset:0
    ds_read_b64_tr_b16 a[6:7], v31 offset:512
    ds_read_b64_tr_b16 a[8:9], v30 offset:0
    ds_read_b64_tr_b16 a[10:11], v28 offset:512
    ds_read_b64_tr_b16 a[12:13], v31 offset:0
    ds_read_b64_tr_b16 a[14:15], v29 offset:512
    v_max_f32 v96, 0, v96
    v_max_f32 v97, 0, v97
    v_max_f32 v98, 0, v98
    v_max_f32 v99, 0, v99
    v_max_f32 v100, 0, v100
    v_max_f32 v101, 0, v101
    v_max_f32 v102, 0, v102
    v_max_f32 v103, 0, v103
    v_pk_mul_f32 v[104:105], v[104:105], v[242:243] op_sel_hi:[1,0]
    v_pk_mul_f32 v[106:107], v[106:107], v[242:243] op_sel_hi:[1,0]
    v_pk_mul_f32 v[108:109], v[108:109], v[240:241] op_sel_hi:[1,0]
    v_pk_mul_f32 v[110:111], v[110:111], v[240:241] op_sel_hi:[1,0]
    v_pk_mul_f32 v[96:97], v[96:97], v[104:105]
    v_pk_mul_f32 v[98:99], v[98:99], v[106:107]
    v_pk_mul_f32 v[100:101], v[100:101], v[108:109]
    v_pk_mul_f32 v[102:103], v[102:103], v[110:111]
    v_cvt_pk_bf16_f32 v176, v96, v97
    v_cvt_pk_bf16_f32 v178, v100, v101
    v_cvt_pk_bf16_f32 v177, v98, v99
    v_cvt_pk_bf16_f32 v179, v102, v103
    v_max_f32 v112, 0, v112
    v_max_f32 v113, 0, v113
    v_permlane16_swap_b32 v176, v178
    v_max_f32 v114, 0, v114
    v_permlane16_swap_b32 v177, v179
    v_max_f32 v115, 0, v115
    buffer_store_dwordx4 v[176:179], v1, s[24:27], s58 offen sc1
    v_max_f32 v116, 0, v116
    v_max_f32 v117, 0, v117
    v_max_f32 v118, 0, v118
    v_max_f32 v119, 0, v119
    v_pk_mul_f32 v[120:121], v[120:121], v[242:243] op_sel_hi:[1,0]
    v_pk_mul_f32 v[122:123], v[122:123], v[242:243] op_sel_hi:[1,0]
    v_pk_mul_f32 v[124:125], v[124:125], v[240:241] op_sel_hi:[1,0]
    v_pk_mul_f32 v[126:127], v[126:127], v[240:241] op_sel_hi:[1,0]
    v_pk_mul_f32 v[112:113], v[112:113], v[120:121]
    v_pk_mul_f32 v[114:115], v[114:115], v[122:123]
    v_pk_mul_f32 v[116:117], v[116:117], v[124:125]
    v_pk_mul_f32 v[118:119], v[118:119], v[126:127]
    v_cvt_pk_bf16_f32 v180, v112, v113
    v_cvt_pk_bf16_f32 v182, v116, v117
    v_cvt_pk_bf16_f32 v181, v114, v115
    v_cvt_pk_bf16_f32 v183, v118, v119
    v_max_f32 v128, 0, v128
    v_max_f32 v129, 0, v129
    v_permlane16_swap_b32 v180, v182
    v_max_f32 v130, 0, v130
    v_permlane16_swap_b32 v181, v183
    v_max_f32 v131, 0, v131
    buffer_store_dwordx4 v[180:183], v1, s[24:27], s61 offen sc1
    v_max_f32 v132, 0, v132
    v_max_f32 v133, 0, v133
    v_max_f32 v134, 0, v134
    v_max_f32 v135, 0, v135
    v_pk_mul_f32 v[136:137], v[136:137], v[242:243] op_sel_hi:[1,0]
    v_pk_mul_f32 v[138:139], v[138:139], v[242:243] op_sel_hi:[1,0]
    v_pk_mul_f32 v[140:141], v[140:141], v[240:241] op_sel_hi:[1,0]
    v_pk_mul_f32 v[142:143], v[142:143], v[240:241] op_sel_hi:[1,0]
    v_pk_mul_f32 v[128:129], v[128:129], v[136:137]
    v_pk_mul_f32 v[130:131], v[130:131], v[138:139]
    v_pk_mul_f32 v[132:133], v[132:133], v[140:141]
    v_pk_mul_f32 v[134:135], v[134:135], v[142:143]
    v_cvt_pk_bf16_f32 v184, v128, v129
    v_cvt_pk_bf16_f32 v186, v132, v133
    v_cvt_pk_bf16_f32 v185, v130, v131
    v_cvt_pk_bf16_f32 v187, v134, v135
    s_nop 1
    v_permlane16_swap_b32 v184, v186
    v_permlane16_swap_b32 v185, v187
    buffer_store_dwordx4 v[184:187], v1, s[24:27], s84 offen sc1
    s_xor_b32 s35, s93, 32768
    buffer_load_dwordx4 a[244:247], v254, s[24:27], s35 offen offset:0 sc1
    buffer_load_dwordx4 a[80:83], v254, s[24:27], s35 offen offset:256 sc1
    s_waitcnt lgkmcnt(4)
    v_mfma_f32_16x16x32_bf16 v[200:203], a[0:3], v[32:35], v[200:203]
    ds_read_b64_tr_b16 a[16:17], v28 offset:4096
    v_mfma_f32_16x16x32_bf16 v[208:211], a[0:3], v[36:39], v[208:211]
    ds_read_b64_tr_b16 a[18:19], v30 offset:4608
    buffer_load_dwordx4 a[84:87], v254, s[24:27], s35 offen offset:2048 sc1
    v_mfma_f32_16x16x32_bf16 v[204:207], a[4:7], v[32:35], v[204:207]
    ds_read_b64_tr_b16 a[20:21], v29 offset:4096
    v_mfma_f32_16x16x32_bf16 v[212:215], a[4:7], v[36:39], v[212:215]
    ds_read_b64_tr_b16 a[22:23], v31 offset:4608
    s_waitcnt lgkmcnt(4)
    v_mfma_f32_16x16x32_bf16 v[176:179], a[8:11], v[32:35], 0
    ds_read_b64_tr_b16 a[40:41], v30 offset:4096
    v_mfma_f32_16x16x32_bf16 v[184:187], a[8:11], v[36:39], 0
    ds_read_b64_tr_b16 a[42:43], v28 offset:4608
    buffer_load_dwordx4 a[88:91], v254, s[24:27], s35 offen offset:2304 sc1
    v_mfma_f32_16x16x32_bf16 v[180:183], a[12:15], v[32:35], 0
    ds_read_b64_tr_b16 a[44:45], v31 offset:4096
    v_mfma_f32_16x16x32_bf16 v[188:191], a[12:15], v[36:39], 0
    ds_read_b64_tr_b16 a[46:47], v29 offset:4608
    s_waitcnt vmcnt(19) lgkmcnt(4)
    v_mfma_f32_16x16x32_bf16 v[200:203], a[16:19], v[40:43], v[200:203]
    ds_read_b64_tr_b16 a[0:1], v28 offset:8192
    s_xor_b32 s35, s93, 36864
    v_mfma_f32_16x16x32_bf16 v[208:211], a[16:19], v[44:47], v[208:211]
    ds_read_b64_tr_b16 a[2:3], v30 offset:8704
    buffer_load_dwordx4 a[92:95], v254, s[24:27], s35 offen offset:0 sc1
    v_mfma_f32_16x16x32_bf16 v[204:207], a[20:23], v[40:43], v[204:207]
    ds_read_b64_tr_b16 a[4:5], v29 offset:8192
    v_mfma_f32_16x16x32_bf16 v[212:215], a[20:23], v[44:47], v[212:215]
    ds_read_b64_tr_b16 a[6:7], v31 offset:8704
    s_waitcnt lgkmcnt(4)
    v_mfma_f32_16x16x32_bf16 v[176:179], a[40:43], v[40:43], v[176:179]
    ds_read_b64_tr_b16 a[8:9], v30 offset:8192
    v_mfma_f32_16x16x32_bf16 v[184:187], a[40:43], v[44:47], v[184:187]
    ds_read_b64_tr_b16 a[10:11], v28 offset:8704
    buffer_load_dwordx4 a[96:99], v254, s[24:27], s35 offen offset:256 sc1
    v_mfma_f32_16x16x32_bf16 v[180:183], a[44:47], v[40:43], v[180:183]
    ds_read_b64_tr_b16 a[12:13], v31 offset:8192
    v_mfma_f32_16x16x32_bf16 v[188:191], a[44:47], v[44:47], v[188:191]
    ds_read_b64_tr_b16 a[14:15], v29 offset:8704
    s_waitcnt vmcnt(19) lgkmcnt(4)
    v_mfma_f32_16x16x32_bf16 v[200:203], a[0:3], v[144:147], v[200:203]
    ds_read_b64_tr_b16 a[16:17], v28 offset:12288
    v_mfma_f32_16x16x32_bf16 v[208:211], a[0:3], v[148:151], v[208:211]
    ds_read_b64_tr_b16 a[18:19], v30 offset:12800
    buffer_load_dwordx4 a[100:103], v254, s[24:27], s35 offen offset:2048 sc1
    v_mfma_f32_16x16x32_bf16 v[204:207], a[4:7], v[144:147], v[204:207]
    ds_read_b64_tr_b16 a[20:21], v29 offset:12288
    v_mfma_f32_16x16x32_bf16 v[212:215], a[4:7], v[148:151], v[212:215]
    ds_read_b64_tr_b16 a[22:23], v31 offset:12800
    s_waitcnt lgkmcnt(4)
    v_mfma_f32_16x16x32_bf16 v[176:179], a[8:11], v[144:147], v[176:179]
    ds_read_b64_tr_b16 a[40:41], v30 offset:12288
    v_mfma_f32_16x16x32_bf16 v[184:187], a[8:11], v[148:151], v[184:187]
    ds_read_b64_tr_b16 a[42:43], v28 offset:12800
    buffer_load_dwordx4 a[104:107], v254, s[24:27], s35 offen offset:2304 sc1
    v_mfma_f32_16x16x32_bf16 v[180:183], a[12:15], v[144:147], v[180:183]
    ds_read_b64_tr_b16 a[44:45], v31 offset:12288
    v_mfma_f32_16x16x32_bf16 v[188:191], a[12:15], v[148:151], v[188:191]
    ds_read_b64_tr_b16 a[46:47], v29 offset:12800
    s_waitcnt vmcnt(19) lgkmcnt(4)
    v_mfma_f32_16x16x32_bf16 v[200:203], a[16:19], v[152:155], v[200:203]
    ds_read_b64_tr_b16 a[0:1], v28 offset:16384
    s_xor_b32 s35, s93, 49152
    v_mfma_f32_16x16x32_bf16 v[208:211], a[16:19], v[156:159], v[208:211]
    ds_read_b64_tr_b16 a[2:3], v30 offset:16896
    buffer_load_dwordx4 a[108:111], v254, s[24:27], s35 offen offset:0 sc1
    v_mfma_f32_16x16x32_bf16 v[204:207], a[20:23], v[152:155], v[204:207]
    ds_read_b64_tr_b16 a[4:5], v29 offset:16384
    v_mfma_f32_16x16x32_bf16 v[212:215], a[20:23], v[156:159], v[212:215]
    ds_read_b64_tr_b16 a[6:7], v31 offset:16896
    s_waitcnt lgkmcnt(4)
    v_mfma_f32_16x16x32_bf16 v[176:179], a[40:43], v[152:155], v[176:179]
    ds_read_b64_tr_b16 a[8:9], v30 offset:16384
    v_mfma_f32_16x16x32_bf16 v[184:187], a[40:43], v[156:159], v[184:187]
    ds_read_b64_tr_b16 a[10:11], v28 offset:16896
    buffer_load_dwordx4 a[112:115], v254, s[24:27], s35 offen offset:256 sc1
    v_mfma_f32_16x16x32_bf16 v[180:183], a[44:47], v[152:155], v[180:183]
    ds_read_b64_tr_b16 a[12:13], v31 offset:16384
    v_mfma_f32_16x16x32_bf16 v[188:191], a[44:47], v[156:159], v[188:191]
    ds_read_b64_tr_b16 a[14:15], v29 offset:16896
    s_waitcnt vmcnt(19) lgkmcnt(4)
    v_mfma_f32_16x16x32_bf16 v[200:203], a[0:3], v[160:163], v[200:203]
    ds_read_b64_tr_b16 a[16:17], v28 offset:20480
    v_mfma_f32_16x16x32_bf16 v[208:211], a[0:3], v[164:167], v[208:211]
    ds_read_b64_tr_b16 a[18:19], v30 offset:20992
    buffer_load_dwordx4 a[116:119], v254, s[24:27], s35 offen offset:2048 sc1
    v_mfma_f32_16x16x32_bf16 v[204:207], a[4:7], v[160:163], v[204:207]
    ds_read_b64_tr_b16 a[20:21], v29 offset:20480
    v_mfma_f32_16x16x32_bf16 v[212:215], a[4:7], v[164:167], v[212:215]
    ds_read_b64_tr_b16 a[22:23], v31 offset:20992
    s_waitcnt lgkmcnt(4)
    v_mfma_f32_16x16x32_bf16 v[176:179], a[8:11], v[160:163], v[176:179]
    ds_read_b64_tr_b16 a[40:41], v30 offset:20480
    v_mfma_f32_16x16x32_bf16 v[184:187], a[8:11], v[164:167], v[184:187]
    ds_read_b64_tr_b16 a[42:43], v28 offset:20992
    buffer_load_dwordx4 a[120:123], v254, s[24:27], s35 offen offset:2304 sc1
    v_mfma_f32_16x16x32_bf16 v[180:183], a[12:15], v[160:163], v[180:183]
    ds_read_b64_tr_b16 a[44:45], v31 offset:20480
    v_mfma_f32_16x16x32_bf16 v[188:191], a[12:15], v[164:167], v[188:191]
    ds_read_b64_tr_b16 a[46:47], v29 offset:20992
    s_waitcnt vmcnt(19) lgkmcnt(4)
    v_mfma_f32_16x16x32_bf16 v[200:203], a[16:19], v[168:171], v[200:203]
    ds_read_b64_tr_b16 a[0:1], v28 offset:24576
    s_xor_b32 s35, s93, 53248
    v_mfma_f32_16x16x32_bf16 v[208:211], a[16:19], v[172:175], v[208:211]
    ds_read_b64_tr_b16 a[2:3], v30 offset:25088
    buffer_load_dwordx4 a[124:127], v254, s[24:27], s35 offen offset:0 sc1
    v_mfma_f32_16x16x32_bf16 v[204:207], a[20:23], v[168:171], v[204:207]
    ds_read_b64_tr_b16 a[4:5], v29 offset:24576
    v_mfma_f32_16x16x32_bf16 v[212:215], a[20:23], v[172:175], v[212:215]
    ds_read_b64_tr_b16 a[6:7], v31 offset:25088
    s_waitcnt lgkmcnt(4)
    v_mfma_f32_16x16x32_bf16 v[176:179], a[40:43], v[168:171], v[176:179]
    ds_read_b64_tr_b16 a[8:9], v30 offset:24576
    v_mfma_f32_16x16x32_bf16 v[184:187], a[40:43], v[172:175], v[184:187]
    ds_read_b64_tr_b16 a[10:11], v28 offset:25088
    buffer_load_dwordx4 a[128:131], v254, s[24:27], s35 offen offset:256 sc1
    v_mfma_f32_16x16x32_bf16 v[180:183], a[44:47], v[168:171], v[180:183]
    ds_read_b64_tr_b16 a[12:13], v31 offset:24576
    v_mfma_f32_16x16x32_bf16 v[188:191], a[44:47], v[172:175], v[188:191]
    ds_read_b64_tr_b16 a[14:15], v29 offset:25088
    s_waitcnt vmcnt(19) lgkmcnt(4)
    v_mfma_f32_16x16x32_bf16 v[200:203], a[0:3], a[216:219], v[200:203]
    ds_read_b64_tr_b16 a[16:17], v28 offset:28672
    v_mfma_f32_16x16x32_bf16 v[208:211], a[0:3], a[220:223], v[208:211]
    ds_read_b64_tr_b16 a[18:19], v30 offset:29184
    buffer_load_dwordx4 a[132:135], v254, s[24:27], s35 offen offset:2048 sc1
    v_mfma_f32_16x16x32_bf16 v[204:207], a[4:7], a[216:219], v[204:207]
    ds_read_b64_tr_b16 a[20:21], v29 offset:28672
    v_mfma_f32_16x16x32_bf16 v[212:215], a[4:7], a[220:223], v[212:215]
    ds_read_b64_tr_b16 a[22:23], v31 offset:29184
    s_waitcnt lgkmcnt(4)
    v_mfma_f32_16x16x32_bf16 v[176:179], a[8:11], a[216:219], v[176:179]
    ds_read_b64_tr_b16 a[40:41], v30 offset:28672
    v_mfma_f32_16x16x32_bf16 v[184:187], a[8:11], a[220:223], v[184:187]
    ds_read_b64_tr_b16 a[42:43], v28 offset:29184
    buffer_load_dwordx4 a[136:139], v254, s[24:27], s35 offen offset:2304 sc1
    v_mfma_f32_16x16x32_bf16 v[180:183], a[12:15], a[216:219], v[180:183]
    ds_read_b64_tr_b16 a[44:45], v31 offset:28672
    v_mfma_f32_16x16x32_bf16 v[188:191], a[12:15], a[220:223], v[188:191]
    ds_read_b64_tr_b16 a[46:47], v29 offset:29184
    s_add_u32 s44, s42, s41
    s_waitcnt vmcnt(19) lgkmcnt(4)
    v_mfma_f32_16x16x32_bf16 v[200:203], a[16:19], a[236:239], v[200:203]
    ds_read_b64_tr_b16 a[0:1], v28 offset:32768
    s_mov_b32 s45, s43
    v_mfma_f32_16x16x32_bf16 v[208:211], a[16:19], a[240:243], v[208:211]
    ds_read_b64_tr_b16 a[2:3], v30 offset:33280
    s_add_u32 s44, s44, 5
    v_mfma_f32_16x16x32_bf16 v[204:207], a[20:23], a[236:239], v[204:207]
    ds_read_b64_tr_b16 a[4:5], v29 offset:32768
    v_mov_b32 v19, s45
    v_mfma_f32_16x16x32_bf16 v[212:215], a[20:23], a[240:243], v[212:215]
    ds_read_b64_tr_b16 a[6:7], v31 offset:33280
    v_mov_b32 v18, s44
    s_waitcnt lgkmcnt(4)
    v_mfma_f32_16x16x32_bf16 v[176:179], a[40:43], a[236:239], v[176:179]
    ds_read_b64_tr_b16 a[8:9], v30 offset:32768
    s_xor_b32 s35, s89, 0
    v_mfma_f32_16x16x32_bf16 v[184:187], a[40:43], a[240:243], v[184:187]
    ds_read_b64_tr_b16 a[10:11], v28 offset:33280
    s_waitcnt vmcnt(16)
    v_mfma_f32_16x16x32_bf16 v[180:183], a[44:47], a[236:239], v[180:183]
    ds_read_b64_tr_b16 a[12:13], v31 offset:32768
    buffer_load_dwordx4 v[48:51], v254, s[24:27], s35 offen offset:0 sc1
    v_mfma_f32_16x16x32_bf16 v[188:191], a[44:47], a[240:243], v[188:191]
    ds_read_b64_tr_b16 a[14:15], v29 offset:33280
    s_mov_b64 exec, 1
    buffer_store_dwordx2 v[18:19], off, s[24:27], s5 sc1
    s_mov_b64 exec, -1
    s_waitcnt vmcnt(16) lgkmcnt(4)
    v_mfma_f32_16x16x32_bf16 v[200:203], a[0:3], a[244:247], v[200:203]
    ds_read_b64_tr_b16 a[16:17], v28 offset:36864
    buffer_load_dwordx4 v[52:55], v254, s[24:27], s35 offen offset:256 sc1
    v_mfma_f32_16x16x32_bf16 v[208:211], a[0:3], a[80:83], v[208:211]
    ds_read_b64_tr_b16 a[18:19], v30 offset:37376
    buffer_load_dwordx4 v[56:59], v254, s[24:27], s35 offen offset:2048 sc1
    v_mfma_f32_16x16x32_bf16 v[204:207], a[4:7], a[244:247], v[204:207]
    ds_read_b64_tr_b16 a[20:21], v29 offset:36864
    buffer_load_dwordx4 v[60:63], v254, s[24:27], s35 offen offset:2304 sc1
    v_mfma_f32_16x16x32_bf16 v[212:215], a[4:7], a[80:83], v[212:215]
    ds_read_b64_tr_b16 a[22:23], v31 offset:37376
    s_waitcnt lgkmcnt(4)
    v_mfma_f32_16x16x32_bf16 v[176:179], a[8:11], a[244:247], v[176:179]
    ds_read_b64_tr_b16 a[40:41], v30 offset:36864
    s_xor_b32 s35, s89, 4096
    v_mfma_f32_16x16x32_bf16 v[184:187], a[8:11], a[80:83], v[184:187]
    ds_read_b64_tr_b16 a[42:43], v28 offset:37376
    buffer_load_dwordx4 v[64:67], v254, s[24:27], s35 offen offset:0 sc1
    v_mfma_f32_16x16x32_bf16 v[180:183], a[12:15], a[244:247], v[180:183]
    ds_read_b64_tr_b16 a[44:45], v31 offset:36864
    s_lshl_b32 s61, s48, 16
    v_mfma_f32_16x16x32_bf16 v[188:191], a[12:15], a[80:83], v[188:191]
    ds_read_b64_tr_b16 a[46:47], v29 offset:37376
    s_waitcnt vmcnt(18) lgkmcnt(4)
    v_mfma_f32_16x16x32_bf16 v[200:203], a[16:19], a[84:87], v[200:203]
    ds_read_b64_tr_b16 a[0:1], v28 offset:40960
    buffer_load_dwordx4 v[68:71], v254, s[24:27], s35 offen offset:256 sc1
    v_mfma_f32_16x16x32_bf16 v[208:211], a[16:19], a[88:91], v[208:211]
    ds_read_b64_tr_b16 a[2:3], v30 offset:41472
    s_add_u32 s61, s61, s39
    v_mfma_f32_16x16x32_bf16 v[204:207], a[20:23], a[84:87], v[204:207]
    ds_read_b64_tr_b16 a[4:5], v29 offset:40960
    s_lshl_b32 s59, s6, 8
    v_mfma_f32_16x16x32_bf16 v[212:215], a[20:23], a[88:91], v[212:215]
    ds_read_b64_tr_b16 a[6:7], v31 offset:41472
    s_waitcnt lgkmcnt(4)
    v_mfma_f32_16x16x32_bf16 v[176:179], a[40:43], a[84:87], v[176:179]
    ds_read_b64_tr_b16 a[8:9], v30 offset:40960
    buffer_load_dwordx4 v[72:75], v254, s[24:27], s35 offen offset:2048 sc1
    v_mfma_f32_16x16x32_bf16 v[184:187], a[40:43], a[88:91], v[184:187]
    ds_read_b64_tr_b16 a[10:11], v28 offset:41472
    s_lshl_b32 s58, s6, 11
    v_mfma_f32_16x16x32_bf16 v[180:183], a[44:47], a[84:87], v[180:183]
    ds_read_b64_tr_b16 a[12:13], v31 offset:40960
    buffer_load_dwordx4 v[76:79], v254, s[24:27], s35 offen offset:2304 sc1
    v_mfma_f32_16x16x32_bf16 v[188:191], a[44:47], a[88:91], v[188:191]
    ds_read_b64_tr_b16 a[14:15], v29 offset:41472
    s_waitcnt vmcnt(19) lgkmcnt(4)
    v_mfma_f32_16x16x32_bf16 v[200:203], a[0:3], a[92:95], v[200:203]
    ds_read_b64_tr_b16 a[16:17], v28 offset:45056
    s_xor_b32 s35, s81, 0
    v_mfma_f32_16x16x32_bf16 v[208:211], a[0:3], a[96:99], v[208:211]
    ds_read_b64_tr_b16 a[18:19], v30 offset:45568
    buffer_load_dwordx4 v[80:83], v254, s[24:27], s35 offen offset:0 sc1
    v_mfma_f32_16x16x32_bf16 v[204:207], a[4:7], a[92:95], v[204:207]
    ds_read_b64_tr_b16 a[20:21], v29 offset:45056
    s_add_u32 s59, s59, s61
    v_mfma_f32_16x16x32_bf16 v[212:215], a[4:7], a[96:99], v[212:215]
    ds_read_b64_tr_b16 a[22:23], v31 offset:45568
    s_waitcnt lgkmcnt(4)
    v_mfma_f32_16x16x32_bf16 v[176:179], a[8:11], a[92:95], v[176:179]
    ds_read_b64_tr_b16 a[40:41], v30 offset:45056
    buffer_load_dwordx4 v[84:87], v254, s[24:27], s35 offen offset:256 sc1
    v_mfma_f32_16x16x32_bf16 v[184:187], a[8:11], a[96:99], v[184:187]
    ds_read_b64_tr_b16 a[42:43], v28 offset:45568
    s_add_u32 s61, s61, s58
    v_mfma_f32_16x16x32_bf16 v[180:183], a[12:15], a[92:95], v[180:183]
    ds_read_b64_tr_b16 a[44:45], v31 offset:45056
    s_and_b32 s58, s58, -8192
    v_mfma_f32_16x16x32_bf16 v[188:191], a[12:15], a[96:99], v[188:191]
    ds_read_b64_tr_b16 a[46:47], v29 offset:45568
    s_waitcnt vmcnt(19) lgkmcnt(4)
    v_mfma_f32_16x16x32_bf16 v[200:203], a[16:19], a[100:103], v[200:203]
    ds_read_b64_tr_b16 a[0:1], v216 offset:0
    buffer_load_dwordx4 v[88:91], v254, s[24:27], s35 offen offset:2048 sc1
    v_mfma_f32_16x16x32_bf16 v[208:211], a[16:19], a[104:107], v[208:211]
    ds_read_b64_tr_b16 a[2:3], v218 offset:512
    s_add_u32 s58, s58, s61
    v_mfma_f32_16x16x32_bf16 v[204:207], a[20:23], a[100:103], v[204:207]
    ds_read_b64_tr_b16 a[4:5], v217 offset:0
    buffer_load_dwordx4 v[92:95], v254, s[24:27], s35 offen offset:2304 sc1
    v_mfma_f32_16x16x32_bf16 v[212:215], a[20:23], a[104:107], v[212:215]
    ds_read_b64_tr_b16 a[6:7], v219 offset:512
    s_waitcnt lgkmcnt(4)
    v_mfma_f32_16x16x32_bf16 v[176:179], a[40:43], a[100:103], v[176:179]
    ds_read_b64_tr_b16 a[8:9], v218 offset:0
    s_xor_b32 s35, s81, 4096
    v_mfma_f32_16x16x32_bf16 v[184:187], a[40:43], a[104:107], v[184:187]
    ds_read_b64_tr_b16 a[10:11], v216 offset:512
    buffer_load_dwordx4 v[96:99], v254, s[24:27], s35 offen offset:0 sc1
    v_mfma_f32_16x16x32_bf16 v[180:183], a[44:47], a[100:103], v[180:183]
    ds_read_b64_tr_b16 a[12:13], v219 offset:0
    s_add_u32 s58, s58, 16777216
    v_mfma_f32_16x16x32_bf16 v[188:191], a[44:47], a[104:107], v[188:191]
    ds_read_b64_tr_b16 a[14:15], v217 offset:512
    s_waitcnt vmcnt(20) lgkmcnt(4)
    v_mfma_f32_16x16x32_bf16 v[200:203], a[0:3], a[108:111], v[200:203]
    ds_read_b64_tr_b16 a[16:17], v216 offset:4096
    buffer_load_dwordx4 v[100:103], v254, s[24:27], s35 offen offset:256 sc1
    v_mfma_f32_16x16x32_bf16 v[208:211], a[0:3], a[112:115], v[208:211]
    ds_read_b64_tr_b16 a[18:19], v218 offset:4608
    s_add_u32 s59, s59, 21008384
    v_mfma_f32_16x16x32_bf16 v[204:207], a[4:7], a[108:111], v[204:207]
    ds_read_b64_tr_b16 a[20:21], v217 offset:4096
    v_mfma_f32_16x16x32_bf16 v[212:215], a[4:7], a[112:115], v[212:215]
    ds_read_b64_tr_b16 a[22:23], v219 offset:4608
    s_waitcnt lgkmcnt(4)
    v_mfma_f32_16x16x32_bf16 v[176:179], a[8:11], a[108:111], v[176:179]
    ds_read_b64_tr_b16 a[40:41], v218 offset:4096
    buffer_load_dwordx4 v[104:107], v254, s[24:27], s35 offen offset:2048 sc1
    v_mfma_f32_16x16x32_bf16 v[184:187], a[8:11], a[112:115], v[184:187]
    ds_read_b64_tr_b16 a[42:43], v216 offset:4608
    v_mfma_f32_16x16x32_bf16 v[180:183], a[12:15], a[108:111], v[180:183]
    ds_read_b64_tr_b16 a[44:45], v219 offset:4096
    buffer_load_dwordx4 v[108:111], v254, s[24:27], s35 offen offset:2304 sc1
    v_mfma_f32_16x16x32_bf16 v[188:191], a[12:15], a[112:115], v[188:191]
    ds_read_b64_tr_b16 a[46:47], v217 offset:4608
    s_waitcnt vmcnt(21) lgkmcnt(4)
    v_mfma_f32_16x16x32_bf16 v[200:203], a[16:19], a[116:119], v[200:203]
    ds_read_b64_tr_b16 a[0:1], v216 offset:8192
    s_xor_b32 s35, s82, 0
    v_mfma_f32_16x16x32_bf16 v[208:211], a[16:19], a[120:123], v[208:211]
    ds_read_b64_tr_b16 a[2:3], v218 offset:8704
    buffer_load_dwordx4 v[112:115], v254, s[24:27], s35 offen offset:0 sc1
    v_mfma_f32_16x16x32_bf16 v[204:207], a[20:23], a[116:119], v[204:207]
    ds_read_b64_tr_b16 a[4:5], v217 offset:8192
    v_mfma_f32_16x16x32_bf16 v[212:215], a[20:23], a[120:123], v[212:215]
    ds_read_b64_tr_b16 a[6:7], v219 offset:8704
    s_waitcnt lgkmcnt(4)
    v_mfma_f32_16x16x32_bf16 v[176:179], a[40:43], a[116:119], v[176:179]
    ds_read_b64_tr_b16 a[8:9], v218 offset:8192
    buffer_load_dwordx4 v[116:119], v254, s[24:27], s35 offen offset:256 sc1
    v_mfma_f32_16x16x32_bf16 v[184:187], a[40:43], a[120:123], v[184:187]
    ds_read_b64_tr_b16 a[10:11], v216 offset:8704
    v_mfma_f32_16x16x32_bf16 v[180:183], a[44:47], a[116:119], v[180:183]
    ds_read_b64_tr_b16 a[12:13], v219 offset:8192
    v_mfma_f32_16x16x32_bf16 v[188:191], a[44:47], a[120:123], v[188:191]
    ds_read_b64_tr_b16 a[14:15], v217 offset:8704
    s_waitcnt vmcnt(21) lgkmcnt(4)
    v_mfma_f32_16x16x32_bf16 v[200:203], a[0:3], a[124:127], v[200:203]
    ds_read_b64_tr_b16 a[16:17], v216 offset:12288
    buffer_load_dwordx4 v[120:123], v254, s[24:27], s35 offen offset:2048 sc1
    v_mfma_f32_16x16x32_bf16 v[208:211], a[0:3], a[128:131], v[208:211]
    ds_read_b64_tr_b16 a[18:19], v218 offset:12800
    v_mfma_f32_16x16x32_bf16 v[204:207], a[4:7], a[124:127], v[204:207]
    ds_read_b64_tr_b16 a[20:21], v217 offset:12288
    buffer_load_dwordx4 v[124:127], v254, s[24:27], s35 offen offset:2304 sc1
    v_mfma_f32_16x16x32_bf16 v[212:215], a[4:7], a[128:131], v[212:215]
    ds_read_b64_tr_b16 a[22:23], v219 offset:12800
    s_waitcnt lgkmcnt(4)
    v_mfma_f32_16x16x32_bf16 v[176:179], a[8:11], a[124:127], v[176:179]
    ds_read_b64_tr_b16 a[40:41], v218 offset:12288
    s_xor_b32 s35, s82, 4096
    v_mfma_f32_16x16x32_bf16 v[184:187], a[8:11], a[128:131], v[184:187]
    ds_read_b64_tr_b16 a[42:43], v216 offset:12800
    buffer_load_dwordx4 v[128:131], v254, s[24:27], s35 offen offset:0 sc1
    v_mfma_f32_16x16x32_bf16 v[180:183], a[12:15], a[124:127], v[180:183]
    ds_read_b64_tr_b16 a[44:45], v219 offset:12288
    v_mfma_f32_16x16x32_bf16 v[188:191], a[12:15], a[128:131], v[188:191]
    ds_read_b64_tr_b16 a[46:47], v217 offset:12800
    s_waitcnt vmcnt(22) lgkmcnt(4)
    v_mfma_f32_16x16x32_bf16 v[200:203], a[16:19], a[132:135], v[200:203]
    ds_read_b64_tr_b16 a[0:1], v218 offset:16384
    s_waitcnt vmcnt(17)
    v_mfma_f32_16x16x32_bf16 v[208:211], a[16:19], a[136:139], v[208:211]
    ds_read_b64_tr_b16 a[2:3], v216 offset:16896
    v_max3_u32 v20, v48, v52, v56
    v_mfma_f32_16x16x32_bf16 v[204:207], a[20:23], a[132:135], v[204:207]
    ds_read_b64_tr_b16 a[4:5], v219 offset:16384
    v_max_u32 v20, v20, v60
    v_mfma_f32_16x16x32_bf16 v[212:215], a[20:23], a[136:139], v[212:215]
    ds_read_b64_tr_b16 a[6:7], v217 offset:16896
    v_cmp_eq_u32 vcc, -1, v20
    s_waitcnt lgkmcnt(4)
    v_mfma_f32_16x16x32_bf16 v[176:179], a[40:43], a[132:135], v[176:179]
    ds_read_b64_tr_b16 a[8:9], v218 offset:20480
    s_cbranch_vccz L_hback0
L_hspin0:
    s_mov_b32 s98, 0
L_hloop0:
    s_xor_b32 s99, s89, 0
    buffer_load_dwordx4 v[48:51], v254, s[24:27], s99 offen offset:0 sc1
    buffer_load_dwordx4 v[52:55], v254, s[24:27], s99 offen offset:256 sc1
    buffer_load_dwordx4 v[56:59], v254, s[24:27], s99 offen offset:2048 sc1
    buffer_load_dwordx4 v[60:63], v254, s[24:27], s99 offen offset:2304 sc1
    s_xor_b32 s99, s89, 4096
    buffer_load_dwordx4 v[64:67], v254, s[24:27], s99 offen offset:0 sc1
    buffer_load_dwordx4 v[68:71], v254, s[24:27], s99 offen offset:256 sc1
    buffer_load_dwordx4 v[72:75], v254, s[24:27], s99 offen offset:2048 sc1
    buffer_load_dwordx4 v[76:79], v254, s[24:27], s99 offen offset:2304 sc1
    s_xor_b32 s99, s81, 0
    buffer_load_dwordx4 v[80:83], v254, s[24:27], s99 offen offset:0 sc1
    buffer_load_dwordx4 v[84:87], v254, s[24:27], s99 offen offset:256 sc1
    buffer_load_dwordx4 v[88:91], v254, s[24:27], s99 offen offset:2048 sc1
    buffer_load_dwordx4 v[92:95], v254, s[24:27], s99 offen offset:2304 sc1
    s_xor_b32 s99, s81, 4096
    buffer_load_dwordx4 v[96:99], v254, s[24:27], s99 offen offset:0 sc1
    buffer_load_dwordx4 v[100:103], v254, s[24:27], s99 offen offset:256 sc1
    buffer_load_dwordx4 v[104:107], v254, s[24:27], s99 offen offset:2048 sc1
    buffer_load_dwordx4 v[108:111], v254, s[24:27], s99 offen offset:2304 sc1
    s_xor_b32 s99, s82, 0
    buffer_load_dwordx4 v[112:115], v254, s[24:27], s99 offen offset:0 sc1
    buffer_load_dwordx4 v[116:119], v254, s[24:27], s99 offen offset:256 sc1
    buffer_load_dwordx4 v[120:123], v254, s[24:27], s99 offen offset:2048 sc1
    buffer_load_dwordx4 v[124:127], v254, s[24:27], s99 offen offset:2304 sc1
    s_xor_b32 s99, s82, 4096
    buffer_load_dwordx4 v[128:131], v254, s[24:27], s99 offen offset:0 sc1
    buffer_load_dwordx4 v[132:135], v254, s[24:27], s99 offen offset:256 sc1
    buffer_load_dwordx4 v[136:139], v254, s[24:27], s99 offen offset:2048 sc1
    buffer_load_dwordx4 v[140:143], v254, s[24:27], s99 offen offset:2304 sc1
    buffer_load_dwordx2 v[26:27], v221, s[24:27], 0 offen sc1
    s_sub_u32 s62, s62, 1
    s_waitcnt vmcnt(0)
    v_max3_u32 v20, v48, v52, v56
    v_max_u32 v20, v20, v60
    v_cmp_eq_u32 vcc, -1, v20
    s_cbranch_vccz L_hback0
    s_cmp_lg_u32 s98, 0
    s_cbranch_scc1 L_hback0
    v_cmp_ge_u64 vcc, v[26:27], s[44:45]
    v_cmp_le_u64 s[84:85], v[26:27], s[46:47]
    s_and_b64 vcc, vcc, s[84:85]
    s_cmp_eq_u64 vcc, -1
    s_cselect_b32 s98, 1, 0
    s_cmp_gt_i32 s62, 0
    s_cbranch_scc1 L_hloop0
L_hback0:
    v_mfma_f32_16x16x32_bf16 v[184:187], a[40:43], a[136:139], v[184:187]
    ds_read_b64_tr_b16 a[10:11], v216 offset:20992
    buffer_load_dwordx4 v[132:135], v254, s[24:27], s35 offen offset:256 sc1
    v_mfma_f32_16x16x32_bf16 v[180:183], a[44:47], a[132:135], v[180:183]
    ds_read_b64_tr_b16 a[12:13], v219 offset:20480
    buffer_load_dwordx4 v[136:139], v254, s[24:27], s35 offen offset:2048 sc1
    v_mfma_f32_16x16x32_bf16 v[188:191], a[44:47], a[136:139], v[188:191]
    ds_read_b64_tr_b16 a[14:15], v217 offset:20992
    s_barrier
    s_waitcnt lgkmcnt(4)
    v_mfma_f32_16x16x32_bf16 v[176:179], a[0:3], v[48:51], v[176:179]
    ds_read_b64_tr_b16 a[16:17], v218 offset:24576
    s_waitcnt vmcnt(15)
    v_mfma_f32_16x16x32_bf16 v[184:187], a[0:3], v[52:55], v[184:187]
    ds_read_b64_tr_b16 a[18:19], v216 offset:25088
    v_max3_u32 v20, v64, v68, v72
    v_mfma_f32_16x16x32_bf16 v[180:183], a[4:7], v[48:51], v[180:183]
    ds_read_b64_tr_b16 a[20:21], v219 offset:24576
    v_max_u32 v20, v20, v76
    v_mfma_f32_16x16x32_bf16 v[188:191], a[4:7], v[52:55], v[188:191]
    ds_read_b64_tr_b16 a[22:23], v217 offset:25088
    v_cmp_eq_u32 vcc, -1, v20
    s_waitcnt lgkmcnt(4)
    v_mfma_f32_16x16x32_bf16 v[176:179], a[8:11], v[56:59], v[176:179]
    ds_read_b64_tr_b16 a[40:41], v218 offset:28672
    s_cbranch_vccnz L_hspin1
L_hback1:
    v_mfma_f32_16x16x32_bf16 v[184:187], a[8:11], v[60:63], v[184:187]
    ds_read_b64_tr_b16 a[42:43], v216 offset:29184
    buffer_load_dwordx4 v[140:143], v254, s[24:27], s35 offen offset:2304 sc1
    v_mfma_f32_16x16x32_bf16 v[180:183], a[12:15], v[56:59], v[180:183]
    ds_read_b64_tr_b16 a[44:45], v219 offset:28672
    s_add_u32 m0, s51, 49152
    v_mfma_f32_16x16x32_bf16 v[188:191], a[12:15], v[60:63], v[188:191]
    ds_read_b64_tr_b16 a[46:47], v217 offset:29184
    s_waitcnt lgkmcnt(4)
    v_mfma_f32_16x16x32_bf16 v[176:179], a[16:19], v[64:67], v[176:179]
    ds_read_b64_tr_b16 a[0:1], v218 offset:32768
    s_waitcnt vmcnt(12)
    v_mfma_f32_16x16x32_bf16 v[184:187], a[16:19], v[68:71], v[184:187]
    ds_read_b64_tr_b16 a[2:3], v216 offset:33280
    v_max3_u32 v20, v80, v84, v88
    v_mfma_f32_16x16x32_bf16 v[180:183], a[20:23], v[64:67], v[180:183]
    ds_read_b64_tr_b16 a[4:5], v219 offset:32768
    v_max_u32 v20, v20, v92
    v_mfma_f32_16x16x32_bf16 v[188:191], a[20:23], v[68:71], v[188:191]
    ds_read_b64_tr_b16 a[6:7], v217 offset:33280
    v_cmp_eq_u32 vcc, -1, v20
    s_waitcnt lgkmcnt(4)
    v_mfma_f32_16x16x32_bf16 v[176:179], a[40:43], v[72:75], v[176:179]
    ds_read_b64_tr_b16 a[8:9], v218 offset:36864
    s_cbranch_vccnz L_hspin2
L_hback2:
    v_mfma_f32_16x16x32_bf16 v[184:187], a[40:43], v[76:79], v[184:187]
    ds_read_b64_tr_b16 a[10:11], v216 offset:37376
    buffer_load_dwordx4 v1, s[8:11], m0 offen offset:0 sc1 lds
    v_mfma_f32_16x16x32_bf16 v[180:183], a[44:47], v[72:75], v[180:183]
    ds_read_b64_tr_b16 a[12:13], v219 offset:36864
    buffer_load_dwordx4 v1, s[8:11], m0 offen offset:1024 sc1 lds
    v_mfma_f32_16x16x32_bf16 v[188:191], a[44:47], v[76:79], v[188:191]
    ds_read_b64_tr_b16 a[14:15], v217 offset:37376
    s_waitcnt lgkmcnt(4)
    v_mfma_f32_16x16x32_bf16 v[176:179], a[0:3], v[80:83], v[176:179]
    ds_read_b64_tr_b16 a[16:17], v218 offset:40960
    s_waitcnt vmcnt(10)
    v_mfma_f32_16x16x32_bf16 v[184:187], a[0:3], v[84:87], v[184:187]
    ds_read_b64_tr_b16 a[18:19], v216 offset:41472
    v_max3_u32 v20, v96, v100, v104
    v_mfma_f32_16x16x32_bf16 v[180:183], a[4:7], v[80:83], v[180:183]
    ds_read_b64_tr_b16 a[20:21], v219 offset:40960
    v_max_u32 v20, v20, v108
    v_mfma_f32_16x16x32_bf16 v[188:191], a[4:7], v[84:87], v[188:191]
    ds_read_b64_tr_b16 a[22:23], v217 offset:41472
    v_cmp_eq_u32 vcc, -1, v20
    s_waitcnt lgkmcnt(4)
    v_mfma_f32_16x16x32_bf16 v[176:179], a[8:11], v[88:91], v[176:179]
    ds_read_b64_tr_b16 a[40:41], v218 offset:45056
    s_cbranch_vccnz L_hspin3
L_hback3:
    v_mfma_f32_16x16x32_bf16 v[184:187], a[8:11], v[92:95], v[184:187]
    ds_read_b64_tr_b16 a[42:43], v216 offset:45568
    buffer_load_dwordx4 v1, s[8:11], m0 offen offset:2048 sc1 lds
    v_mfma_f32_16x16x32_bf16 v[180:183], a[12:15], v[88:91], v[180:183]
    ds_read_b64_tr_b16 a[44:45], v219 offset:45056
    s_add_u32 m0, s51, 61440
    v_mfma_f32_16x16x32_bf16 v[188:191], a[12:15], v[92:95], v[188:191]
    ds_read_b64_tr_b16 a[46:47], v217 offset:45568
    s_waitcnt lgkmcnt(4)
    v_mfma_f32_16x16x32_bf16 v[176:179], a[16:19], v[96:99], v[176:179]
    ds_read_b64_tr_b16 a[0:1], v218 offset:49152
    s_waitcnt vmcnt(7)
    v_mfma_f32_16x16x32_bf16 v[184:187], a[16:19], v[100:103], v[184:187]
    ds_read_b64_tr_b16 a[2:3], v216 offset:49664
    v_max3_u32 v20, v112, v116, v120
    v_mfma_f32_16x16x32_bf16 v[180:183], a[20:23], v[96:99], v[180:183]
    ds_read_b64_tr_b16 a[4:5], v219 offset:49152
    v_max_u32 v20, v20, v124
    v_mfma_f32_16x16x32_bf16 v[188:191], a[20:23], v[100:103], v[188:191]
    ds_read_b64_tr_b16 a[6:7], v217 offset:49664
    v_cmp_eq_u32 vcc, -1, v20
    s_waitcnt lgkmcnt(4)
    v_mfma_f32_16x16x32_bf16 v[176:179], a[40:43], v[104:107], v[176:179]
    ds_read_b64_tr_b16 a[8:9], v218 offset:53248
    s_cbranch_vccnz L_hspin4
L_hback4:
    v_mfma_f32_16x16x32_bf16 v[184:187], a[40:43], v[108:111], v[184:187]
    ds_read_b64_tr_b16 a[10:11], v216 offset:53760
    buffer_load_dwordx4 v1, s[8:11], m0 offen offset:0 sc1 lds
    v_mfma_f32_16x16x32_bf16 v[180:183], a[44:47], v[104:107], v[180:183]
    ds_read_b64_tr_b16 a[12:13], v219 offset:53248
    buffer_load_dwordx4 v1, s[8:11], m0 offen offset:1024 sc1 lds
    v_mfma_f32_16x16x32_bf16 v[188:191], a[44:47], v[108:111], v[188:191]
    ds_read_b64_tr_b16 a[14:15], v217 offset:53760
    s_waitcnt lgkmcnt(4)
    v_mfma_f32_16x16x32_bf16 v[176:179], a[0:3], v[112:115], v[176:179]
    ds_read_b64_tr_b16 a[16:17], v218 offset:57344
    s_waitcnt vmcnt(5)
    v_mfma_f32_16x16x32_bf16 v[184:187], a[0:3], v[116:119], v[184:187]
    ds_read_b64_tr_b16 a[18:19], v216 offset:57856
    v_max3_u32 v20, v128, v132, v136
    v_mfma_f32_16x16x32_bf16 v[180:183], a[4:7], v[112:115], v[180:183]
    ds_read_b64_tr_b16 a[20:21], v219 offset:57344
    v_max_u32 v20, v20, v140
    v_mfma_f32_16x16x32_bf16 v[188:191], a[4:7], v[116:119], v[188:191]
    ds_read_b64_tr_b16 a[22:23], v217 offset:57856
    v_cmp_eq_u32 vcc, -1, v20
    s_waitcnt lgkmcnt(4)
    v_mfma_f32_16x16x32_bf16 v[176:179], a[8:11], v[120:123], v[176:179]
    ds_read_b64_tr_b16 a[40:41], v218 offset:61440
    s_cbranch_vccnz L_hspin5
L_hback5:
    v_mfma_f32_16x16x32_bf16 v[184:187], a[8:11], v[124:127], v[184:187]
    ds_read_b64_tr_b16 a[42:43], v216 offset:61952
    buffer_load_dwordx4 v1, s[8:11], m0 offen offset:2048 sc1 lds
    v_mfma_f32_16x16x32_bf16 v[180:183], a[12:15], v[120:123], v[180:183]
    ds_read_b64_tr_b16 a[44:45], v219 offset:61440
    s_add_u32 m0, s51, 73728
    v_mfma_f32_16x16x32_bf16 v[188:191], a[12:15], v[124:127], v[188:191]
    ds_read_b64_tr_b16 a[46:47], v217 offset:61952
    s_waitcnt lgkmcnt(4)
    v_mfma_f32_16x16x32_bf16 v[176:179], a[16:19], v[128:131], v[176:179]
    ds_read_b64_tr_b16 a[0:1], v216 offset:16384
    buffer_load_dwordx4 v1, s[8:11], m0 offen offset:0 sc1 lds
    v_mfma_f32_16x16x32_bf16 v[184:187], a[16:19], v[132:135], v[184:187]
    ds_read_b64_tr_b16 a[2:3], v218 offset:16896
    buffer_load_dwordx4 v1, s[8:11], m0 offen offset:1024 sc1 lds
    v_mfma_f32_16x16x32_bf16 v[180:183], a[20:23], v[128:131], v[180:183]
    ds_read_b64_tr_b16 a[4:5], v217 offset:16384
    buffer_load_dwordx4 v1, s[8:11], m0 offen offset:2048 sc1 lds
    v_mfma_f32_16x16x32_bf16 v[188:191], a[20:23], v[132:135], v[188:191]
    ds_read_b64_tr_b16 a[6:7], v219 offset:16896
    s_waitcnt lgkmcnt(4)
    v_mfma_f32_16x16x32_bf16 v[176:179], a[40:43], v[136:139], v[176:179]
    ds_read_b64_tr_b16 a[8:9], v216 offset:20480
    v_mfma_f32_16x16x32_bf16 v[184:187], a[40:43], v[140:143], v[184:187]
    ds_read_b64_tr_b16 a[10:11], v218 offset:20992
    v_mfma_f32_16x16x32_bf16 v[180:183], a[44:47], v[136:139], v[180:183]
    ds_read_b64_tr_b16 a[12:13], v217 offset:20480
    v_mfma_f32_16x16x32_bf16 v[188:191], a[44:47], v[140:143], v[188:191]
    ds_read_b64_tr_b16 a[14:15], v219 offset:20992
    s_waitcnt lgkmcnt(4)
    v_mfma_f32_16x16x32_bf16 v[200:203], a[0:3], v[48:51], v[200:203]
    ds_read_b64_tr_b16 a[16:17], v216 offset:24576
    v_mfma_f32_16x16x32_bf16 v[208:211], a[0:3], v[52:55], v[208:211]
    ds_read_b64_tr_b16 a[18:19], v218 offset:25088
    v_mfma_f32_16x16x32_bf16 v[204:207], a[4:7], v[48:51], v[204:207]
    ds_read_b64_tr_b16 a[20:21], v217 offset:24576
    v_bfi_b32 v176, v223, v222, v176
    v_mfma_f32_16x16x32_bf16 v[212:215], a[4:7], v[52:55], v[212:215]
    ds_read_b64_tr_b16 a[22:23], v219 offset:25088
    s_waitcnt lgkmcnt(4)
    v_mfma_f32_16x16x32_bf16 v[200:203], a[8:11], v[56:59], v[200:203]
    ds_read_b64_tr_b16 a[40:41], v216 offset:28672
    v_bfi_b32 v184, v223, v222, v184
    v_mfma_f32_16x16x32_bf16 v[208:211], a[8:11], v[60:63], v[208:211]
    ds_read_b64_tr_b16 a[42:43], v218 offset:29184
    buffer_store_dwordx4 v[176:179], v1, s[24:27], s7 offen offset:0 sc1
    v_mfma_f32_16x16x32_bf16 v[204:207], a[12:15], v[56:59], v[204:207]
    ds_read_b64_tr_b16 a[44:45], v217 offset:28672
    v_bfi_b32 v180, v223, v222, v180
    v_mfma_f32_16x16x32_bf16 v[212:215], a[12:15], v[60:63], v[212:215]
    ds_read_b64_tr_b16 a[46:47], v219 offset:29184
    s_waitcnt lgkmcnt(4)
    v_mfma_f32_16x16x32_bf16 v[200:203], a[16:19], v[64:67], v[200:203]
    ds_read_b64_tr_b16 a[0:1], v216 offset:32768
    buffer_store_dwordx4 v[184:187], v1, s[24:27], s7 offen offset:2048 sc1
    v_mfma_f32_16x16x32_bf16 v[208:211], a[16:19], v[68:71], v[208:211]
    ds_read_b64_tr_b16 a[2:3], v218 offset:33280
    v_bfi_b32 v188, v223, v222, v188
    v_mfma_f32_16x16x32_bf16 v[204:207], a[20:23], v[64:67], v[204:207]
    ds_read_b64_tr_b16 a[4:5], v217 offset:32768
    buffer_store_dwordx4 v[180:183], v1, s[24:27], s7 offen offset:1024 sc1
    v_mfma_f32_16x16x32_bf16 v[212:215], a[20:23], v[68:71], v[212:215]
    ds_read_b64_tr_b16 a[6:7], v219 offset:33280
    s_waitcnt lgkmcnt(4)
    v_mfma_f32_16x16x32_bf16 v[200:203], a[40:43], v[72:75], v[200:203]
    ds_read_b64_tr_b16 a[8:9], v216 offset:36864
    buffer_store_dwordx4 v[188:191], v1, s[24:27], s7 offen offset:3072 sc1
    v_mfma_f32_16x16x32_bf16 v[208:211], a[40:43], v[76:79], v[208:211]
    ds_read_b64_tr_b16 a[10:11], v218 offset:37376
    v_mfma_f32_16x16x32_bf16 v[204:207], a[44:47], v[72:75], v[204:207]
    ds_read_b64_tr_b16 a[12:13], v217 offset:36864
    v_mfma_f32_16x16x32_bf16 v[212:215], a[44:47], v[76:79], v[212:215]
    ds_read_b64_tr_b16 a[14:15], v219 offset:37376
    s_waitcnt lgkmcnt(4)
    v_mfma_f32_16x16x32_bf16 v[200:203], a[0:3], v[80:83], v[200:203]
    ds_read_b64_tr_b16 a[16:17], v216 offset:40960
    v_mfma_f32_16x16x32_bf16 v[208:211], a[0:3], v[84:87], v[208:211]
    ds_read_b64_tr_b16 a[18:19], v218 offset:41472
    v_mfma_f32_16x16x32_bf16 v[204:207], a[4:7], v[80:83], v[204:207]
    ds_read_b64_tr_b16 a[20:21], v217 offset:40960
    v_mfma_f32_16x16x32_bf16 v[212:215], a[4:7], v[84:87], v[212:215]
    ds_read_b64_tr_b16 a[22:23], v219 offset:41472
    s_waitcnt lgkmcnt(4)
    v_mfma_f32_16x16x32_bf16 v[200:203], a[8:11], v[88:91], v[200:203]
    ds_read_b64_tr_b16 a[40:41], v216 offset:45056
    v_mfma_f32_16x16x32_bf16 v[208:211], a[8:11], v[92:95], v[208:211]
    ds_read_b64_tr_b16 a[42:43], v218 offset:45568
    v_mfma_f32_16x16x32_bf16 v[204:207], a[12:15], v[88:91], v[204:207]
    ds_read_b64_tr_b16 a[44:45], v217 offset:45056
    v_mfma_f32_16x16x32_bf16 v[212:215], a[12:15], v[92:95], v[212:215]
    ds_read_b64_tr_b16 a[46:47], v219 offset:45568
    s_waitcnt lgkmcnt(4)
    v_mfma_f32_16x16x32_bf16 v[200:203], a[16:19], v[96:99], v[200:203]
    ds_read_b64_tr_b16 a[0:1], v216 offset:49152
    v_mfma_f32_16x16x32_bf16 v[208:211], a[16:19], v[100:103], v[208:211]
    ds_read_b64_tr_b16 a[2:3], v218 offset:49664
    v_mfma_f32_16x16x32_bf16 v[204:207], a[20:23], v[96:99], v[204:207]
    ds_read_b64_tr_b16 a[4:5], v217 offset:49152
    buffer_load_dwordx4 v[32:35], v1, s[24:27], s32 offen offset:0 sc1
    v_mfma_f32_16x16x32_bf16 v[212:215], a[20:23], v[100:103], v[212:215]
    ds_read_b64_tr_b16 a[6:7], v219 offset:49664
    s_waitcnt lgkmcnt(4)
    v_mfma_f32_16x16x32_bf16 v[200:203], a[40:43], v[104:107], v[200:203]
    ds_read_b64_tr_b16 a[8:9], v216 offset:53248
    buffer_load_dwordx4 v[36:39], v1, s[24:27], s32 offen offset:1024 sc1
    v_mfma_f32_16x16x32_bf16 v[208:211], a[40:43], v[108:111], v[208:211]
    ds_read_b64_tr_b16 a[10:11], v218 offset:53760
    buffer_load_dwordx4 v[40:43], v1, s[24:27], s32 offen offset:2048 sc1
    v_mfma_f32_16x16x32_bf16 v[204:207], a[44:47], v[104:107], v[204:207]
    ds_read_b64_tr_b16 a[12:13], v217 offset:53248
    buffer_load_dwordx4 v[44:47], v1, s[24:27], s32 offen offset:3072 sc1
    v_mfma_f32_16x16x32_bf16 v[212:215], a[44:47], v[108:111], v[212:215]
    ds_read_b64_tr_b16 a[14:15], v219 offset:53760
    s_waitcnt lgkmcnt(4)
    v_mfma_f32_16x16x32_bf16 v[200:203], a[0:3], v[112:115], v[200:203]
    ds_read_b64_tr_b16 a[16:17], v216 offset:57344
    v_mfma_f32_16x16x32_bf16 v[208:211], a[0:3], v[116:119], v[208:211]
    ds_read_b64_tr_b16 a[18:19], v218 offset:57856
    v_mfma_f32_16x16x32_bf16 v[204:207], a[4:7], v[112:115], v[204:207]
    ds_read_b64_tr_b16 a[20:21], v217 offset:57344
    v_mfma_f32_16x16x32_bf16 v[212:215], a[4:7], v[116:119], v[212:215]
    ds_read_b64_tr_b16 a[22:23], v219 offset:57856
    s_waitcnt lgkmcnt(4)
    v_mfma_f32_16x16x32_bf16 v[200:203], a[8:11], v[120:123], v[200:203]
    ds_read_b64_tr_b16 a[40:41], v216 offset:61440
    v_mfma_f32_16x16x32_bf16 v[208:211], a[8:11], v[124:127], v[208:211]
    ds_read_b64_tr_b16 a[42:43], v218 offset:61952
    v_mfma_f32_16x16x32_bf16 v[204:207], a[12:15], v[120:123], v[204:207]
    ds_read_b64_tr_b16 a[44:45], v217 offset:61440
    v_mfma_f32_16x16x32_bf16 v[212:215], a[12:15], v[124:127], v[212:215]
    ds_read_b64_tr_b16 a[46:47], v219 offset:61952
    s_waitcnt lgkmcnt(4)
    v_mfma_f32_16x16x32_bf16 v[200:203], a[16:19], v[128:131], v[200:203]
    v_mfma_f32_16x16x32_bf16 v[208:211], a[16:19], v[132:135], v[208:211]
    v_mfma_f32_16x16x32_bf16 v[204:207], a[20:23], v[128:131], v[204:207]
    v_mfma_f32_16x16x32_bf16 v[212:215], a[20:23], v[132:135], v[212:215]
    s_waitcnt lgkmcnt(0)
    v_mfma_f32_16x16x32_bf16 v[200:203], a[40:43], v[136:139], v[200:203]
    v_mfma_f32_16x16x32_bf16 v[208:211], a[40:43], v[140:143], v[208:211]
    v_mfma_f32_16x16x32_bf16 v[204:207], a[44:47], v[136:139], v[204:207]
    v_mfma_f32_16x16x32_bf16 v[212:215], a[44:47], v[140:143], v[212:215]
    s_waitcnt vmcnt(0)
    v_bitop3_b32 v24, v32, v36, v222 bitop3:0x7e
    v_bitop3_b32 v25, v40, v44, v222 bitop3:0x7e
    v_or_b32 v24, v24, v25
    v_and_b32 v24, 0xfff, v24
    v_cmp_ne_u32 vcc, 0, v24
    s_cbranch_vccz L_rback
L_rspin:
    buffer_load_dwordx4 v[32:35], v1, s[24:27], s32 offen offset:0 sc1
    buffer_load_dwordx4 v[36:39], v1, s[24:27], s32 offen offset:1024 sc1
    buffer_load_dwordx4 v[40:43], v1, s[24:27], s32 offen offset:2048 sc1
    buffer_load_dwordx4 v[44:47], v1, s[24:27], s32 offen offset:3072 sc1
    s_sub_u32 s62, s62, 1
    s_waitcnt vmcnt(0)
    v_bitop3_b32 v24, v32, v36, v222 bitop3:0x7e
    v_bitop3_b32 v25, v40, v44, v222 bitop3:0x7e
    v_or_b32 v24, v24, v25
    v_and_b32 v24, 0xfff, v24
    v_cmp_ne_u32 vcc, 0, v24
    s_cmp_le_i32 s62, 0
    s_cbranch_scc1 L_rback
    s_cbranch_vccnz L_rspin
L_rback:
    v_pk_add_f32 v[200:201], v[200:201], v[32:33]
    v_pk_add_f32 v[202:203], v[202:203], v[34:35]
    v_cvt_pk_bf16_f32 v48, v200, v201
    v_cvt_pk_bf16_f32 v49, v202, v203
    v_pk_add_f32 v[204:205], v[204:205], v[36:37]
    v_pk_add_f32 v[206:207], v[206:207], v[38:39]
    v_cvt_pk_bf16_f32 v50, v204, v205
    v_cvt_pk_bf16_f32 v51, v206, v207
    v_pk_add_f32 v[208:209], v[208:209], v[40:41]
    v_pk_add_f32 v[210:211], v[210:211], v[42:43]
    v_cvt_pk_bf16_f32 v52, v208, v209
    v_cvt_pk_bf16_f32 v53, v210, v211
    v_pk_add_f32 v[212:213], v[212:213], v[44:45]
    v_pk_add_f32 v[214:215], v[214:215], v[46:47]
    v_cvt_pk_bf16_f32 v54, v212, v213
    v_cvt_pk_bf16_f32 v55, v214, v215
    s_cmp_lg_u32 s40, 0
    s_cbranch_scc0 L_cont
    v_and_b32 v18, 16, v0
    v_lshrrev_b32 v19, 5, v0
    v_lshlrev_b32 v18, 1, v18
    v_lshl_add_u32 v18, v19, 4, v18
    v_and_b32 v19, 0xfffffc00, v17
    v_add_u32 v18, v18, v19
    s_add_u32 s58, s91, 16384
    v_permlane16_swap_b32 v48, v50
    v_permlane16_swap_b32 v49, v51
    v_permlane16_swap_b32 v52, v54
    v_permlane16_swap_b32 v53, v55
    buffer_store_dwordx4 v[48:51], v18, s[28:31], s91 offen sc1
    buffer_store_dwordx4 v[52:55], v18, s[28:31], s58 offen sc1
    s_endpgm
L_cont:
    buffer_store_dwordx4 v[48:51], v1, s[24:27], s58 offen sc1
    buffer_store_dwordx4 v[52:55], v1, s[24:27], s58 offen offset:1024 sc1
    v_dot2_f32_bf16 v56, v48, s90, 0
    v_dot2_f32_bf16 v57, v48, v48, 0
    v_dot2_f32_bf16 v58, v52, s90, 0
    v_dot2_f32_bf16 v59, v52, v52, 0
    v_dot2_f32_bf16 v56, v49, s90, v56
    v_dot2_f32_bf16 v57, v49, v49, v57
    v_dot2_f32_bf16 v58, v53, s90, v58
    v_dot2_f32_bf16 v59, v53, v53, v59
    v_dot2_f32_bf16 v56, v50, s90, v56
    v_dot2_f32_bf16 v57, v50, v50, v57
    v_dot2_f32_bf16 v58, v54, s90, v58
    v_dot2_f32_bf16 v59, v54, v54, v59
    v_dot2_f32_bf16 v56, v51, s90, v56
    v_dot2_f32_bf16 v57, v51, v51, v57
    v_dot2_f32_bf16 v58, v55, s90, v58
    v_dot2_f32_bf16 v59, v55, v55, v59
    v_lshlrev_b32 v60, 3, v0
    s_nop 1
    v_permlane16_swap_b32 v56, v58
    v_permlane16_swap_b32 v57, v59
    v_add_f32 v56, v56, v58
    v_add_f32 v57, v57, v59
    v_mov_b32 v58, v56
    v_mov_b32 v59, v57
    s_nop 1
    v_permlane32_swap_b32 v56, v58
    v_permlane32_swap_b32 v57, v59
    v_add_f32 v56, v56, v58
    v_add_f32 v57, v57, v59
    s_mov_b32 exec_hi, 0
    buffer_store_dwordx2 v[56:57], v60, s[24:27], s59 offen sc1
    s_mov_b32 exec_hi, -1
    s_add_u32 m0, s51, 86016
    s_nop 0
    buffer_load_dwordx4 v1, s[8:11], m0 offen offset:0 sc1 lds
    buffer_load_dwordx4 v1, s[8:11], m0 offen offset:1024 sc1 lds
    buffer_load_dwordx4 v1, s[8:11], m0 offen offset:2048 sc1 lds
    s_add_u32 m0, s51, 0
    s_nop 0
    buffer_load_dwordx4 v1, s[8:11], m0 offen offset:0 sc1 lds
    buffer_load_dwordx4 v1, s[8:11], m0 offen offset:1024 sc1 lds
    buffer_load_dwordx4 v1, s[8:11], m0 offen offset:2048 sc1 lds
    s_barrier
    s_add_u32 m0, s51, 12288
    s_nop 0
    buffer_load_dwordx4 v1, s[8:11], m0 offen offset:0 sc1 lds
    buffer_load_dwordx4 v1, s[8:11], m0 offen offset:1024 sc1 lds
    buffer_load_dwordx4 v1, s[8:11], m0 offen offset:2048 sc1 lds
    s_add_u32 m0, s51, 24576
    s_nop 0
    buffer_load_dwordx4 v1, s[8:11], m0 offen offset:0 sc1 lds
    buffer_load_dwordx4 v1, s[8:11], m0 offen offset:1024 sc1 lds
    buffer_load_dwordx4 v1, s[8:11], m0 offen offset:2048 sc1 lds
    s_add_u32 m0, s51, 36864
    s_nop 0
    buffer_load_dwordx4 v1, s[8:11], m0 offen offset:0 sc1 lds
    buffer_load_dwordx4 v1, s[8:11], m0 offen offset:1024 sc1 lds
    buffer_load_dwordx4 v1, s[8:11], m0 offen offset:2048 sc1 lds
    v_and_b32 v18, 15, v0
    v_lshrrev_b32 v19, 2, v18
    v_lshrrev_b32 v20, 4, v0
    v_lshl_add_u32 v19, v20, 2, v19
    v_mul_u32_u24 v19, 192, v19
    v_and_b32 v18, 3, v18
    v_lshl_add_u32 v19, v18, 3, v19
    v_lshrrev_b32 v18, 5, v0
    v_xor_b32 v20, v20, v18
    v_xor_b32 v20, s63, v20
    v_and_b32 v20, 1, v20
    v_lshl_add_u32 v28, v20, 5, v19
    v_xor_b32 v29, 32, v28
    v_add_u32 v30, 49152, v28
    v_add_u32 v31, 49152, v29
    v_lshrrev_b32 v20, 5, v0
    v_and_b32 v21, 31, v0
    v_lshlrev_b32 v20, 11, v20
    s_lshl_b32 s93, s48, 16
    v_lshl_add_u32 v20, v21, 3, v20
    s_add_u32 s93, s93, s39
    s_add_u32 s93, s93, 21008384
    s_lshl_b32 s61, s48, 16
    s_add_u32 s61, s61, s39
    s_add_u32 s61, s61, 16777216
    s_lshl_b32 s60, s50, 11
    s_and_b32 s34, s60, -8192
    s_add_u32 s34, s34, s60
    s_lshl_b32 s60, s49, 16
    s_add_u32 s34, s34, s60
    s_add_u32 s34, s34, s39
    s_add_u32 s34, s34, 16777216
    s_mov_b32 s10, 0
    s_mov_b32 s40, 1
    s_mov_b32 s41, 6
    s_add_u32 s39, s39, 50331648
    s_add_u32 s44, s42, s41
    s_mov_b32 s45, s43
    s_add_u32 s44, s44, 0
    v_mov_b32 v19, s45
    v_mov_b32 v18, s44
    s_waitcnt vmcnt(16)
    s_add_u32 s59, s61, 32768
    buffer_load_dwordx4 v[96:99], v1, s[24:27], s59 offen offset:0 sc1
    buffer_load_dwordx4 v[100:103], v1, s[24:27], s59 offen offset:1024 sc1
    buffer_load_dwordx4 v[104:107], v1, s[24:27], s59 offen offset:2048 sc1
    buffer_load_dwordx4 v[108:111], v1, s[24:27], s59 offen offset:3072 sc1
    s_add_u32 s59, s61, 36864
    buffer_load_dwordx4 v[112:115], v1, s[24:27], s59 offen offset:0 sc1
    buffer_load_dwordx4 v[116:119], v1, s[24:27], s59 offen offset:1024 sc1
    buffer_load_dwordx4 v[120:123], v1, s[24:27], s59 offen offset:2048 sc1
    buffer_load_dwordx4 v[124:127], v1, s[24:27], s59 offen offset:3072 sc1
    s_mov_b64 exec, 1
    buffer_store_dwordx2 v[18:19], off, s[24:27], s5 sc1
    s_mov_b64 exec, -1
    s_waitcnt vmcnt(21)
    s_barrier
    ds_read_b64_tr_b16 a[8:9], v30 offset:64
    ds_read_b64_tr_b16 a[10:11], v30 offset:3136
    ds_read_b64_tr_b16 a[12:13], v31 offset:64
    ds_read_b64_tr_b16 a[14:15], v31 offset:3136
    ds_read_b64_tr_b16 a[16:17], v30 offset:128
    ds_read_b64_tr_b16 a[18:19], v30 offset:3200
    ds_read_b64_tr_b16 a[20:21], v31 offset:128
    ds_read_b64_tr_b16 a[22:23], v31 offset:3200
    ds_read_b64_tr_b16 a[0:1], v30 offset:0
    ds_read_b64_tr_b16 a[2:3], v30 offset:3072
    ds_read_b64_tr_b16 a[4:5], v31 offset:0
    ds_read_b64_tr_b16 a[6:7], v31 offset:3072
    s_waitcnt vmcnt(5)
    v_max3_u32 v21, v96, v100, v104
    v_max_u32 v21, v21, v108
    v_cmp_eq_u32 vcc, -1, v21
    s_cbranch_vccnz L_dsp_x2_0
L_dbk_x2_0:
    s_waitcnt lgkmcnt(8)
    v_mfma_f32_16x16x32_bf16 v[48:51], a[8:11], v[96:99], 0
    ds_read_b64_tr_b16 a[32:33], v30 offset:6208
    v_mfma_f32_16x16x32_bf16 v[52:55], a[8:11], v[100:103], 0
    ds_read_b64_tr_b16 a[34:35], v30 offset:9280
    s_add_u32 s59, s61, 49152
    v_mfma_f32_16x16x32_bf16 v[56:59], a[12:15], v[96:99], 0
    ds_read_b64_tr_b16 a[36:37], v31 offset:6208
    buffer_load_dwordx4 v[128:131], v1, s[24:27], s59 offen offset:0 sc1
    v_mfma_f32_16x16x32_bf16 v[60:63], a[12:15], v[100:103], 0
    ds_read_b64_tr_b16 a[38:39], v31 offset:9280
    s_waitcnt lgkmcnt(4)
    v_mfma_f32_16x16x32_bf16 v[64:67], v[96:99], a[16:19], 0
    ds_read_b64_tr_b16 a[40:41], v30 offset:6272
    v_mfma_f32_16x16x32_bf16 v[68:71], v[100:103], a[16:19], 0
    ds_read_b64_tr_b16 a[42:43], v30 offset:9344
    v_mfma_f32_16x16x32_bf16 v[72:75], v[96:99], a[20:23], 0
    ds_read_b64_tr_b16 a[44:45], v31 offset:6272
    buffer_load_dwordx4 v[132:135], v1, s[24:27], s59 offen offset:1024 sc1
    v_mfma_f32_16x16x32_bf16 v[76:79], v[100:103], a[20:23], 0
    ds_read_b64_tr_b16 a[46:47], v31 offset:9344
    v_mfma_f32_16x16x32_bf16 v[32:35], a[0:3], v[96:99], 0
    ds_read_b64_tr_b16 a[24:25], v30 offset:6144
    v_mfma_f32_16x16x32_bf16 v[36:39], a[0:3], v[100:103], 0
    ds_read_b64_tr_b16 a[26:27], v30 offset:9216
    v_mfma_f32_16x16x32_bf16 v[40:43], a[4:7], v[96:99], 0
    ds_read_b64_tr_b16 a[28:29], v31 offset:6144
    buffer_load_dwordx4 v[136:139], v1, s[24:27], s59 offen offset:2048 sc1
    v_mfma_f32_16x16x32_bf16 v[44:47], a[4:7], v[100:103], 0
    ds_read_b64_tr_b16 a[30:31], v31 offset:9216
    s_waitcnt lgkmcnt(8)
    v_mfma_f32_16x16x32_bf16 v[48:51], a[32:35], v[104:107], v[48:51]
    ds_read_b64_tr_b16 a[8:9], v30 offset:12352
    v_mfma_f32_16x16x32_bf16 v[52:55], a[32:35], v[108:111], v[52:55]
    ds_read_b64_tr_b16 a[10:11], v30 offset:15424
    v_mfma_f32_16x16x32_bf16 v[56:59], a[36:39], v[104:107], v[56:59]
    ds_read_b64_tr_b16 a[12:13], v31 offset:12352
    buffer_load_dwordx4 v[140:143], v1, s[24:27], s59 offen offset:3072 sc1
    v_mfma_f32_16x16x32_bf16 v[60:63], a[36:39], v[108:111], v[60:63]
    ds_read_b64_tr_b16 a[14:15], v31 offset:15424
    s_waitcnt lgkmcnt(4)
    v_mfma_f32_16x16x32_bf16 v[64:67], v[104:107], a[40:43], v[64:67]
    ds_read_b64_tr_b16 a[16:17], v30 offset:12416
    v_mfma_f32_16x16x32_bf16 v[68:71], v[108:111], a[40:43], v[68:71]
    ds_read_b64_tr_b16 a[18:19], v30 offset:15488
    s_add_u32 s59, s61, 53248
    v_mfma_f32_16x16x32_bf16 v[72:75], v[104:107], a[44:47], v[72:75]
    ds_read_b64_tr_b16 a[20:21], v31 offset:12416
    buffer_load_dwordx4 v[144:147], v1, s[24:27], s59 offen offset:0 sc1
    v_mfma_f32_16x16x32_bf16 v[76:79], v[108:111], a[44:47], v[76:79]
    ds_read_b64_tr_b16 a[22:23], v31 offset:15488
    v_mfma_f32_16x16x32_bf16 v[32:35], a[24:27], v[104:107], v[32:35]
    ds_read_b64_tr_b16 a[0:1], v30 offset:12288
    s_waitcnt vmcnt(6)
    v_mfma_f32_16x16x32_bf16 v[36:39], a[24:27], v[108:111], v[36:39]
    ds_read_b64_tr_b16 a[2:3], v30 offset:15360
    v_max3_u32 v21, v112, v116, v120
    v_mfma_f32_16x16x32_bf16 v[40:43], a[28:31], v[104:107], v[40:43]
    ds_read_b64_tr_b16 a[4:5], v31 offset:12288
    v_max_u32 v21, v21, v124
    v_mfma_f32_16x16x32_bf16 v[44:47], a[28:31], v[108:111], v[44:47]
    ds_read_b64_tr_b16 a[6:7], v31 offset:15360
    v_cmp_eq_u32 vcc, -1, v21
    s_cbranch_vccnz L_dsp_x2_1
L_dbk_x2_1:
    s_waitcnt lgkmcnt(8)
    v_mfma_f32_16x16x32_bf16 v[48:51], a[8:11], v[112:115], v[48:51]
    ds_read_b64_tr_b16 a[32:33], v30 offset:18496
    buffer_load_dwordx4 v[148:151], v1, s[24:27], s59 offen offset:1024 sc1
    v_mfma_f32_16x16x32_bf16 v[52:55], a[8:11], v[116:119], v[52:55]
    ds_read_b64_tr_b16 a[34:35], v30 offset:21568
    v_mfma_f32_16x16x32_bf16 v[56:59], a[12:15], v[112:115], v[56:59]
    ds_read_b64_tr_b16 a[36:37], v31 offset:18496
    buffer_load_dwordx4 v[152:155], v1, s[24:27], s59 offen offset:2048 sc1
    v_mfma_f32_16x16x32_bf16 v[60:63], a[12:15], v[116:119], v[60:63]
    ds_read_b64_tr_b16 a[38:39], v31 offset:21568
    s_waitcnt lgkmcnt(4)
    v_mfma_f32_16x16x32_bf16 v[64:67], v[112:115], a[16:19], v[64:67]
    ds_read_b64_tr_b16 a[40:41], v30 offset:18560
    v_mfma_f32_16x16x32_bf16 v[68:71], v[116:119], a[16:19], v[68:71]
    ds_read_b64_tr_b16 a[42:43], v30 offset:21632
    v_mfma_f32_16x16x32_bf16 v[72:75], v[112:115], a[20:23], v[72:75]
    ds_read_b64_tr_b16 a[44:45], v31 offset:18560
    buffer_load_dwordx4 v[156:159], v1, s[24:27], s59 offen offset:3072 sc1
    v_mfma_f32_16x16x32_bf16 v[76:79], v[116:119], a[20:23], v[76:79]
    ds_read_b64_tr_b16 a[46:47], v31 offset:21632
    v_mfma_f32_16x16x32_bf16 v[32:35], a[0:3], v[112:115], v[32:35]
    ds_read_b64_tr_b16 a[24:25], v30 offset:18432
    v_mfma_f32_16x16x32_bf16 v[36:39], a[0:3], v[116:119], v[36:39]
    ds_read_b64_tr_b16 a[26:27], v30 offset:21504
    s_add_u32 s59, s61, 0
    v_mfma_f32_16x16x32_bf16 v[40:43], a[4:7], v[112:115], v[40:43]
    ds_read_b64_tr_b16 a[28:29], v31 offset:18432
    buffer_load_dwordx4 v[160:163], v1, s[24:27], s59 offen offset:0 sc1
    v_mfma_f32_16x16x32_bf16 v[44:47], a[4:7], v[116:119], v[44:47]
    ds_read_b64_tr_b16 a[30:31], v31 offset:21504
    s_waitcnt lgkmcnt(8)
    v_mfma_f32_16x16x32_bf16 v[48:51], a[32:35], v[120:123], v[48:51]
    ds_read_b64_tr_b16 a[8:9], v30 offset:24640
    v_mfma_f32_16x16x32_bf16 v[52:55], a[32:35], v[124:127], v[52:55]
    ds_read_b64_tr_b16 a[10:11], v30 offset:27712
    v_mfma_f32_16x16x32_bf16 v[56:59], a[36:39], v[120:123], v[56:59]
    ds_read_b64_tr_b16 a[12:13], v31 offset:24640
    buffer_load_dwordx4 v[164:167], v1, s[24:27], s59 offen offset:1024 sc1
    v_mfma_f32_16x16x32_bf16 v[60:63], a[36:39], v[124:127], v[60:63]
    ds_read_b64_tr_b16 a[14:15], v31 offset:27712
    s_waitcnt lgkmcnt(4)
    v_mfma_f32_16x16x32_bf16 v[64:67], v[120:123], a[40:43], v[64:67]
    ds_read_b64_tr_b16 a[16:17], v30 offset:24704
    v_mfma_f32_16x16x32_bf16 v[68:71], v[124:127], a[40:43], v[68:71]
    ds_read_b64_tr_b16 a[18:19], v30 offset:27776
    v_mfma_f32_16x16x32_bf16 v[72:75], v[120:123], a[44:47], v[72:75]
    ds_read_b64_tr_b16 a[20:21], v31 offset:24704
    buffer_load_dwordx4 v[168:171], v1, s[24:27], s59 offen offset:2048 sc1
    v_mfma_f32_16x16x32_bf16 v[76:79], v[124:127], a[44:47], v[76:79]
    ds_read_b64_tr_b16 a[22:23], v31 offset:27776
    v_mfma_f32_16x16x32_bf16 v[32:35], a[24:27], v[120:123], v[32:35]
    ds_read_b64_tr_b16 a[0:1], v30 offset:24576
    s_waitcnt vmcnt(7)
    v_mfma_f32_16x16x32_bf16 v[36:39], a[24:27], v[124:127], v[36:39]
    ds_read_b64_tr_b16 a[2:3], v30 offset:27648
    v_max3_u32 v21, v128, v132, v136
    v_mfma_f32_16x16x32_bf16 v[40:43], a[28:31], v[120:123], v[40:43]
    ds_read_b64_tr_b16 a[4:5], v31 offset:24576
    v_max_u32 v21, v21, v140
    v_mfma_f32_16x16x32_bf16 v[44:47], a[28:31], v[124:127], v[44:47]
    ds_read_b64_tr_b16 a[6:7], v31 offset:27648
    v_cmp_eq_u32 vcc, -1, v21
    s_cbranch_vccnz L_dsp_x2_2
L_dbk_x2_2:
    s_waitcnt lgkmcnt(8)
    v_mfma_f32_16x16x32_bf16 v[48:51], a[8:11], v[128:131], v[48:51]
    ds_read_b64_tr_b16 a[32:33], v30 offset:30784
    buffer_load_dwordx4 v[172:175], v1, s[24:27], s59 offen offset:3072 sc1
    v_mfma_f32_16x16x32_bf16 v[52:55], a[8:11], v[132:135], v[52:55]
    ds_read_b64_tr_b16 a[34:35], v30 offset:33856
    s_add_u32 s59, s61, 4096
    v_mfma_f32_16x16x32_bf16 v[56:59], a[12:15], v[128:131], v[56:59]
    ds_read_b64_tr_b16 a[36:37], v31 offset:30784
    buffer_load_dwordx4 v[176:179], v1, s[24:27], s59 offen offset:0 sc1
    v_mfma_f32_16x16x32_bf16 v[60:63], a[12:15], v[132:135], v[60:63]
    ds_read_b64_tr_b16 a[38:39], v31 offset:33856
    s_waitcnt lgkmcnt(4)
    v_mfma_f32_16x16x32_bf16 v[64:67], v[128:131], a[16:19], v[64:67]
    ds_read_b64_tr_b16 a[40:41], v30 offset:30848
    buffer_load_dwordx2 v[80:81], v20, s[24:27], s93 offen offset:0 sc1
    v_mfma_f32_16x16x32_bf16 v[68:71], v[132:135], a[16:19], v[68:71]
    ds_read_b64_tr_b16 a[42:43], v30 offset:33920
    buffer_load_dwordx2 v[82:83], v20, s[24:27], s93 offen offset:256 sc1
    v_mfma_f32_16x16x32_bf16 v[72:75], v[128:131], a[20:23], v[72:75]
    ds_read_b64_tr_b16 a[44:45], v31 offset:30848
    buffer_load_dwordx4 v[180:183], v1, s[24:27], s59 offen offset:1024 sc1
    v_mfma_f32_16x16x32_bf16 v[76:79], v[132:135], a[20:23], v[76:79]
    ds_read_b64_tr_b16 a[46:47], v31 offset:33920
    buffer_load_dwordx2 v[84:85], v20, s[24:27], s93 offen offset:512 sc1
    v_mfma_f32_16x16x32_bf16 v[32:35], a[0:3], v[128:131], v[32:35]
    ds_read_b64_tr_b16 a[24:25], v30 offset:30720
    buffer_load_dwordx2 v[86:87], v20, s[24:27], s93 offen offset:768 sc1
    v_mfma_f32_16x16x32_bf16 v[36:39], a[0:3], v[132:135], v[36:39]
    ds_read_b64_tr_b16 a[26:27], v30 offset:33792
    v_mfma_f32_16x16x32_bf16 v[40:43], a[4:7], v[128:131], v[40:43]
    ds_read_b64_tr_b16 a[28:29], v31 offset:30720
    buffer_load_dwordx4 v[184:187], v1, s[24:27], s59 offen offset:2048 sc1
    v_mfma_f32_16x16x32_bf16 v[44:47], a[4:7], v[132:135], v[44:47]
    ds_read_b64_tr_b16 a[30:31], v31 offset:33792
    s_waitcnt lgkmcnt(8)
    v_mfma_f32_16x16x32_bf16 v[48:51], a[32:35], v[136:139], v[48:51]
    ds_read_b64_tr_b16 a[8:9], v30 offset:36928
    buffer_load_dwordx2 v[88:89], v20, s[24:27], s93 offen offset:1024 sc1
    v_mfma_f32_16x16x32_bf16 v[52:55], a[32:35], v[140:143], v[52:55]
    ds_read_b64_tr_b16 a[10:11], v30 offset:40000
    v_mfma_f32_16x16x32_bf16 v[56:59], a[36:39], v[136:139], v[56:59]
    ds_read_b64_tr_b16 a[12:13], v31 offset:36928
    buffer_load_dwordx4 v[188:191], v1, s[24:27], s59 offen offset:3072 sc1
    v_mfma_f32_16x16x32_bf16 v[60:63], a[36:39], v[140:143], v[60:63]
    ds_read_b64_tr_b16 a[14:15], v31 offset:40000
    s_waitcnt lgkmcnt(4)
    v_mfma_f32_16x16x32_bf16 v[64:67], v[136:139], a[40:43], v[64:67]
    ds_read_b64_tr_b16 a[16:17], v30 offset:36992
    buffer_load_dwordx2 v[90:91], v20, s[24:27], s93 offen offset:1280 sc1
    v_mfma_f32_16x16x32_bf16 v[68:71], v[140:143], a[40:43], v[68:71]
    ds_read_b64_tr_b16 a[18:19], v30 offset:40064
    s_add_u32 s59, s61, 16384
    v_mfma_f32_16x16x32_bf16 v[72:75], v[136:139], a[44:47], v[72:75]
    ds_read_b64_tr_b16 a[20:21], v31 offset:36992
    buffer_load_dwordx4 v[192:195], v1, s[24:27], s59 offen offset:0 sc1
    v_mfma_f32_16x16x32_bf16 v[76:79], v[140:143], a[44:47], v[76:79]
    ds_read_b64_tr_b16 a[22:23], v31 offset:40064
    v_mfma_f32_16x16x32_bf16 v[32:35], a[24:27], v[136:139], v[32:35]
    ds_read_b64_tr_b16 a[0:1], v30 offset:36864
    s_waitcnt vmcnt(15)
    v_mfma_f32_16x16x32_bf16 v[36:39], a[24:27], v[140:143], v[36:39]
    ds_read_b64_tr_b16 a[2:3], v30 offset:39936
    v_max3_u32 v21, v144, v148, v152
    v_mfma_f32_16x16x32_bf16 v[40:43], a[28:31], v[136:139], v[40:43]
    ds_read_b64_tr_b16 a[4:5], v31 offset:36864
    v_max_u32 v21, v21, v156
    v_mfma_f32_16x16x32_bf16 v[44:47], a[28:31], v[140:143], v[44:47]
    ds_read_b64_tr_b16 a[6:7], v31 offset:39936
    v_cmp_eq_u32 vcc, -1, v21
    s_cbranch_vccnz L_dsp_x2_3
L_dbk_x2_3:
    s_waitcnt lgkmcnt(8)
    v_mfma_f32_16x16x32_bf16 v[48:51], a[8:11], v[144:147], v[48:51]
    ds_read_b64_tr_b16 a[32:33], v30 offset:43072
    buffer_load_dwordx4 v[196:199], v1, s[24:27], s59 offen offset:1024 sc1
    v_mfma_f32_16x16x32_bf16 v[52:55], a[8:11], v[148:151], v[52:55]
    ds_read_b64_tr_b16 a[34:35], v30 offset:46144
    buffer_load_dwordx2 v[92:93], v20, s[24:27], s93 offen offset:1536 sc1
    v_mfma_f32_16x16x32_bf16 v[56:59], a[12:15], v[144:147], v[56:59]
    ds_read_b64_tr_b16 a[36:37], v31 offset:43072
    buffer_load_dwordx4 v[200:203], v1, s[24:27], s59 offen offset:2048 sc1
    v_mfma_f32_16x16x32_bf16 v[60:63], a[12:15], v[148:151], v[60:63]
    ds_read_b64_tr_b16 a[38:39], v31 offset:46144
    s_waitcnt lgkmcnt(4)
    v_mfma_f32_16x16x32_bf16 v[64:67], v[144:147], a[16:19], v[64:67]
    ds_read_b64_tr_b16 a[40:41], v30 offset:43136
    buffer_load_dwordx2 v[94:95], v20, s[24:27], s93 offen offset:1792 sc1
    v_mfma_f32_16x16x32_bf16 v[68:71], v[148:151], a[16:19], v[68:71]
    ds_read_b64_tr_b16 a[42:43], v30 offset:46208
    v_mfma_f32_16x16x32_bf16 v[72:75], v[144:147], a[20:23], v[72:75]
    ds_read_b64_tr_b16 a[44:45], v31 offset:43136
    buffer_load_dwordx4 v[204:207], v1, s[24:27], s59 offen offset:3072 sc1
    v_mfma_f32_16x16x32_bf16 v[76:79], v[148:151], a[20:23], v[76:79]
    ds_read_b64_tr_b16 a[46:47], v31 offset:46208
    v_mfma_f32_16x16x32_bf16 v[32:35], a[0:3], v[144:147], v[32:35]
    ds_read_b64_tr_b16 a[24:25], v30 offset:43008
    v_mfma_f32_16x16x32_bf16 v[36:39], a[0:3], v[148:151], v[36:39]
    ds_read_b64_tr_b16 a[26:27], v30 offset:46080
    s_add_u32 s59, s61, 20480
    v_mfma_f32_16x16x32_bf16 v[40:43], a[4:7], v[144:147], v[40:43]
    ds_read_b64_tr_b16 a[28:29], v31 offset:43008
    buffer_load_dwordx4 v[208:211], v1, s[24:27], s59 offen offset:0 sc1
    v_mfma_f32_16x16x32_bf16 v[44:47], a[4:7], v[148:151], v[44:47]
    ds_read_b64_tr_b16 a[30:31], v31 offset:46080
    s_barrier
    s_waitcnt lgkmcnt(8)
    v_mfma_f32_16x16x32_bf16 v[48:51], a[32:35], v[152:155], v[48:51]
    ds_read_b64_tr_b16 a[8:9], v28 offset:64
    v_mfma_f32_16x16x32_bf16 v[52:55], a[32:35], v[156:159], v[52:55]
    ds_read_b64_tr_b16 a[10:11], v28 offset:3136
    v_mfma_f32_16x16x32_bf16 v[56:59], a[36:39], v[152:155], v[56:59]
    ds_read_b64_tr_b16 a[12:13], v29 offset:64
    buffer_load_dwordx4 v[212:215], v1, s[24:27], s59 offen offset:1024 sc1
    v_mfma_f32_16x16x32_bf16 v[60:63], a[36:39], v[156:159], v[60:63]
    ds_read_b64_tr_b16 a[14:15], v29 offset:3136
    s_waitcnt lgkmcnt(4)
    v_mfma_f32_16x16x32_bf16 v[64:67], v[152:155], a[40:43], v[64:67]
    ds_read_b64_tr_b16 a[16:17], v28 offset:128
    v_mfma_f32_16x16x32_bf16 v[68:71], v[156:159], a[40:43], v[68:71]
    ds_read_b64_tr_b16 a[18:19], v28 offset:3200
    v_mfma_f32_16x16x32_bf16 v[72:75], v[152:155], a[44:47], v[72:75]
    ds_read_b64_tr_b16 a[20:21], v29 offset:128
    buffer_load_dwordx4 v[216:219], v1, s[24:27], s59 offen offset:2048 sc1
    v_mfma_f32_16x16x32_bf16 v[76:79], v[156:159], a[44:47], v[76:79]
    ds_read_b64_tr_b16 a[22:23], v29 offset:3200
    v_mfma_f32_16x16x32_bf16 v[32:35], a[24:27], v[152:155], v[32:35]
    ds_read_b64_tr_b16 a[128:129], v28 offset:0
    s_waitcnt vmcnt(19)
    v_mfma_f32_16x16x32_bf16 v[36:39], a[24:27], v[156:159], v[36:39]
    ds_read_b64_tr_b16 a[130:131], v28 offset:3072
    v_max3_u32 v21, v160, v164, v168
    v_mfma_f32_16x16x32_bf16 v[40:43], a[28:31], v[152:155], v[40:43]
    ds_read_b64_tr_b16 a[132:133], v29 offset:0
    v_max_u32 v21, v21, v172
    v_mfma_f32_16x16x32_bf16 v[44:47], a[28:31], v[156:159], v[44:47]
    ds_read_b64_tr_b16 a[134:135], v29 offset:3072
    v_cmp_eq_u32 vcc, -1, v21
    s_cbranch_vccnz L_dsp_x2_4
L_dbk_x2_4:
    s_waitcnt lgkmcnt(8)
    v_mfma_f32_16x16x32_bf16 v[48:51], a[8:11], v[160:163], v[48:51]
    ds_read_b64_tr_b16 a[32:33], v28 offset:6208
    ds_read_b64_tr_b16 a[34:35], v28 offset:9280
    v_mfma_f32_16x16x32_bf16 v[52:55], a[8:11], v[164:167], v[52:55]
    ds_read_b64_tr_b16 a[36:37], v29 offset:6208
    ds_read_b64_tr_b16 a[38:39], v29 offset:9280
    v_mfma_f32_16x16x32_bf16 v[56:59], a[12:15], v[160:163], v[56:59]
    ds_read_b64_tr_b16 a[40:41], v28 offset:6272
    ds_read_b64_tr_b16 a[42:43], v28 offset:9344
    v_mfma_f32_16x16x32_bf16 v[60:63], a[12:15], v[164:167], v[60:63]
    ds_read_b64_tr_b16 a[44:45], v29 offset:6272
    ds_read_b64_tr_b16 a[46:47], v29 offset:9344
    s_waitcnt lgkmcnt(12)
    v_mfma_f32_16x16x32_bf16 v[64:67], v[160:163], a[16:19], v[64:67]
    ds_read_b64_tr_b16 a[136:137], v28 offset:6144
    buffer_load_dwordx4 v[220:223], v1, s[24:27], s59 offen offset:3072 sc1
    v_mfma_f32_16x16x32_bf16 v[68:71], v[164:167], a[16:19], v[68:71]
    ds_read_b64_tr_b16 a[138:139], v28 offset:9216
    v_and_b32 v24, 31, v0
    v_mfma_f32_16x16x32_bf16 v[72:75], v[160:163], a[20:23], v[72:75]
    ds_read_b64_tr_b16 a[140:141], v29 offset:6144
    v_lshrrev_b32 v25, 4, v0
    v_mfma_f32_16x16x32_bf16 v[76:79], v[164:167], a[20:23], v[76:79]
    ds_read_b64_tr_b16 a[142:143], v29 offset:9216
    s_waitcnt lgkmcnt(8)
    v_mfma_f32_16x16x32_bf16 v[48:51], a[32:35], v[168:171], v[48:51]
    ds_read_b64_tr_b16 a[8:9], v28 offset:12352
    ds_read_b64_tr_b16 a[10:11], v28 offset:15424
    v_mfma_f32_16x16x32_bf16 v[52:55], a[32:35], v[172:175], v[52:55]
    ds_read_b64_tr_b16 a[12:13], v29 offset:12352
    ds_read_b64_tr_b16 a[14:15], v29 offset:15424
    v_mfma_f32_16x16x32_bf16 v[56:59], a[36:39], v[168:171], v[56:59]
    ds_read_b64_tr_b16 a[16:17], v28 offset:12416
    ds_read_b64_tr_b16 a[18:19], v28 offset:15488
    v_mfma_f32_16x16x32_bf16 v[60:63], a[36:39], v[172:175], v[60:63]
    ds_read_b64_tr_b16 a[20:21], v29 offset:12416
    ds_read_b64_tr_b16 a[22:23], v29 offset:15488
    s_waitcnt lgkmcnt(12)
    v_mfma_f32_16x16x32_bf16 v[64:67], v[168:171], a[40:43], v[64:67]
    ds_read_b64_tr_b16 a[144:145], v28 offset:12288
    s_waitcnt vmcnt(11)
    v_mfma_f32_16x16x32_bf16 v[68:71], v[172:175], a[40:43], v[68:71]
    ds_read_b64_tr_b16 a[146:147], v28 offset:15360
    v_max3_u32 v21, v176, v180, v184
    v_mfma_f32_16x16x32_bf16 v[72:75], v[168:171], a[44:47], v[72:75]
    ds_read_b64_tr_b16 a[148:149], v29 offset:12288
    v_max_u32 v21, v21, v188
    v_mfma_f32_16x16x32_bf16 v[76:79], v[172:175], a[44:47], v[76:79]
    ds_read_b64_tr_b16 a[150:151], v29 offset:15360
    v_cmp_eq_u32 vcc, -1, v21
    s_cbranch_vccnz L_dsp_x2_5
L_dbk_x2_5:
    s_waitcnt lgkmcnt(8)
    v_mfma_f32_16x16x32_bf16 v[48:51], a[8:11], v[176:179], v[48:51]
    ds_read_b64_tr_b16 a[32:33], v28 offset:18496
    ds_read_b64_tr_b16 a[34:35], v28 offset:21568
    v_mfma_f32_16x16x32_bf16 v[52:55], a[8:11], v[180:183], v[52:55]
    ds_read_b64_tr_b16 a[36:37], v29 offset:18496
    ds_read_b64_tr_b16 a[38:39], v29 offset:21568
    v_mfma_f32_16x16x32_bf16 v[56:59], a[12:15], v[176:179], v[56:59]
    ds_read_b64_tr_b16 a[40:41], v28 offset:18560
    ds_read_b64_tr_b16 a[42:43], v28 offset:21632
    v_mfma_f32_16x16x32_bf16 v[60:63], a[12:15], v[180:183], v[60:63]
    ds_read_b64_tr_b16 a[44:45], v29 offset:18560
    ds_read_b64_tr_b16 a[46:47], v29 offset:21632
    s_waitcnt lgkmcnt(12)
    v_mfma_f32_16x16x32_bf16 v[64:67], v[176:179], a[16:19], v[64:67]
    ds_read_b64_tr_b16 a[152:153], v28 offset:18432
    s_add_u32 s60, s53, 98304
    v_mfma_f32_16x16x32_bf16 v[68:71], v[180:183], a[16:19], v[68:71]
    ds_read_b64_tr_b16 a[154:155], v28 offset:21504
    v_lshl_add_u32 v24, v24, 2, s60
    v_mfma_f32_16x16x32_bf16 v[72:75], v[176:179], a[20:23], v[72:75]
    ds_read_b64_tr_b16 a[156:157], v29 offset:18432
    v_lshl_add_u32 v25, v25, 4, s60
    v_mfma_f32_16x16x32_bf16 v[76:79], v[180:183], a[20:23], v[76:79]
    ds_read_b64_tr_b16 a[158:159], v29 offset:21504
    s_waitcnt lgkmcnt(8)
    v_mfma_f32_16x16x32_bf16 v[48:51], a[32:35], v[184:187], v[48:51]
    ds_read_b64_tr_b16 a[8:9], v28 offset:24640
    ds_read_b64_tr_b16 a[10:11], v28 offset:27712
    v_mfma_f32_16x16x32_bf16 v[52:55], a[32:35], v[188:191], v[52:55]
    ds_read_b64_tr_b16 a[12:13], v29 offset:24640
    ds_read_b64_tr_b16 a[14:15], v29 offset:27712
    v_mfma_f32_16x16x32_bf16 v[56:59], a[36:39], v[184:187], v[56:59]
    ds_read_b64_tr_b16 a[16:17], v28 offset:24704
    ds_read_b64_tr_b16 a[18:19], v28 offset:27776
    v_mfma_f32_16x16x32_bf16 v[60:63], a[36:39], v[188:191], v[60:63]
    ds_read_b64_tr_b16 a[20:21], v29 offset:24704
    ds_read_b64_tr_b16 a[22:23], v29 offset:27776
    s_waitcnt lgkmcnt(12)
    v_mfma_f32_16x16x32_bf16 v[64:67], v[184:187], a[40:43], v[64:67]
    ds_read_b64_tr_b16 a[160:161], v28 offset:24576
    s_waitcnt vmcnt(4)
    v_mfma_f32_16x16x32_bf16 v[68:71], v[188:191], a[40:43], v[68:71]
    ds_read_b64_tr_b16 a[162:163], v28 offset:27648
    v_max3_u32 v21, v192, v196, v200
    v_mfma_f32_16x16x32_bf16 v[72:75], v[184:187], a[44:47], v[72:75]
    ds_read_b64_tr_b16 a[164:165], v29 offset:24576
    v_max_u32 v21, v21, v204
    v_mfma_f32_16x16x32_bf16 v[76:79], v[188:191], a[44:47], v[76:79]
    ds_read_b64_tr_b16 a[166:167], v29 offset:27648
    v_cmp_eq_u32 vcc, -1, v21
    s_cbranch_vccnz L_dsp_x2_6
L_dbk_x2_6:
    s_waitcnt lgkmcnt(8)
    v_mfma_f32_16x16x32_bf16 v[48:51], a[8:11], v[192:195], v[48:51]
    ds_read_b64_tr_b16 a[32:33], v28 offset:30784
    ds_read_b64_tr_b16 a[34:35], v28 offset:33856
    v_mfma_f32_16x16x32_bf16 v[52:55], a[8:11], v[196:199], v[52:55]
    ds_read_b64_tr_b16 a[36:37], v29 offset:30784
    ds_read_b64_tr_b16 a[38:39], v29 offset:33856
    v_mfma_f32_16x16x32_bf16 v[56:59], a[12:15], v[192:195], v[56:59]
    ds_read_b64_tr_b16 a[40:41], v28 offset:30848
    ds_read_b64_tr_b16 a[42:43], v28 offset:33920
    v_mfma_f32_16x16x32_bf16 v[60:63], a[12:15], v[196:199], v[60:63]
    ds_read_b64_tr_b16 a[44:45], v29 offset:30848
    ds_read_b64_tr_b16 a[46:47], v29 offset:33920
    s_waitcnt lgkmcnt(12)
    v_mfma_f32_16x16x32_bf16 v[64:67], v[192:195], a[16:19], v[64:67]
    ds_read_b64_tr_b16 a[168:169], v28 offset:30720
    v_mfma_f32_16x16x32_bf16 v[68:71], v[196:199], a[16:19], v[68:71]
    ds_read_b64_tr_b16 a[170:171], v28 offset:33792
    v_add_f32 v80, v80, v88
    v_mfma_f32_16x16x32_bf16 v[72:75], v[192:195], a[20:23], v[72:75]
    ds_read_b64_tr_b16 a[172:173], v29 offset:30720
    v_add_f32 v81, v81, v89
    v_mfma_f32_16x16x32_bf16 v[76:79], v[196:199], a[20:23], v[76:79]
    ds_read_b64_tr_b16 a[174:175], v29 offset:33792
    s_waitcnt lgkmcnt(8)
    v_mfma_f32_16x16x32_bf16 v[48:51], a[32:35], v[200:203], v[48:51]
    ds_read_b64_tr_b16 a[8:9], v28 offset:36928
    ds_read_b64_tr_b16 a[10:11], v28 offset:40000
    v_mfma_f32_16x16x32_bf16 v[52:55], a[32:35], v[204:207], v[52:55]
    ds_read_b64_tr_b16 a[12:13], v29 offset:36928
    ds_read_b64_tr_b16 a[14:15], v29 offset:40000
    v_mfma_f32_16x16x32_bf16 v[56:59], a[36:39], v[200:203], v[56:59]
    ds_read_b64_tr_b16 a[16:17], v28 offset:36992
    ds_read_b64_tr_b16 a[18:19], v28 offset:40064
    v_mfma_f32_16x16x32_bf16 v[60:63], a[36:39], v[204:207], v[60:63]
    ds_read_b64_tr_b16 a[20:21], v29 offset:36992
    ds_read_b64_tr_b16 a[22:23], v29 offset:40064
    s_waitcnt lgkmcnt(12)
    v_mfma_f32_16x16x32_bf16 v[64:67], v[200:203], a[40:43], v[64:67]
    ds_read_b64_tr_b16 a[176:177], v28 offset:36864
    s_waitcnt vmcnt(0)
    v_mfma_f32_16x16x32_bf16 v[68:71], v[204:207], a[40:43], v[68:71]
    ds_read_b64_tr_b16 a[178:179], v28 offset:39936
    v_max3_u32 v21, v208, v212, v216
    v_mfma_f32_16x16x32_bf16 v[72:75], v[200:203], a[44:47], v[72:75]
    ds_read_b64_tr_b16 a[180:181], v29 offset:36864
    v_max_u32 v21, v21, v220
    v_mfma_f32_16x16x32_bf16 v[76:79], v[204:207], a[44:47], v[76:79]
    ds_read_b64_tr_b16 a[182:183], v29 offset:39936
    v_cmp_eq_u32 vcc, -1, v21
    s_cbranch_vccnz L_dsp_x2_7
L_dbk_x2_7:
    s_waitcnt lgkmcnt(8)
    v_mfma_f32_16x16x32_bf16 v[48:51], a[8:11], v[208:211], v[48:51]
    ds_read_b64_tr_b16 a[32:33], v28 offset:43072
    ds_read_b64_tr_b16 a[34:35], v28 offset:46144
    v_mfma_f32_16x16x32_bf16 v[52:55], a[8:11], v[212:215], v[52:55]
    ds_read_b64_tr_b16 a[36:37], v29 offset:43072
    ds_read_b64_tr_b16 a[38:39], v29 offset:46144
    v_mfma_f32_16x16x32_bf16 v[56:59], a[12:15], v[208:211], v[56:59]
    ds_read_b64_tr_b16 a[40:41], v28 offset:43136
    ds_read_b64_tr_b16 a[42:43], v28 offset:46208
    v_mfma_f32_16x16x32_bf16 v[60:63], a[12:15], v[212:215], v[60:63]
    ds_read_b64_tr_b16 a[44:45], v29 offset:43136
    ds_read_b64_tr_b16 a[46:47], v29 offset:46208
    s_waitcnt lgkmcnt(12)
    v_mfma_f32_16x16x32_bf16 v[64:67], v[208:211], a[16:19], v[64:67]
    ds_read_b64_tr_b16 a[184:185], v28 offset:43008
    v_add_f32 v82, v82, v90
    v_mfma_f32_16x16x32_bf16 v[68:71], v[212:215], a[16:19], v[68:71]
    ds_read_b64_tr_b16 a[186:187], v28 offset:46080
    v_add_f32 v83, v83, v91
    v_mfma_f32_16x16x32_bf16 v[72:75], v[208:211], a[20:23], v[72:75]
    ds_read_b64_tr_b16 a[188:189], v29 offset:43008
    v_add_f32 v84, v84, v92
    v_mfma_f32_16x16x32_bf16 v[76:79], v[212:215], a[20:23], v[76:79]
    ds_read_b64_tr_b16 a[190:191], v29 offset:46080
    s_waitcnt lgkmcnt(8)
    v_mfma_f32_16x16x32_bf16 v[48:51], a[32:35], v[216:219], v[48:51]
    v_add_f32 v85, v85, v93
    v_add_f32 v86, v86, v94
    v_mfma_f32_16x16x32_bf16 v[52:55], a[32:35], v[220:223], v[52:55]
    v_add_f32 v87, v87, v95
    v_add_f32 v80, v80, v84
    v_mfma_f32_16x16x32_bf16 v[56:59], a[36:39], v[216:219], v[56:59]
    v_add_f32 v81, v81, v85
    v_add_f32 v82, v82, v86
    v_mfma_f32_16x16x32_bf16 v[60:63], a[36:39], v[220:223], v[60:63]
    v_add_f32 v83, v83, v87
    s_waitcnt lgkmcnt(4)
    v_mfma_f32_16x16x32_bf16 v[64:67], v[216:219], a[40:43], v[64:67]
    v_add_f32 v80, v80, v82
    v_add_f32 v81, v81, v83
    v_mfma_f32_16x16x32_bf16 v[68:71], v[220:223], a[40:43], v[68:71]
    v_cmp_u_f32 vcc, v80, v81
    s_cbranch_vccnz L_ssp_st2
L_sbk_st2:
    v_mfma_f32_16x16x32_bf16 v[72:75], v[216:219], a[44:47], v[72:75]
    v_mov_b32 v22, v80
    v_mov_b32 v23, v81
    v_mfma_f32_16x16x32_bf16 v[76:79], v[220:223], a[44:47], v[76:79]
    s_nop 1
    v_permlane32_swap_b32 v80, v22
    v_permlane32_swap_b32 v81, v23
    v_add_f32 v80, v80, v22
    v_add_f32 v81, v81, v23
    v_mul_f32 v232, 0xbb000000, v80
    v_mul_f32 v81, 0x3b000000, v81
    v_fma_f32 v81, -v232, v232, v81
    v_max_f32 v81, 0, v81
    v_add_f32 v81, 0x3727c5ac, v81
    v_rsq_f32 v240, v81
    s_nop 0
    ds_write_b32 v24, v240
    v_mov_b32 v235, v240
    ds_read_b128 v[96:99], v25
    ds_read_b128 v[100:103], v25 offset:64
    v_permlane16_swap_b32 v240, v235
    v_mul_f32 v242, 0x3eb8aa3b, v240
    v_mul_f32 v234, 0x3eb8aa3b, v235
    s_waitcnt lgkmcnt(3)
    s_nop 2
    s_barrier
    buffer_load_dwordx4 a[248:251], v1, s[24:27], s34 offen offset:0 sc1
    buffer_load_dwordx4 a[252:255], v1, s[24:27], s34 offen offset:1024 sc1
    s_branch L_g1_epi
L_p2exit_5:
    s_barrier
    s_add_u32 m0, s53, 131072
    s_add_u32 s60, s54, 0
    buffer_load_dwordx4 v12, s[12:15], s60 offen offset:0 lds
    buffer_load_dwordx4 v14, s[12:15], s60 offen offset:1024 lds
    buffer_load_dwordx4 v15, s[12:15], s60 offen offset:2048 lds
    buffer_load_dwordx4 v228, s[12:15], s60 offen offset:3072 lds
    s_add_u32 m0, s53, 135168
    s_add_u32 s60, s54, 32768
    buffer_load_dwordx4 v12, s[12:15], s60 offen offset:0 lds
    buffer_load_dwordx4 v14, s[12:15], s60 offen offset:1024 lds
    buffer_load_dwordx4 v15, s[12:15], s60 offen offset:2048 lds
    buffer_load_dwordx4 v228, s[12:15], s60 offen offset:3072 lds
    s_add_u32 m0, s53, 0
    s_add_u32 s60, s96, 0
    buffer_load_dwordx4 v5, s[16:19], s60 offen offset:0 lds
    buffer_load_dwordx4 v6, s[16:19], s60 offen offset:1024 lds
    buffer_load_dwordx4 v7, s[16:19], s60 offen offset:2048 lds
    buffer_load_dwordx4 v8, s[16:19], s60 offen offset:3072 lds
    s_add_u32 m0, s53, 4096
    s_add_u32 s60, s96, 114688
    buffer_load_dwordx4 v5, s[16:19], s60 offen offset:0 lds
    buffer_load_dwordx4 v6, s[16:19], s60 offen offset:1024 lds
    buffer_load_dwordx4 v7, s[16:19], s60 offen offset:2048 lds
    buffer_load_dwordx4 v8, s[16:19], s60 offen offset:3072 lds
    s_add_u32 m0, s53, 32768
    s_add_u32 s60, s96, 458752
    buffer_load_dwordx4 v5, s[16:19], s60 offen offset:0 lds
    buffer_load_dwordx4 v6, s[16:19], s60 offen offset:1024 lds
    buffer_load_dwordx4 v7, s[16:19], s60 offen offset:2048 lds
    buffer_load_dwordx4 v8, s[16:19], s60 offen offset:3072 lds
    s_cmp_eq_u32 s40, 0
    s_cselect_b64 exec, s[100:101], 0
    buffer_load_dwordx2 v[230:231], v9, s[24:27], 0 offen sc1
    s_mov_b64 exec, -1
    s_nop 11
    s_branch L_p2done
L_p2exit_6:
    s_add_u32 m0, s53, 32768
    s_add_u32 s60, s96, 458752
    buffer_load_dwordx4 v5, s[16:19], s60 offen offset:0 lds
    buffer_load_dwordx4 v6, s[16:19], s60 offen offset:1024 lds
    buffer_load_dwordx4 v7, s[16:19], s60 offen offset:2048 lds
    buffer_load_dwordx4 v8, s[16:19], s60 offen offset:3072 lds
    s_cmp_eq_u32 s40, 0
    s_cselect_b64 exec, s[100:101], 0
    buffer_load_dwordx2 v[230:231], v9, s[24:27], 0 offen sc1
    s_mov_b64 exec, -1
    s_nop 11
    s_branch L_p2done
L_p2exit_7:
    s_nop 11
    s_branch L_p2done
L_p2exit_8:
    s_nop 11
    s_branch L_p2done
L_hspin1:
    s_mov_b32 s98, 0
L_hloop1:
    s_xor_b32 s99, s89, 4096
    buffer_load_dwordx4 v[64:67], v254, s[24:27], s99 offen offset:0 sc1
    buffer_load_dwordx4 v[68:71], v254, s[24:27], s99 offen offset:256 sc1
    buffer_load_dwordx4 v[72:75], v254, s[24:27], s99 offen offset:2048 sc1
    buffer_load_dwordx4 v[76:79], v254, s[24:27], s99 offen offset:2304 sc1
    s_xor_b32 s99, s81, 0
    buffer_load_dwordx4 v[80:83], v254, s[24:27], s99 offen offset:0 sc1
    buffer_load_dwordx4 v[84:87], v254, s[24:27], s99 offen offset:256 sc1
    buffer_load_dwordx4 v[88:91], v254, s[24:27], s99 offen offset:2048 sc1
    buffer_load_dwordx4 v[92:95], v254, s[24:27], s99 offen offset:2304 sc1
    s_xor_b32 s99, s81, 4096
    buffer_load_dwordx4 v[96:99], v254, s[24:27], s99 offen offset:0 sc1
    buffer_load_dwordx4 v[100:103], v254, s[24:27], s99 offen offset:256 sc1
    buffer_load_dwordx4 v[104:107], v254, s[24:27], s99 offen offset:2048 sc1
    buffer_load_dwordx4 v[108:111], v254, s[24:27], s99 offen offset:2304 sc1
    s_xor_b32 s99, s82, 0
    buffer_load_dwordx4 v[112:115], v254, s[24:27], s99 offen offset:0 sc1
    buffer_load_dwordx4 v[116:119], v254, s[24:27], s99 offen offset:256 sc1
    buffer_load_dwordx4 v[120:123], v254, s[24:27], s99 offen offset:2048 sc1
    buffer_load_dwordx4 v[124:127], v254, s[24:27], s99 offen offset:2304 sc1
    s_xor_b32 s99, s82, 4096
    buffer_load_dwordx4 v[128:131], v254, s[24:27], s99 offen offset:0 sc1
    buffer_load_dwordx4 v[132:135], v254, s[24:27], s99 offen offset:256 sc1
    buffer_load_dwordx4 v[136:139], v254, s[24:27], s99 offen offset:2048 sc1
    buffer_load_dwordx4 v[140:143], v254, s[24:27], s99 offen offset:2304 sc1
    buffer_load_dwordx2 v[26:27], v221, s[24:27], 0 offen sc1
    s_sub_u32 s62, s62, 1
    s_waitcnt vmcnt(0)
    v_max3_u32 v20, v64, v68, v72
    v_max_u32 v20, v20, v76
    v_cmp_eq_u32 vcc, -1, v20
    s_cbranch_vccz L_hback1
    s_cmp_lg_u32 s98, 0
    s_cbranch_scc1 L_hback1
    v_cmp_ge_u64 vcc, v[26:27], s[44:45]
    v_cmp_le_u64 s[84:85], v[26:27], s[46:47]
    s_and_b64 vcc, vcc, s[84:85]
    s_cmp_eq_u64 vcc, -1
    s_cselect_b32 s98, 1, 0
    s_cmp_gt_i32 s62, 0
    s_cbranch_scc1 L_hloop1
    s_branch L_hback1
L_hspin2:
    s_mov_b32 s98, 0
L_hloop2:
    s_xor_b32 s99, s81, 0
    buffer_load_dwordx4 v[80:83], v254, s[24:27], s99 offen offset:0 sc1
    buffer_load_dwordx4 v[84:87], v254, s[24:27], s99 offen offset:256 sc1
    buffer_load_dwordx4 v[88:91], v254, s[24:27], s99 offen offset:2048 sc1
    buffer_load_dwordx4 v[92:95], v254, s[24:27], s99 offen offset:2304 sc1
    s_xor_b32 s99, s81, 4096
    buffer_load_dwordx4 v[96:99], v254, s[24:27], s99 offen offset:0 sc1
    buffer_load_dwordx4 v[100:103], v254, s[24:27], s99 offen offset:256 sc1
    buffer_load_dwordx4 v[104:107], v254, s[24:27], s99 offen offset:2048 sc1
    buffer_load_dwordx4 v[108:111], v254, s[24:27], s99 offen offset:2304 sc1
    s_xor_b32 s99, s82, 0
    buffer_load_dwordx4 v[112:115], v254, s[24:27], s99 offen offset:0 sc1
    buffer_load_dwordx4 v[116:119], v254, s[24:27], s99 offen offset:256 sc1
    buffer_load_dwordx4 v[120:123], v254, s[24:27], s99 offen offset:2048 sc1
    buffer_load_dwordx4 v[124:127], v254, s[24:27], s99 offen offset:2304 sc1
    s_xor_b32 s99, s82, 4096
    buffer_load_dwordx4 v[128:131], v254, s[24:27], s99 offen offset:0 sc1
    buffer_load_dwordx4 v[132:135], v254, s[24:27], s99 offen offset:256 sc1
    buffer_load_dwordx4 v[136:139], v254, s[24:27], s99 offen offset:2048 sc1
    buffer_load_dwordx4 v[140:143], v254, s[24:27], s99 offen offset:2304 sc1
    buffer_load_dwordx2 v[26:27], v221, s[24:27], 0 offen sc1
    s_sub_u32 s62, s62, 1
    s_waitcnt vmcnt(0)
    v_max3_u32 v20, v80, v84, v88
    v_max_u32 v20, v20, v92
    v_cmp_eq_u32 vcc, -1, v20
    s_cbranch_vccz L_hback2
    s_cmp_lg_u32 s98, 0
    s_cbranch_scc1 L_hback2
    v_cmp_ge_u64 vcc, v[26:27], s[44:45]
    v_cmp_le_u64 s[84:85], v[26:27], s[46:47]
    s_and_b64 vcc, vcc, s[84:85]
    s_cmp_eq_u64 vcc, -1
    s_cselect_b32 s98, 1, 0
    s_cmp_gt_i32 s62, 0
    s_cbranch_scc1 L_hloop2
    s_branch L_hback2
L_hspin3:
    s_mov_b32 s98, 0
L_hloop3:
    s_xor_b32 s99, s81, 4096
    buffer_load_dwordx4 v[96:99], v254, s[24:27], s99 offen offset:0 sc1
    buffer_load_dwordx4 v[100:103], v254, s[24:27], s99 offen offset:256 sc1
    buffer_load_dwordx4 v[104:107], v254, s[24:27], s99 offen offset:2048 sc1
    buffer_load_dwordx4 v[108:111], v254, s[24:27], s99 offen offset:2304 sc1
    s_xor_b32 s99, s82, 0
    buffer_load_dwordx4 v[112:115], v254, s[24:27], s99 offen offset:0 sc1
    buffer_load_dwordx4 v[116:119], v254, s[24:27], s99 offen offset:256 sc1
    buffer_load_dwordx4 v[120:123], v254, s[24:27], s99 offen offset:2048 sc1
    buffer_load_dwordx4 v[124:127], v254, s[24:27], s99 offen offset:2304 sc1
    s_xor_b32 s99, s82, 4096
    buffer_load_dwordx4 v[128:131], v254, s[24:27], s99 offen offset:0 sc1
    buffer_load_dwordx4 v[132:135], v254, s[24:27], s99 offen offset:256 sc1
    buffer_load_dwordx4 v[136:139], v254, s[24:27], s99 offen offset:2048 sc1
    buffer_load_dwordx4 v[140:143], v254, s[24:27], s99 offen offset:2304 sc1
    buffer_load_dwordx2 v[26:27], v221, s[24:27], 0 offen sc1
    s_sub_u32 s62, s62, 1
    s_waitcnt vmcnt(0)
    v_max3_u32 v20, v96, v100, v104
    v_max_u32 v20, v20, v108
    v_cmp_eq_u32 vcc, -1, v20
    s_cbranch_vccz L_hback3
    s_cmp_lg_u32 s98, 0
    s_cbranch_scc1 L_hback3
    v_cmp_ge_u64 vcc, v[26:27], s[44:45]
    v_cmp_le_u64 s[84:85], v[26:27], s[46:47]
    s_and_b64 vcc, vcc, s[84:85]
    s_cmp_eq_u64 vcc, -1
    s_cselect_b32 s98, 1, 0
    s_cmp_gt_i32 s62, 0
    s_cbranch_scc1 L_hloop3
    s_branch L_hback3
L_hspin4:
    s_mov_b32 s98, 0
L_hloop4:
    s_xor_b32 s99, s82, 0
    buffer_load_dwordx4 v[112:115], v254, s[24:27], s99 offen offset:0 sc1
    buffer_load_dwordx4 v[116:119], v254, s[24:27], s99 offen offset:256 sc1
    buffer_load_dwordx4 v[120:123], v254, s[24:27], s99 offen offset:2048 sc1
    buffer_load_dwordx4 v[124:127], v254, s[24:27], s99 offen offset:2304 sc1
    s_xor_b32 s99, s82, 4096
    buffer_load_dwordx4 v[128:131], v254, s[24:27], s99 offen offset:0 sc1
    buffer_load_dwordx4 v[132:135], v254, s[24:27], s99 offen offset:256 sc1
    buffer_load_dwordx4 v[136:139], v254, s[24:27], s99 offen offset:2048 sc1
    buffer_load_dwordx4 v[140:143], v254, s[24:27], s99 offen offset:2304 sc1
    buffer_load_dwordx2 v[26:27], v221, s[24:27], 0 offen sc1
    s_sub_u32 s62, s62, 1
    s_waitcnt vmcnt(0)
    v_max3_u32 v20, v112, v116, v120
    v_max_u32 v20, v20, v124
    v_cmp_eq_u32 vcc, -1, v20
    s_cbranch_vccz L_hback4
    s_cmp_lg_u32 s98, 0
    s_cbranch_scc1 L_hback4
    v_cmp_ge_u64 vcc, v[26:27], s[44:45]
    v_cmp_le_u64 s[84:85], v[26:27], s[46:47]
    s_and_b64 vcc, vcc, s[84:85]
    s_cmp_eq_u64 vcc, -1
    s_cselect_b32 s98, 1, 0
    s_cmp_gt_i32 s62, 0
    s_cbranch_scc1 L_hloop4
    s_branch L_hback4
L_hspin5:
    s_mov_b32 s98, 0
L_hloop5:
    s_xor_b32 s99, s82, 4096
    buffer_load_dwordx4 v[128:131], v254, s[24:27], s99 offen offset:0 sc1
    buffer_load_dwordx4 v[132:135], v254, s[24:27], s99 offen offset:256 sc1
    buffer_load_dwordx4 v[136:139], v254, s[24:27], s99 offen offset:2048 sc1
    buffer_load_dwordx4 v[140:143], v254, s[24:27], s99 offen offset:2304 sc1
    buffer_load_dwordx2 v[26:27], v221, s[24:27], 0 offen sc1
    s_sub_u32 s62, s62, 1
    s_waitcnt vmcnt(0)
    v_max3_u32 v20, v128, v132, v136
    v_max_u32 v20, v20, v140
    v_cmp_eq_u32 vcc, -1, v20
    s_cbranch_vccz L_hback5
    s_cmp_lg_u32 s98, 0
    s_cbranch_scc1 L_hback5
    v_cmp_ge_u64 vcc, v[26:27], s[44:45]
    v_cmp_le_u64 s[84:85], v[26:27], s[46:47]
    s_and_b64 vcc, vcc, s[84:85]
    s_cmp_eq_u64 vcc, -1
    s_cselect_b32 s98, 1, 0
    s_cmp_gt_i32 s62, 0
    s_cbranch_scc1 L_hloop5
    s_branch L_hback5
L_dsp_x2_0:
    v_writelane_b32 v253, s98, 0
    v_writelane_b32 v253, s99, 1
    s_mov_b32 s98, -8
    v_mov_b32 v26, 0
    v_mov_b32 v27, 0
L_dlp_x2_0:
    s_and_b32 s99, s5, -128
    v_and_b32 v21, 15, v0
    v_lshl_add_u32 v21, v21, 3, s99
    s_cmp_eq_i32 s98, 0
    s_cselect_b64 exec, -1, 0
    buffer_load_dwordx2 v[26:27], v21, s[24:27], 0 offen sc1
    s_mov_b64 exec, -1
    s_add_u32 s99, s61, 32768
    buffer_load_dwordx4 v[96:99], v1, s[24:27], s99 offen offset:0 sc1
    buffer_load_dwordx4 v[100:103], v1, s[24:27], s99 offen offset:1024 sc1
    buffer_load_dwordx4 v[104:107], v1, s[24:27], s99 offen offset:2048 sc1
    buffer_load_dwordx4 v[108:111], v1, s[24:27], s99 offen offset:3072 sc1
    s_sub_u32 s62, s62, 1
    s_waitcnt vmcnt(0)
    v_max3_u32 v21, v96, v100, v104
    v_max_u32 v21, v21, v108
    v_cmp_eq_u32 vcc, -1, v21
    s_cbranch_vccz L_dex_x2_0
    s_cmp_gt_i32 s98, 0
    s_cbranch_scc1 L_dex_x2_0
    v_cmp_ge_u64 vcc, v[26:27], s[44:45]
    v_cmp_le_u64 s[84:85], v[26:27], s[46:47]
    s_and_b64 vcc, vcc, s[84:85]
    s_cmp_eq_u64 vcc, -1
    s_cselect_b32 s84, 1, 0
    s_add_u32 s98, s98, 1
    s_min_i32 s98, s98, s84
    s_cmp_gt_i32 s62, 0
    s_cbranch_scc1 L_dlp_x2_0
L_dex_x2_0:
    s_and_b32 s99, s5, -128
    v_and_b32 v21, 15, v0
    v_lshl_add_u32 v21, v21, 3, s99
    s_add_u32 s99, s61, 36864
    buffer_load_dwordx4 v[112:115], v1, s[24:27], s99 offen offset:0 sc1
    buffer_load_dwordx4 v[116:119], v1, s[24:27], s99 offen offset:1024 sc1
    buffer_load_dwordx4 v[120:123], v1, s[24:27], s99 offen offset:2048 sc1
    buffer_load_dwordx4 v[124:127], v1, s[24:27], s99 offen offset:3072 sc1
    buffer_load_dwordx2 v[26:27], v21, s[24:27], 0 offen sc1
    v_readlane_b32 s98, v253, 0
    v_readlane_b32 s99, v253, 1
    s_nop 3
    s_branch L_dbk_x2_0
L_dsp_x2_1:
    v_writelane_b32 v253, s98, 0
    v_writelane_b32 v253, s99, 1
    s_mov_b32 s98, -8
    v_mov_b32 v26, 0
    v_mov_b32 v27, 0
L_dlp_x2_1:
    s_and_b32 s99, s5, -128
    v_and_b32 v21, 15, v0
    v_lshl_add_u32 v21, v21, 3, s99
    s_cmp_eq_i32 s98, 0
    s_cselect_b64 exec, -1, 0
    buffer_load_dwordx2 v[26:27], v21, s[24:27], 0 offen sc1
    s_mov_b64 exec, -1
    s_add_u32 s99, s61, 36864
    buffer_load_dwordx4 v[112:115], v1, s[24:27], s99 offen offset:0 sc1
    buffer_load_dwordx4 v[116:119], v1, s[24:27], s99 offen offset:1024 sc1
    buffer_load_dwordx4 v[120:123], v1, s[24:27], s99 offen offset:2048 sc1
    buffer_load_dwordx4 v[124:127], v1, s[24:27], s99 offen offset:3072 sc1
    s_sub_u32 s62, s62, 1
    s_waitcnt vmcnt(0)
    v_max3_u32 v21, v112, v116, v120
    v_max_u32 v21, v21, v124
    v_cmp_eq_u32 vcc, -1, v21
    s_cbranch_vccz L_dex_x2_1
    s_cmp_gt_i32 s98, 0
    s_cbranch_scc1 L_dex_x2_1
    v_cmp_ge_u64 vcc, v[26:27], s[44:45]
    v_cmp_le_u64 s[84:85], v[26:27], s[46:47]
    s_and_b64 vcc, vcc, s[84:85]
    s_cmp_eq_u64 vcc, -1
    s_cselect_b32 s84, 1, 0
    s_add_u32 s98, s98, 1
    s_min_i32 s98, s98, s84
    s_cmp_gt_i32 s62, 0
    s_cbranch_scc1 L_dlp_x2_1
L_dex_x2_1:
    s_and_b32 s99, s5, -128
    v_and_b32 v21, 15, v0
    v_lshl_add_u32 v21, v21, 3, s99
    buffer_load_dwordx2 v[26:27], v21, s[24:27], 0 offen sc1
    s_add_u32 s99, s61, 49152
    buffer_load_dwordx4 v[128:131], v1, s[24:27], s99 offen offset:0 sc1
    buffer_load_dwordx4 v[132:135], v1, s[24:27], s99 offen offset:1024 sc1
    buffer_load_dwordx4 v[136:139], v1, s[24:27], s99 offen offset:2048 sc1
    buffer_load_dwordx4 v[140:143], v1, s[24:27], s99 offen offset:3072 sc1
    s_add_u32 s99, s61, 53248
    buffer_load_dwordx4 v[144:147], v1, s[24:27], s99 offen offset:0 sc1
    v_readlane_b32 s98, v253, 0
    v_readlane_b32 s99, v253, 1
    s_nop 3
    s_branch L_dbk_x2_1
L_dsp_x2_2:
    v_writelane_b32 v253, s98, 0
    v_writelane_b32 v253, s99, 1
    s_mov_b32 s98, -8
    v_mov_b32 v26, 0
    v_mov_b32 v27, 0
L_dlp_x2_2:
    s_and_b32 s99, s5, -128
    v_and_b32 v21, 15, v0
    v_lshl_add_u32 v21, v21, 3, s99
    s_cmp_eq_i32 s98, 0
    s_cselect_b64 exec, -1, 0
    buffer_load_dwordx2 v[26:27], v21, s[24:27], 0 offen sc1
    s_mov_b64 exec, -1
    s_add_u32 s99, s61, 49152
    buffer_load_dwordx4 v[128:131], v1, s[24:27], s99 offen offset:0 sc1
    buffer_load_dwordx4 v[132:135], v1, s[24:27], s99 offen offset:1024 sc1
    buffer_load_dwordx4 v[136:139], v1, s[24:27], s99 offen offset:2048 sc1
    buffer_load_dwordx4 v[140:143], v1, s[24:27], s99 offen offset:3072 sc1
    s_sub_u32 s62, s62, 1
    s_waitcnt vmcnt(0)
    v_max3_u32 v21, v128, v132, v136
    v_max_u32 v21, v21, v140
    v_cmp_eq_u32 vcc, -1, v21
    s_cbranch_vccz L_dex_x2_2
    s_cmp_gt_i32 s98, 0
    s_cbranch_scc1 L_dex_x2_2
    v_cmp_ge_u64 vcc, v[26:27], s[44:45]
    v_cmp_le_u64 s[84:85], v[26:27], s[46:47]
    s_and_b64 vcc, vcc, s[84:85]
    s_cmp_eq_u64 vcc, -1
    s_cselect_b32 s84, 1, 0
    s_add_u32 s98, s98, 1
    s_min_i32 s98, s98, s84
    s_cmp_gt_i32 s62, 0
    s_cbranch_scc1 L_dlp_x2_2
L_dex_x2_2:
    s_add_u32 s99, s61, 53248
    buffer_load_dwordx4 v[144:147], v1, s[24:27], s99 offen offset:0 sc1
    buffer_load_dwordx4 v[148:151], v1, s[24:27], s99 offen offset:1024 sc1
    buffer_load_dwordx4 v[152:155], v1, s[24:27], s99 offen offset:2048 sc1
    buffer_load_dwordx4 v[156:159], v1, s[24:27], s99 offen offset:3072 sc1
    s_add_u32 s99, s61, 0
    buffer_load_dwordx4 v[160:163], v1, s[24:27], s99 offen offset:0 sc1
    buffer_load_dwordx4 v[164:167], v1, s[24:27], s99 offen offset:1024 sc1
    buffer_load_dwordx4 v[168:171], v1, s[24:27], s99 offen offset:2048 sc1
    v_readlane_b32 s98, v253, 0
    v_readlane_b32 s99, v253, 1
    s_nop 3
    s_branch L_dbk_x2_2
L_dsp_x2_3:
    v_writelane_b32 v253, s98, 0
    v_writelane_b32 v253, s99, 1
    s_mov_b32 s98, -8
    v_mov_b32 v26, 0
    v_mov_b32 v27, 0
L_dlp_x2_3:
    s_and_b32 s99, s5, -128
    v_and_b32 v21, 15, v0
    v_lshl_add_u32 v21, v21, 3, s99
    s_cmp_eq_i32 s98, 0
    s_cselect_b64 exec, -1, 0
    buffer_load_dwordx2 v[26:27], v21, s[24:27], 0 offen sc1
    s_mov_b64 exec, -1
    s_add_u32 s99, s61, 53248
    buffer_load_dwordx4 v[144:147], v1, s[24:27], s99 offen offset:0 sc1
    buffer_load_dwordx4 v[148:151], v1, s[24:27], s99 offen offset:1024 sc1
    buffer_load_dwordx4 v[152:155], v1, s[24:27], s99 offen offset:2048 sc1
    buffer_load_dwordx4 v[156:159], v1, s[24:27], s99 offen offset:3072 sc1
    s_sub_u32 s62, s62, 1
    s_waitcnt vmcnt(0)
    v_max3_u32 v21, v144, v148, v152
    v_max_u32 v21, v21, v156
    v_cmp_eq_u32 vcc, -1, v21
    s_cbranch_vccz L_dex_x2_3
    s_cmp_gt_i32 s98, 0
    s_cbranch_scc1 L_dex_x2_3
    v_cmp_ge_u64 vcc, v[26:27], s[44:45]
    v_cmp_le_u64 s[84:85], v[26:27], s[46:47]
    s_and_b64 vcc, vcc, s[84:85]
    s_cmp_eq_u64 vcc, -1
    s_cselect_b32 s84, 1, 0
    s_add_u32 s98, s98, 1
    s_min_i32 s98, s98, s84
    s_cmp_gt_i32 s62, 0
    s_cbranch_scc1 L_dlp_x2_3
L_dex_x2_3:
    s_add_u32 s99, s61, 0
    buffer_load_dwordx4 v[160:163], v1, s[24:27], s99 offen offset:0 sc1
    buffer_load_dwordx4 v[164:167], v1, s[24:27], s99 offen offset:1024 sc1
    buffer_load_dwordx4 v[168:171], v1, s[24:27], s99 offen offset:2048 sc1
    buffer_load_dwordx4 v[172:175], v1, s[24:27], s99 offen offset:3072 sc1
    s_add_u32 s99, s61, 4096
    buffer_load_dwordx4 v[176:179], v1, s[24:27], s99 offen offset:0 sc1
    buffer_load_dwordx2 v[80:81], v20, s[24:27], s93 offen offset:0 sc1
    buffer_load_dwordx2 v[82:83], v20, s[24:27], s93 offen offset:256 sc1
    buffer_load_dwordx4 v[180:183], v1, s[24:27], s99 offen offset:1024 sc1
    buffer_load_dwordx2 v[84:85], v20, s[24:27], s93 offen offset:512 sc1
    buffer_load_dwordx2 v[86:87], v20, s[24:27], s93 offen offset:768 sc1
    buffer_load_dwordx4 v[184:187], v1, s[24:27], s99 offen offset:2048 sc1
    buffer_load_dwordx2 v[88:89], v20, s[24:27], s93 offen offset:1024 sc1
    buffer_load_dwordx4 v[188:191], v1, s[24:27], s99 offen offset:3072 sc1
    buffer_load_dwordx2 v[90:91], v20, s[24:27], s93 offen offset:1280 sc1
    s_add_u32 s99, s61, 16384
    buffer_load_dwordx4 v[192:195], v1, s[24:27], s99 offen offset:0 sc1
    v_readlane_b32 s98, v253, 0
    v_readlane_b32 s99, v253, 1
    s_nop 3
    s_branch L_dbk_x2_3
L_dsp_x2_4:
    v_writelane_b32 v253, s98, 0
    v_writelane_b32 v253, s99, 1
    s_mov_b32 s98, -8
    v_mov_b32 v26, 0
    v_mov_b32 v27, 0
L_dlp_x2_4:
    s_and_b32 s99, s5, -128
    v_and_b32 v21, 15, v0
    v_lshl_add_u32 v21, v21, 3, s99
    s_cmp_eq_i32 s98, 0
    s_cselect_b64 exec, -1, 0
    buffer_load_dwordx2 v[26:27], v21, s[24:27], 0 offen sc1
    s_mov_b64 exec, -1
    s_add_u32 s99, s61, 0
    buffer_load_dwordx4 v[160:163], v1, s[24:27], s99 offen offset:0 sc1
    buffer_load_dwordx4 v[164:167], v1, s[24:27], s99 offen offset:1024 sc1
    buffer_load_dwordx4 v[168:171], v1, s[24:27], s99 offen offset:2048 sc1
    buffer_load_dwordx4 v[172:175], v1, s[24:27], s99 offen offset:3072 sc1
    s_sub_u32 s62, s62, 1
    s_waitcnt vmcnt(0)
    v_max3_u32 v21, v160, v164, v168
    v_max_u32 v21, v21, v172
    v_cmp_eq_u32 vcc, -1, v21
    s_cbranch_vccz L_dex_x2_4
    s_cmp_gt_i32 s98, 0
    s_cbranch_scc1 L_dex_x2_4
    v_cmp_ge_u64 vcc, v[26:27], s[44:45]
    v_cmp_le_u64 s[84:85], v[26:27], s[46:47]
    s_and_b64 vcc, vcc, s[84:85]
    s_cmp_eq_u64 vcc, -1
    s_cselect_b32 s84, 1, 0
    s_add_u32 s98, s98, 1
    s_min_i32 s98, s98, s84
    s_cmp_gt_i32 s62, 0
    s_cbranch_scc1 L_dlp_x2_4
L_dex_x2_4:
    s_add_u32 s99, s61, 4096
    buffer_load_dwordx4 v[176:179], v1, s[24:27], s99 offen offset:0 sc1
    buffer_load_dwordx2 v[80:81], v20, s[24:27], s93 offen offset:0 sc1
    buffer_load_dwordx2 v[82:83], v20, s[24:27], s93 offen offset:256 sc1
    buffer_load_dwordx4 v[180:183], v1, s[24:27], s99 offen offset:1024 sc1
    buffer_load_dwordx2 v[84:85], v20, s[24:27], s93 offen offset:512 sc1
    buffer_load_dwordx2 v[86:87], v20, s[24:27], s93 offen offset:768 sc1
    buffer_load_dwordx4 v[184:187], v1, s[24:27], s99 offen offset:2048 sc1
    buffer_load_dwordx2 v[88:89], v20, s[24:27], s93 offen offset:1024 sc1
    buffer_load_dwordx4 v[188:191], v1, s[24:27], s99 offen offset:3072 sc1
    buffer_load_dwordx2 v[90:91], v20, s[24:27], s93 offen offset:1280 sc1
    s_add_u32 s99, s61, 16384
    buffer_load_dwordx4 v[192:195], v1, s[24:27], s99 offen offset:0 sc1
    buffer_load_dwordx4 v[196:199], v1, s[24:27], s99 offen offset:1024 sc1
    buffer_load_dwordx2 v[92:93], v20, s[24:27], s93 offen offset:1536 sc1
    buffer_load_dwordx4 v[200:203], v1, s[24:27], s99 offen offset:2048 sc1
    buffer_load_dwordx2 v[94:95], v20, s[24:27], s93 offen offset:1792 sc1
    buffer_load_dwordx4 v[204:207], v1, s[24:27], s99 offen offset:3072 sc1
    s_add_u32 s99, s61, 20480
    buffer_load_dwordx4 v[208:211], v1, s[24:27], s99 offen offset:0 sc1
    buffer_load_dwordx4 v[212:215], v1, s[24:27], s99 offen offset:1024 sc1
    buffer_load_dwordx4 v[216:219], v1, s[24:27], s99 offen offset:2048 sc1
    v_readlane_b32 s98, v253, 0
    v_readlane_b32 s99, v253, 1
    s_nop 3
    s_branch L_dbk_x2_4
L_dsp_x2_5:
    v_writelane_b32 v253, s98, 0
    v_writelane_b32 v253, s99, 1
    s_mov_b32 s98, -8
    v_mov_b32 v26, 0
    v_mov_b32 v27, 0
L_dlp_x2_5:
    s_and_b32 s99, s5, -128
    v_and_b32 v21, 15, v0
    v_lshl_add_u32 v21, v21, 3, s99
    s_cmp_eq_i32 s98, 0
    s_cselect_b64 exec, -1, 0
    buffer_load_dwordx2 v[26:27], v21, s[24:27], 0 offen sc1
    s_mov_b64 exec, -1
    s_add_u32 s99, s61, 4096
    buffer_load_dwordx4 v[176:179], v1, s[24:27], s99 offen offset:0 sc1
    buffer_load_dwordx4 v[180:183], v1, s[24:27], s99 offen offset:1024 sc1
    buffer_load_dwordx4 v[184:187], v1, s[24:27], s99 offen offset:2048 sc1
    buffer_load_dwordx4 v[188:191], v1, s[24:27], s99 offen offset:3072 sc1
    s_sub_u32 s62, s62, 1
    s_waitcnt vmcnt(0)
    v_max3_u32 v21, v176, v180, v184
    v_max_u32 v21, v21, v188
    v_cmp_eq_u32 vcc, -1, v21
    s_cbranch_vccz L_dex_x2_5
    s_cmp_gt_i32 s98, 0
    s_cbranch_scc1 L_dex_x2_5
    v_cmp_ge_u64 vcc, v[26:27], s[44:45]
    v_cmp_le_u64 s[84:85], v[26:27], s[46:47]
    s_and_b64 vcc, vcc, s[84:85]
    s_cmp_eq_u64 vcc, -1
    s_cselect_b32 s84, 1, 0
    s_add_u32 s98, s98, 1
    s_min_i32 s98, s98, s84
    s_cmp_gt_i32 s62, 0
    s_cbranch_scc1 L_dlp_x2_5
L_dex_x2_5:
    buffer_load_dwordx2 v[90:91], v20, s[24:27], s93 offen offset:1280 sc1
    s_add_u32 s99, s61, 16384
    buffer_load_dwordx4 v[192:195], v1, s[24:27], s99 offen offset:0 sc1
    buffer_load_dwordx4 v[196:199], v1, s[24:27], s99 offen offset:1024 sc1
    buffer_load_dwordx2 v[92:93], v20, s[24:27], s93 offen offset:1536 sc1
    buffer_load_dwordx4 v[200:203], v1, s[24:27], s99 offen offset:2048 sc1
    buffer_load_dwordx2 v[94:95], v20, s[24:27], s93 offen offset:1792 sc1
    buffer_load_dwordx4 v[204:207], v1, s[24:27], s99 offen offset:3072 sc1
    s_add_u32 s99, s61, 20480
    buffer_load_dwordx4 v[208:211], v1, s[24:27], s99 offen offset:0 sc1
    buffer_load_dwordx4 v[212:215], v1, s[24:27], s99 offen offset:1024 sc1
    buffer_load_dwordx4 v[216:219], v1, s[24:27], s99 offen offset:2048 sc1
    buffer_load_dwordx4 v[220:223], v1, s[24:27], s99 offen offset:3072 sc1
    v_readlane_b32 s98, v253, 0
    v_readlane_b32 s99, v253, 1
    s_nop 3
    s_branch L_dbk_x2_5
L_dsp_x2_6:
    v_writelane_b32 v253, s98, 0
    v_writelane_b32 v253, s99, 1
    s_mov_b32 s98, -8
    v_mov_b32 v26, 0
    v_mov_b32 v27, 0
L_dlp_x2_6:
    s_and_b32 s99, s5, -128
    v_and_b32 v21, 15, v0
    v_lshl_add_u32 v21, v21, 3, s99
    s_cmp_eq_i32 s98, 0
    s_cselect_b64 exec, -1, 0
    buffer_load_dwordx2 v[26:27], v21, s[24:27], 0 offen sc1
    s_mov_b64 exec, -1
    s_add_u32 s99, s61, 16384
    buffer_load_dwordx4 v[192:195], v1, s[24:27], s99 offen offset:0 sc1
    buffer_load_dwordx4 v[196:199], v1, s[24:27], s99 offen offset:1024 sc1
    buffer_load_dwordx4 v[200:203], v1, s[24:27], s99 offen offset:2048 sc1
    buffer_load_dwordx4 v[204:207], v1, s[24:27], s99 offen offset:3072 sc1
    s_sub_u32 s62, s62, 1
    s_waitcnt vmcnt(0)
    v_max3_u32 v21, v192, v196, v200
    v_max_u32 v21, v21, v204
    v_cmp_eq_u32 vcc, -1, v21
    s_cbranch_vccz L_dex_x2_6
    s_cmp_gt_i32 s98, 0
    s_cbranch_scc1 L_dex_x2_6
    v_cmp_ge_u64 vcc, v[26:27], s[44:45]
    v_cmp_le_u64 s[84:85], v[26:27], s[46:47]
    s_and_b64 vcc, vcc, s[84:85]
    s_cmp_eq_u64 vcc, -1
    s_cselect_b32 s84, 1, 0
    s_add_u32 s98, s98, 1
    s_min_i32 s98, s98, s84
    s_cmp_gt_i32 s62, 0
    s_cbranch_scc1 L_dlp_x2_6
L_dex_x2_6:
    s_add_u32 s99, s61, 20480
    buffer_load_dwordx4 v[208:211], v1, s[24:27], s99 offen offset:0 sc1
    buffer_load_dwordx4 v[212:215], v1, s[24:27], s99 offen offset:1024 sc1
    buffer_load_dwordx4 v[216:219], v1, s[24:27], s99 offen offset:2048 sc1
    buffer_load_dwordx4 v[220:223], v1, s[24:27], s99 offen offset:3072 sc1
    v_readlane_b32 s98, v253, 0
    v_readlane_b32 s99, v253, 1
    s_nop 3
    s_branch L_dbk_x2_6
L_dsp_x2_7:
    v_writelane_b32 v253, s98, 0
    v_writelane_b32 v253, s99, 1
    s_mov_b32 s98, -8
    v_mov_b32 v26, 0
    v_mov_b32 v27, 0
L_dlp_x2_7:
    s_and_b32 s99, s5, -128
    v_and_b32 v21, 15, v0
    v_lshl_add_u32 v21, v21, 3, s99
    s_cmp_eq_i32 s98, 0
    s_cselect_b64 exec, -1, 0
    buffer_load_dwordx2 v[26:27], v21, s[24:27], 0 offen sc1
    s_mov_b64 exec, -1
    s_add_u32 s99, s61, 20480
    buffer_load_dwordx4 v[208:211], v1, s[24:27], s99 offen offset:0 sc1
    buffer_load_dwordx4 v[212:215], v1, s[24:27], s99 offen offset:1024 sc1
    buffer_load_dwordx4 v[216:219], v1, s[24:27], s99 offen offset:2048 sc1
    buffer_load_dwordx4 v[220:223], v1, s[24:27], s99 offen offset:3072 sc1
    s_sub_u32 s62, s62, 1
    s_waitcnt vmcnt(0)
    v_max3_u32 v21, v208, v212, v216
    v_max_u32 v21, v21, v220
    v_cmp_eq_u32 vcc, -1, v21
    s_cbranch_vccz L_dex_x2_7
    s_cmp_gt_i32 s98, 0
    s_cbranch_scc1 L_dex_x2_7
    v_cmp_ge_u64 vcc, v[26:27], s[44:45]
    v_cmp_le_u64 s[84:85], v[26:27], s[46:47]
    s_and_b64 vcc, vcc, s[84:85]
    s_cmp_eq_u64 vcc, -1
    s_cselect_b32 s84, 1, 0
    s_add_u32 s98, s98, 1
    s_min_i32 s98, s98, s84
    s_cmp_gt_i32 s62, 0
    s_cbranch_scc1 L_dlp_x2_7
L_dex_x2_7:
    v_readlane_b32 s98, v253, 0
    v_readlane_b32 s99, v253, 1
    s_nop 3
    s_branch L_dbk_x2_7
L_ssp_st1:
    buffer_load_dwordx2 v[144:145], v20, s[24:27], s93 offen offset:0 sc1
    buffer_load_dwordx2 v[146:147], v20, s[24:27], s93 offen offset:256 sc1
    buffer_load_dwordx2 v[148:149], v20, s[24:27], s93 offen offset:512 sc1
    buffer_load_dwordx2 v[150:151], v20, s[24:27], s93 offen offset:768 sc1
    buffer_load_dwordx2 v[152:153], v20, s[24:27], s93 offen offset:1024 sc1
    buffer_load_dwordx2 v[154:155], v20, s[24:27], s93 offen offset:1280 sc1
    buffer_load_dwordx2 v[156:157], v20, s[24:27], s93 offen offset:1536 sc1
    buffer_load_dwordx2 v[158:159], v20, s[24:27], s93 offen offset:1792 sc1
    s_sub_u32 s62, s62, 1
    s_waitcnt vmcnt(0)
    v_max3_u32 v21, v144, v146, v148
    v_max3_u32 v21, v21, v150, v152
    v_max3_u32 v21, v21, v154, v156
    v_max_u32 v21, v21, v158
    v_cmp_eq_u32 vcc, -1, v21
    s_cmp_gt_i32 s62, 0
    s_cselect_b64 s[84:85], vcc, 0
    s_cmp_lg_u64 s[84:85], 0
    s_cbranch_scc1 L_ssp_st1
    v_add_f32 v144, v144, v152
    v_add_f32 v145, v145, v153
    v_add_f32 v146, v146, v154
    v_add_f32 v147, v147, v155
    v_add_f32 v148, v148, v156
    v_add_f32 v149, v149, v157
    v_add_f32 v150, v150, v158
    v_add_f32 v151, v151, v159
    v_add_f32 v144, v144, v148
    v_add_f32 v145, v145, v149
    v_add_f32 v146, v146, v150
    v_add_f32 v147, v147, v151
    v_add_f32 v144, v144, v146
    v_add_f32 v145, v145, v147
    s_branch L_sbk_st1
L_ssp_st2:
    buffer_load_dwordx2 v[80:81], v20, s[24:27], s93 offen offset:0 sc1
    buffer_load_dwordx2 v[82:83], v20, s[24:27], s93 offen offset:256 sc1
    buffer_load_dwordx2 v[84:85], v20, s[24:27], s93 offen offset:512 sc1
    buffer_load_dwordx2 v[86:87], v20, s[24:27], s93 offen offset:768 sc1
    buffer_load_dwordx2 v[88:89], v20, s[24:27], s93 offen offset:1024 sc1
    buffer_load_dwordx2 v[90:91], v20, s[24:27], s93 offen offset:1280 sc1
    buffer_load_dwordx2 v[92:93], v20, s[24:27], s93 offen offset:1536 sc1
    buffer_load_dwordx2 v[94:95], v20, s[24:27], s93 offen offset:1792 sc1
    s_sub_u32 s62, s62, 1
    s_waitcnt vmcnt(0)
    v_max3_u32 v21, v80, v82, v84
    v_max3_u32 v21, v21, v86, v88
    v_max3_u32 v21, v21, v90, v92
    v_max_u32 v21, v21, v94
    v_cmp_eq_u32 vcc, -1, v21
    s_cmp_gt_i32 s62, 0
    s_cselect_b64 s[84:85], vcc, 0
    s_cmp_lg_u64 s[84:85], 0
    s_cbranch_scc1 L_ssp_st2
    v_add_f32 v80, v80, v88
    v_add_f32 v81, v81, v89
    v_add_f32 v82, v82, v90
    v_add_f32 v83, v83, v91
    v_add_f32 v84, v84, v92
    v_add_f32 v85, v85, v93
    v_add_f32 v86, v86, v94
    v_add_f32 v87, v87, v95
    v_add_f32 v80, v80, v84
    v_add_f32 v81, v81, v85
    v_add_f32 v82, v82, v86
    v_add_f32 v83, v83, v87
    v_add_f32 v80, v80, v82
    v_add_f32 v81, v81, v83
    s_branch L_sbk_st2
L_end:
    s_endpgm
L_fb:
    v_and_b32 v21, 31, v0
    v_lshrrev_b32 v22, 5, v0
    v_lshlrev_b32 v22, 2, v22
    v_sub_u32 v21, v21, v22
    v_sub_u32 v32, -1, v21
    v_ashrrev_i32 v32, 31, v32
    v_sub_u32 v33, 0, v21
    v_ashrrev_i32 v33, 31, v33
    v_sub_u32 v34, 1, v21
    v_ashrrev_i32 v34, 31, v34
    v_sub_u32 v35, 2, v21
    v_ashrrev_i32 v35, 31, v35
    v_sub_u32 v36, 7, v21
    v_ashrrev_i32 v36, 31, v36
    v_sub_u32 v37, 8, v21
    v_ashrrev_i32 v37, 31, v37
    v_sub_u32 v38, 9, v21
    v_ashrrev_i32 v38, 31, v38
    v_sub_u32 v39, 10, v21
    v_ashrrev_i32 v39, 31, v39
    v_sub_u32 v40, 15, v21
    v_ashrrev_i32 v40, 31, v40
    v_sub_u32 v41, 16, v21
    v_ashrrev_i32 v41, 31, v41
    v_sub_u32 v42, 17, v21
    v_ashrrev_i32 v42, 31, v42
    v_sub_u32 v43, 18, v21
    v_ashrrev_i32 v43, 31, v43
    v_sub_u32 v44, 23, v21
    v_ashrrev_i32 v44, 31, v44
    v_sub_u32 v45, 24, v21
    v_ashrrev_i32 v45, 31, v45
    v_sub_u32 v46, 25, v21
    v_ashrrev_i32 v46, 31, v46
    v_sub_u32 v47, 26, v21
    v_ashrrev_i32 v47, 31, v47
    s_mov_b32 s61, 0xff800000
    v_bfi_b32 v128, v32, 0, s61
    v_and_b32 v144, s61, v32
    v_bfi_b32 v129, v33, 0, s61
    v_and_b32 v145, s61, v33
    v_bfi_b32 v130, v34, 0, s61
    v_and_b32 v146, s61, v34
    v_bfi_b32 v131, v35, 0, s61
    v_and_b32 v147, s61, v35
    v_bfi_b32 v132, v36, 0, s61
    v_and_b32 v148, s61, v36
    v_bfi_b32 v133, v37, 0, s61
    v_and_b32 v149, s61, v37
    v_bfi_b32 v134, v38, 0, s61
    v_and_b32 v150, s61, v38
    v_bfi_b32 v135, v39, 0, s61
    v_and_b32 v151, s61, v39
    v_bfi_b32 v136, v40, 0, s61
    v_and_b32 v152, s61, v40
    v_bfi_b32 v137, v41, 0, s61
    v_and_b32 v153, s61, v41
    v_bfi_b32 v138, v42, 0, s61
    v_and_b32 v154, s61, v42
    v_bfi_b32 v139, v43, 0, s61
    v_and_b32 v155, s61, v43
    v_bfi_b32 v140, v44, 0, s61
    v_and_b32 v156, s61, v44
    v_bfi_b32 v141, v45, 0, s61
    v_and_b32 v157, s61, v45
    v_bfi_b32 v142, v46, 0, s61
    v_and_b32 v158, s61, v46
    v_bfi_b32 v143, v47, 0, s61
    v_and_b32 v159, s61, v47
    v_mov_b32 v20, s61
    v_mov_b32 v21, s61
    v_mfma_f32_32x32x16_bf16 v[32:47], a[0:3], v[248:251], v[128:143]
    v_mfma_f32_32x32x16_bf16 v[48:63], a[4:7], v[244:247], v[128:143]
    v_mfma_f32_32x32x16_bf16 v[64:79], a[4:7], v[248:251], 0
    s_nop 11
    v_max3_f32 v21, v21, v32, v33
    v_max3_f32 v21, v21, v34, v35
    v_max3_f32 v21, v21, v36, v37
    v_max3_f32 v21, v21, v38, v39
    v_max3_f32 v21, v21, v40, v41
    v_max3_f32 v21, v21, v42, v43
    v_max3_f32 v21, v21, v44, v45
    v_max3_f32 v21, v21, v46, v47
    v_mfma_f32_32x32x16_bf16 v[80:95], a[8:11], v[244:247], 0
    s_nop 11
    v_max3_f32 v20, v20, v48, v49
    v_max3_f32 v20, v20, v50, v51
    v_max3_f32 v20, v20, v52, v53
    v_max3_f32 v20, v20, v54, v55
    v_max3_f32 v20, v20, v56, v57
    v_max3_f32 v20, v20, v58, v59
    v_max3_f32 v20, v20, v60, v61
    v_max3_f32 v20, v20, v62, v63
    v_mfma_f32_32x32x16_bf16 v[32:47], a[8:11], v[248:251], 0
    s_nop 11
    v_max3_f32 v21, v21, v64, v65
    v_max3_f32 v21, v21, v66, v67
    v_max3_f32 v21, v21, v68, v69
    v_max3_f32 v21, v21, v70, v71
    v_max3_f32 v21, v21, v72, v73
    v_max3_f32 v21, v21, v74, v75
    v_max3_f32 v21, v21, v76, v77
    v_max3_f32 v21, v21, v78, v79
    s_cmp_eq_u32 s57, 1
    s_cbranch_scc1 L_f1done
    v_mfma_f32_32x32x16_bf16 v[48:63], a[12:15], v[244:247], 0
    s_nop 11
    v_max3_f32 v20, v20, v80, v81
    v_max3_f32 v20, v20, v82, v83
    v_max3_f32 v20, v20, v84, v85
    v_max3_f32 v20, v20, v86, v87
    v_max3_f32 v20, v20, v88, v89
    v_max3_f32 v20, v20, v90, v91
    v_max3_f32 v20, v20, v92, v93
    v_max3_f32 v20, v20, v94, v95
    v_mfma_f32_32x32x16_bf16 v[64:79], a[12:15], v[248:251], 0
    s_nop 11
    v_max3_f32 v21, v21, v32, v33
    v_max3_f32 v21, v21, v34, v35
    v_max3_f32 v21, v21, v36, v37
    v_max3_f32 v21, v21, v38, v39
    v_max3_f32 v21, v21, v40, v41
    v_max3_f32 v21, v21, v42, v43
    v_max3_f32 v21, v21, v44, v45
    v_max3_f32 v21, v21, v46, v47
    v_mfma_f32_32x32x16_bf16 v[80:95], a[16:19], v[244:247], 0
    s_nop 11
    v_max3_f32 v20, v20, v48, v49
    v_max3_f32 v20, v20, v50, v51
    v_max3_f32 v20, v20, v52, v53
    v_max3_f32 v20, v20, v54, v55
    v_max3_f32 v20, v20, v56, v57
    v_max3_f32 v20, v20, v58, v59
    v_max3_f32 v20, v20, v60, v61
    v_max3_f32 v20, v20, v62, v63
    v_mfma_f32_32x32x16_bf16 v[32:47], a[16:19], v[248:251], 0
    s_nop 11
    v_max3_f32 v21, v21, v64, v65
    v_max3_f32 v21, v21, v66, v67
    v_max3_f32 v21, v21, v68, v69
    v_max3_f32 v21, v21, v70, v71
    v_max3_f32 v21, v21, v72, v73
    v_max3_f32 v21, v21, v74, v75
    v_max3_f32 v21, v21, v76, v77
    v_max3_f32 v21, v21, v78, v79
    s_cmp_eq_u32 s57, 3
    s_cbranch_scc1 L_f1done
    v_mfma_f32_32x32x16_bf16 v[48:63], a[20:23], v[244:247], 0
    s_nop 11
    v_max3_f32 v20, v20, v80, v81
    v_max3_f32 v20, v20, v82, v83
    v_max3_f32 v20, v20, v84, v85
    v_max3_f32 v20, v20, v86, v87
    v_max3_f32 v20, v20, v88, v89
    v_max3_f32 v20, v20, v90, v91
    v_max3_f32 v20, v20, v92, v93
    v_max3_f32 v20, v20, v94, v95
    v_mfma_f32_32x32x16_bf16 v[64:79], a[20:23], v[248:251], 0
    s_nop 11
    v_max3_f32 v21, v21, v32, v33
    v_max3_f32 v21, v21, v34, v35
    v_max3_f32 v21, v21, v36, v37
    v_max3_f32 v21, v21, v38, v39
    v_max3_f32 v21, v21, v40, v41
    v_max3_f32 v21, v21, v42, v43
    v_max3_f32 v21, v21, v44, v45
    v_max3_f32 v21, v21, v46, v47
    v_mfma_f32_32x32x16_bf16 v[80:95], a[24:27], v[244:247], 0
    s_nop 11
    v_max3_f32 v20, v20, v48, v49
    v_max3_f32 v20, v20, v50, v51
    v_max3_f32 v20, v20, v52, v53
    v_max3_f32 v20, v20, v54, v55
    v_max3_f32 v20, v20, v56, v57
    v_max3_f32 v20, v20, v58, v59
    v_max3_f32 v20, v20, v60, v61
    v_max3_f32 v20, v20, v62, v63
    v_mfma_f32_32x32x16_bf16 v[32:47], a[24:27], v[248:251], 0
    s_nop 11
    v_max3_f32 v21, v21, v64, v65
    v_max3_f32 v21, v21, v66, v67
    v_max3_f32 v21, v21, v68, v69
    v_max3_f32 v21, v21, v70, v71
    v_max3_f32 v21, v21, v72, v73
    v_max3_f32 v21, v21, v74, v75
    v_max3_f32 v21, v21, v76, v77
    v_max3_f32 v21, v21, v78, v79
    s_cmp_eq_u32 s57, 5
    s_cbranch_scc1 L_f1done
    v_mfma_f32_32x32x16_bf16 v[48:63], a[28:31], v[244:247], 0
    s_nop 11
    v_max3_f32 v20, v20, v80, v81
    v_max3_f32 v20, v20, v82, v83
    v_max3_f32 v20, v20, v84, v85
    v_max3_f32 v20, v20, v86, v87
    v_max3_f32 v20, v20, v88, v89
    v_max3_f32 v20, v20, v90, v91
    v_max3_f32 v20, v20, v92, v93
    v_max3_f32 v20, v20, v94, v95
    v_mfma_f32_32x32x16_bf16 v[64:79], a[28:31], v[248:251], 0
    s_nop 11
    v_max3_f32 v21, v21, v32, v33
    v_max3_f32 v21, v21, v34, v35
    v_max3_f32 v21, v21, v36, v37
    v_max3_f32 v21, v21, v38, v39
    v_max3_f32 v21, v21, v40, v41
    v_max3_f32 v21, v21, v42, v43
    v_max3_f32 v21, v21, v44, v45
    v_max3_f32 v21, v21, v46, v47
    v_mfma_f32_32x32x16_bf16 v[80:95], a[32:35], v[244:247], 0
    s_nop 11
    v_max3_f32 v20, v20, v48, v49
    v_max3_f32 v20, v20, v50, v51
    v_max3_f32 v20, v20, v52, v53
    v_max3_f32 v20, v20, v54, v55
    v_max3_f32 v20, v20, v56, v57
    v_max3_f32 v20, v20, v58, v59
    v_max3_f32 v20, v20, v60, v61
    v_max3_f32 v20, v20, v62, v63
    v_mfma_f32_32x32x16_bf16 v[32:47], a[32:35], v[248:251], v[144:159]
    s_nop 11
    v_max3_f32 v21, v21, v64, v65
    v_max3_f32 v21, v21, v66, v67
    v_max3_f32 v21, v21, v68, v69
    v_max3_f32 v21, v21, v70, v71
    v_max3_f32 v21, v21, v72, v73
    v_max3_f32 v21, v21, v74, v75
    v_max3_f32 v21, v21, v76, v77
    v_max3_f32 v21, v21, v78, v79
    s_cmp_eq_u32 s57, 7
    s_cbranch_scc1 L_f1done
    v_mfma_f32_32x32x16_bf16 v[48:63], a[36:39], v[244:247], v[144:159]
    s_nop 11
    v_max3_f32 v20, v20, v80, v81
    v_max3_f32 v20, v20, v82, v83
    v_max3_f32 v20, v20, v84, v85
    v_max3_f32 v20, v20, v86, v87
    v_max3_f32 v20, v20, v88, v89
    v_max3_f32 v20, v20, v90, v91
    v_max3_f32 v20, v20, v92, v93
    v_max3_f32 v20, v20, v94, v95
    s_nop 11
    v_max3_f32 v21, v21, v32, v33
    v_max3_f32 v21, v21, v34, v35
    v_max3_f32 v21, v21, v36, v37
    v_max3_f32 v21, v21, v38, v39
    v_max3_f32 v21, v21, v40, v41
    v_max3_f32 v21, v21, v42, v43
    v_max3_f32 v21, v21, v44, v45
    v_max3_f32 v21, v21, v46, v47
    s_nop 11
    v_max3_f32 v20, v20, v48, v49
    v_max3_f32 v20, v20, v50, v51
    v_max3_f32 v20, v20, v52, v53
    v_max3_f32 v20, v20, v54, v55
    v_max3_f32 v20, v20, v56, v57
    v_max3_f32 v20, v20, v58, v59
    v_max3_f32 v20, v20, v60, v61
    v_max3_f32 v20, v20, v62, v63
L_f1done:
    s_nop 15
    v_mov_b32 v18, v20
    v_mov_b32 v19, v21
    s_nop 1
    v_permlane32_swap_b32 v20, v18
    v_permlane32_swap_b32 v21, v19
    v_max_f32 v20, v20, v18
    v_max_f32 v21, v21, v19
    v_sub_f32 v112, 0, v21
    v_sub_f32 v113, 0, v21
    v_sub_f32 v114, 0, v21
    v_sub_f32 v115, 0, v21
    v_sub_f32 v116, 0, v21
    v_sub_f32 v117, 0, v21
    v_sub_f32 v118, 0, v21
    v_sub_f32 v119, 0, v21
    v_sub_f32 v120, 0, v21
    v_sub_f32 v121, 0, v21
    v_sub_f32 v122, 0, v21
    v_sub_f32 v123, 0, v21
    v_sub_f32 v124, 0, v21
    v_sub_f32 v125, 0, v21
    v_sub_f32 v126, 0, v21
    v_sub_f32 v127, 0, v21
    v_sub_f32 v96, 0, v20
    v_sub_f32 v97, 0, v20
    v_mfma_f32_32x32x16_bf16 v[32:47], a[0:3], v[248:251], v[112:127]
    v_sub_f32 v98, 0, v20
    v_sub_f32 v99, 0, v20
    v_sub_f32 v100, 0, v20
    v_sub_f32 v101, 0, v20
    v_sub_f32 v102, 0, v20
    v_sub_f32 v103, 0, v20
    v_sub_f32 v104, 0, v20
    v_sub_f32 v105, 0, v20
    v_sub_f32 v106, 0, v20
    v_sub_f32 v107, 0, v20
    v_sub_f32 v108, 0, v20
    v_sub_f32 v109, 0, v20
    v_sub_f32 v110, 0, v20
    v_sub_f32 v111, 0, v20
    s_nop 1
    v_mfma_f32_32x32x16_bf16 v[48:63], a[4:7], v[244:247], v[96:111]
    s_nop 11
    v_exp_f32 v32, v32
    v_exp_f32 v33, v33
    v_exp_f32 v34, v34
    v_exp_f32 v35, v35
    v_exp_f32 v36, v36
    v_exp_f32 v37, v37
    v_mfma_f32_32x32x16_bf16 v[64:79], a[4:7], v[248:251], v[112:127]
    v_exp_f32 v38, v38
    v_exp_f32 v39, v39
    v_cvt_pk_bf16_f32 v200, v32, v33
    v_cvt_pk_bf16_f32 v201, v34, v35
    v_cvt_pk_bf16_f32 v202, v36, v37
    v_cvt_pk_bf16_f32 v203, v38, v39
    v_and_b32 v200, v160, v200
    v_and_b32 v201, v161, v201
    v_and_b32 v202, v162, v202
    v_and_b32 v203, v163, v203
    v_exp_f32 v40, v40
    v_exp_f32 v41, v41
    v_mfma_f32_32x32x16_bf16 v[184:199], a[40:43], v[200:203], 0
    v_exp_f32 v42, v42
    v_exp_f32 v43, v43
    v_exp_f32 v44, v44
    v_exp_f32 v45, v45
    v_exp_f32 v46, v46
    v_exp_f32 v47, v47
    v_cvt_pk_bf16_f32 v204, v40, v41
    v_cvt_pk_bf16_f32 v205, v42, v43
    v_cvt_pk_bf16_f32 v206, v44, v45
    v_cvt_pk_bf16_f32 v207, v46, v47
    v_and_b32 v204, v164, v204
    v_and_b32 v205, v165, v205
    v_and_b32 v206, v166, v206
    v_and_b32 v207, v167, v207
    v_exp_f32 v48, v48
    v_exp_f32 v49, v49
    v_mfma_f32_32x32x16_bf16 v[184:199], a[44:47], v[204:207], v[184:199]
    v_exp_f32 v50, v50
    v_exp_f32 v51, v51
    v_exp_f32 v52, v52
    v_exp_f32 v53, v53
    v_mfma_f32_32x32x16_bf16 v[80:95], a[8:11], v[244:247], v[96:111]
    v_exp_f32 v54, v54
    v_exp_f32 v55, v55
    v_cvt_pk_bf16_f32 v208, v48, v49
    v_cvt_pk_bf16_f32 v209, v50, v51
    v_cvt_pk_bf16_f32 v210, v52, v53
    v_cvt_pk_bf16_f32 v211, v54, v55
    v_and_b32 v208, v160, v208
    v_and_b32 v209, v161, v209
    v_and_b32 v210, v162, v210
    v_and_b32 v211, v163, v211
    v_exp_f32 v56, v56
    v_exp_f32 v57, v57
    v_mfma_f32_32x32x16_bf16 v[168:183], a[48:51], v[208:211], 0
    v_exp_f32 v58, v58
    v_exp_f32 v59, v59
    v_exp_f32 v60, v60
    v_exp_f32 v61, v61
    v_exp_f32 v62, v62
    v_exp_f32 v63, v63
    v_cvt_pk_bf16_f32 v212, v56, v57
    v_cvt_pk_bf16_f32 v213, v58, v59
    v_cvt_pk_bf16_f32 v214, v60, v61
    v_cvt_pk_bf16_f32 v215, v62, v63
    v_and_b32 v212, v164, v212
    v_and_b32 v213, v165, v213
    v_and_b32 v214, v166, v214
    v_and_b32 v215, v167, v215
    v_exp_f32 v64, v64
    v_exp_f32 v65, v65
    v_mfma_f32_32x32x16_bf16 v[168:183], a[52:55], v[212:215], v[168:183]
    v_exp_f32 v66, v66
    v_exp_f32 v67, v67
    v_exp_f32 v68, v68
    v_exp_f32 v69, v69
    v_mfma_f32_32x32x16_bf16 v[32:47], a[8:11], v[248:251], v[112:127]
    v_exp_f32 v70, v70
    v_exp_f32 v71, v71
    v_cvt_pk_bf16_f32 v200, v64, v65
    v_cvt_pk_bf16_f32 v201, v66, v67
    v_cvt_pk_bf16_f32 v202, v68, v69
    v_cvt_pk_bf16_f32 v203, v70, v71
    v_exp_f32 v72, v72
    v_exp_f32 v73, v73
    v_mfma_f32_32x32x16_bf16 v[184:199], a[48:51], v[200:203], v[184:199]
    v_exp_f32 v74, v74
    v_exp_f32 v75, v75
    v_exp_f32 v76, v76
    v_exp_f32 v77, v77
    v_exp_f32 v78, v78
    v_exp_f32 v79, v79
    v_cvt_pk_bf16_f32 v204, v72, v73
    v_cvt_pk_bf16_f32 v205, v74, v75
    v_cvt_pk_bf16_f32 v206, v76, v77
    v_cvt_pk_bf16_f32 v207, v78, v79
    s_cmp_eq_u32 s57, 1
    s_nop 0
    v_mfma_f32_32x32x16_bf16 v[184:199], a[52:55], v[204:207], v[184:199]
    s_cbranch_scc1 L_f2done
    v_exp_f32 v80, v80
    v_exp_f32 v81, v81
    v_exp_f32 v82, v82
    v_exp_f32 v83, v83
    v_exp_f32 v84, v84
    v_exp_f32 v85, v85
    v_mfma_f32_32x32x16_bf16 v[48:63], a[12:15], v[244:247], v[96:111]
    v_exp_f32 v86, v86
    v_exp_f32 v87, v87
    v_cvt_pk_bf16_f32 v208, v80, v81
    v_cvt_pk_bf16_f32 v209, v82, v83
    v_cvt_pk_bf16_f32 v210, v84, v85
    v_cvt_pk_bf16_f32 v211, v86, v87
    v_exp_f32 v88, v88
    v_exp_f32 v89, v89
    v_mfma_f32_32x32x16_bf16 v[168:183], a[56:59], v[208:211], v[168:183]
    v_exp_f32 v90, v90
    v_exp_f32 v91, v91
    v_exp_f32 v92, v92
    v_exp_f32 v93, v93
    v_exp_f32 v94, v94
    v_exp_f32 v95, v95
    v_cvt_pk_bf16_f32 v212, v88, v89
    v_cvt_pk_bf16_f32 v213, v90, v91
    v_cvt_pk_bf16_f32 v214, v92, v93
    v_cvt_pk_bf16_f32 v215, v94, v95
    v_exp_f32 v32, v32
    v_exp_f32 v33, v33
    v_mfma_f32_32x32x16_bf16 v[168:183], a[60:63], v[212:215], v[168:183]
    v_exp_f32 v34, v34
    v_exp_f32 v35, v35
    v_exp_f32 v36, v36
    v_exp_f32 v37, v37
    v_mfma_f32_32x32x16_bf16 v[64:79], a[12:15], v[248:251], v[112:127]
    v_exp_f32 v38, v38
    v_exp_f32 v39, v39
    v_cvt_pk_bf16_f32 v200, v32, v33
    v_cvt_pk_bf16_f32 v201, v34, v35
    v_cvt_pk_bf16_f32 v202, v36, v37
    v_cvt_pk_bf16_f32 v203, v38, v39
    v_exp_f32 v40, v40
    v_exp_f32 v41, v41
    v_mfma_f32_32x32x16_bf16 v[184:199], a[56:59], v[200:203], v[184:199]
    v_exp_f32 v42, v42
    v_exp_f32 v43, v43
    v_exp_f32 v44, v44
    v_exp_f32 v45, v45
    v_exp_f32 v46, v46
    v_exp_f32 v47, v47
    v_cvt_pk_bf16_f32 v204, v40, v41
    v_cvt_pk_bf16_f32 v205, v42, v43
    v_cvt_pk_bf16_f32 v206, v44, v45
    v_cvt_pk_bf16_f32 v207, v46, v47
    v_exp_f32 v48, v48
    v_exp_f32 v49, v49
    v_mfma_f32_32x32x16_bf16 v[184:199], a[60:63], v[204:207], v[184:199]
    v_exp_f32 v50, v50
    v_exp_f32 v51, v51
    v_exp_f32 v52, v52
    v_exp_f32 v53, v53
    v_mfma_f32_32x32x16_bf16 v[80:95], a[16:19], v[244:247], v[96:111]
    v_exp_f32 v54, v54
    v_exp_f32 v55, v55
    v_cvt_pk_bf16_f32 v208, v48, v49
    v_cvt_pk_bf16_f32 v209, v50, v51
    v_cvt_pk_bf16_f32 v210, v52, v53
    v_cvt_pk_bf16_f32 v211, v54, v55
    v_exp_f32 v56, v56
    v_exp_f32 v57, v57
    v_mfma_f32_32x32x16_bf16 v[168:183], a[64:67], v[208:211], v[168:183]
    v_exp_f32 v58, v58
    v_exp_f32 v59, v59
    v_exp_f32 v60, v60
    v_exp_f32 v61, v61
    v_exp_f32 v62, v62
    v_exp_f32 v63, v63
    v_cvt_pk_bf16_f32 v212, v56, v57
    v_cvt_pk_bf16_f32 v213, v58, v59
    v_cvt_pk_bf16_f32 v214, v60, v61
    v_cvt_pk_bf16_f32 v215, v62, v63
    v_exp_f32 v64, v64
    v_exp_f32 v65, v65
    v_mfma_f32_32x32x16_bf16 v[168:183], a[68:71], v[212:215], v[168:183]
    v_exp_f32 v66, v66
    v_exp_f32 v67, v67
    v_exp_f32 v68, v68
    v_exp_f32 v69, v69
    v_mfma_f32_32x32x16_bf16 v[32:47], a[16:19], v[248:251], v[112:127]
    v_exp_f32 v70, v70
    v_exp_f32 v71, v71
    v_cvt_pk_bf16_f32 v200, v64, v65
    v_cvt_pk_bf16_f32 v201, v66, v67
    v_cvt_pk_bf16_f32 v202, v68, v69
    v_cvt_pk_bf16_f32 v203, v70, v71
    v_exp_f32 v72, v72
    v_exp_f32 v73, v73
    v_mfma_f32_32x32x16_bf16 v[184:199], a[64:67], v[200:203], v[184:199]
    v_exp_f32 v74, v74
    v_exp_f32 v75, v75
    v_exp_f32 v76, v76
    v_exp_f32 v77, v77
    v_exp_f32 v78, v78
    v_exp_f32 v79, v79
    v_cvt_pk_bf16_f32 v204, v72, v73
    v_cvt_pk_bf16_f32 v205, v74, v75
    v_cvt_pk_bf16_f32 v206, v76, v77
    v_cvt_pk_bf16_f32 v207, v78, v79
    s_cmp_eq_u32 s57, 3
    s_nop 0
    v_mfma_f32_32x32x16_bf16 v[184:199], a[68:71], v[204:207], v[184:199]
    s_cbranch_scc1 L_f2done
    v_exp_f32 v80, v80
    v_exp_f32 v81, v81
    v_exp_f32 v82, v82
    v_exp_f32 v83, v83
    v_exp_f32 v84, v84
    v_exp_f32 v85, v85
    v_mfma_f32_32x32x16_bf16 v[48:63], a[20:23], v[244:247], v[96:111]
    v_exp_f32 v86, v86
    v_exp_f32 v87, v87
    v_cvt_pk_bf16_f32 v208, v80, v81
    v_cvt_pk_bf16_f32 v209, v82, v83
    v_cvt_pk_bf16_f32 v210, v84, v85
    v_cvt_pk_bf16_f32 v211, v86, v87
    v_exp_f32 v88, v88
    v_exp_f32 v89, v89
    v_mfma_f32_32x32x16_bf16 v[168:183], a[72:75], v[208:211], v[168:183]
    v_exp_f32 v90, v90
    v_exp_f32 v91, v91
    v_exp_f32 v92, v92
    v_exp_f32 v93, v93
    v_exp_f32 v94, v94
    v_exp_f32 v95, v95
    v_cvt_pk_bf16_f32 v212, v88, v89
    v_cvt_pk_bf16_f32 v213, v90, v91
    v_cvt_pk_bf16_f32 v214, v92, v93
    v_cvt_pk_bf16_f32 v215, v94, v95
    v_exp_f32 v32, v32
    v_exp_f32 v33, v33
    v_mfma_f32_32x32x16_bf16 v[168:183], a[76:79], v[212:215], v[168:183]
    v_exp_f32 v34, v34
    v_exp_f32 v35, v35
    v_exp_f32 v36, v36
    v_exp_f32 v37, v37
    v_mfma_f32_32x32x16_bf16 v[64:79], a[20:23], v[248:251], v[112:127]
    v_exp_f32 v38, v38
    v_exp_f32 v39, v39
    v_cvt_pk_bf16_f32 v200, v32, v33
    v_cvt_pk_bf16_f32 v201, v34, v35
    v_cvt_pk_bf16_f32 v202, v36, v37
    v_cvt_pk_bf16_f32 v203, v38, v39
    v_exp_f32 v40, v40
    v_exp_f32 v41, v41
    v_mfma_f32_32x32x16_bf16 v[184:199], a[72:75], v[200:203], v[184:199]
    v_exp_f32 v42, v42
    v_exp_f32 v43, v43
    v_exp_f32 v44, v44
    v_exp_f32 v45, v45
    v_exp_f32 v46, v46
    v_exp_f32 v47, v47
    v_cvt_pk_bf16_f32 v204, v40, v41
    v_cvt_pk_bf16_f32 v205, v42, v43
    v_cvt_pk_bf16_f32 v206, v44, v45
    v_cvt_pk_bf16_f32 v207, v46, v47
    v_exp_f32 v48, v48
    v_exp_f32 v49, v49
    v_mfma_f32_32x32x16_bf16 v[184:199], a[76:79], v[204:207], v[184:199]
    v_exp_f32 v50, v50
    v_exp_f32 v51, v51
    v_exp_f32 v52, v52
    v_exp_f32 v53, v53
    v_mfma_f32_32x32x16_bf16 v[80:95], a[24:27], v[244:247], v[96:111]
    v_exp_f32 v54, v54
    v_exp_f32 v55, v55
    v_cvt_pk_bf16_f32 v208, v48, v49
    v_cvt_pk_bf16_f32 v209, v50, v51
    v_cvt_pk_bf16_f32 v210, v52, v53
    v_cvt_pk_bf16_f32 v211, v54, v55
    v_exp_f32 v56, v56
    v_exp_f32 v57, v57
    v_mfma_f32_32x32x16_bf16 v[168:183], a[80:83], v[208:211], v[168:183]
    v_exp_f32 v58, v58
    v_exp_f32 v59, v59
    v_exp_f32 v60, v60
    v_exp_f32 v61, v61
    v_exp_f32 v62, v62
    v_exp_f32 v63, v63
    v_cvt_pk_bf16_f32 v212, v56, v57
    v_cvt_pk_bf16_f32 v213, v58, v59
    v_cvt_pk_bf16_f32 v214, v60, v61
    v_cvt_pk_bf16_f32 v215, v62, v63
    v_exp_f32 v64, v64
    v_exp_f32 v65, v65
    v_mfma_f32_32x32x16_bf16 v[168:183], a[84:87], v[212:215], v[168:183]
    v_exp_f32 v66, v66
    v_exp_f32 v67, v67
    v_exp_f32 v68, v68
    v_exp_f32 v69, v69
    v_mfma_f32_32x32x16_bf16 v[32:47], a[24:27], v[248:251], v[112:127]
    v_exp_f32 v70, v70
    v_exp_f32 v71, v71
    v_cvt_pk_bf16_f32 v200, v64, v65
    v_cvt_pk_bf16_f32 v201, v66, v67
    v_cvt_pk_bf16_f32 v202, v68, v69
    v_cvt_pk_bf16_f32 v203, v70, v71
    v_exp_f32 v72, v72
    v_exp_f32 v73, v73
    v_mfma_f32_32x32x16_bf16 v[184:199], a[80:83], v[200:203], v[184:199]
    v_exp_f32 v74, v74
    v_exp_f32 v75, v75
    v_exp_f32 v76, v76
    v_exp_f32 v77, v77
    v_exp_f32 v78, v78
    v_exp_f32 v79, v79
    v_cvt_pk_bf16_f32 v204, v72, v73
    v_cvt_pk_bf16_f32 v205, v74, v75
    v_cvt_pk_bf16_f32 v206, v76, v77
    v_cvt_pk_bf16_f32 v207, v78, v79
    s_cmp_eq_u32 s57, 5
    s_nop 0
    v_mfma_f32_32x32x16_bf16 v[184:199], a[84:87], v[204:207], v[184:199]
    s_cbranch_scc1 L_f2done
    v_exp_f32 v80, v80
    v_exp_f32 v81, v81
    v_exp_f32 v82, v82
    v_exp_f32 v83, v83
    v_exp_f32 v84, v84
    v_exp_f32 v85, v85
    v_mfma_f32_32x32x16_bf16 v[48:63], a[28:31], v[244:247], v[96:111]
    v_exp_f32 v86, v86
    v_exp_f32 v87, v87
    v_cvt_pk_bf16_f32 v208, v80, v81
    v_cvt_pk_bf16_f32 v209, v82, v83
    v_cvt_pk_bf16_f32 v210, v84, v85
    v_cvt_pk_bf16_f32 v211, v86, v87
    v_exp_f32 v88, v88
    v_exp_f32 v89, v89
    v_mfma_f32_32x32x16_bf16 v[168:183], a[88:91], v[208:211], v[168:183]
    v_exp_f32 v90, v90
    v_exp_f32 v91, v91
    v_exp_f32 v92, v92
    v_exp_f32 v93, v93
    v_exp_f32 v94, v94
    v_exp_f32 v95, v95
    v_cvt_pk_bf16_f32 v212, v88, v89
    v_cvt_pk_bf16_f32 v213, v90, v91
    v_cvt_pk_bf16_f32 v214, v92, v93
    v_cvt_pk_bf16_f32 v215, v94, v95
    v_exp_f32 v32, v32
    v_exp_f32 v33, v33
    v_mfma_f32_32x32x16_bf16 v[168:183], a[92:95], v[212:215], v[168:183]
    v_exp_f32 v34, v34
    v_exp_f32 v35, v35
    v_exp_f32 v36, v36
    v_exp_f32 v37, v37
    v_mfma_f32_32x32x16_bf16 v[64:79], a[28:31], v[248:251], v[112:127]
    v_exp_f32 v38, v38
    v_exp_f32 v39, v39
    v_cvt_pk_bf16_f32 v200, v32, v33
    v_cvt_pk_bf16_f32 v201, v34, v35
    v_cvt_pk_bf16_f32 v202, v36, v37
    v_cvt_pk_bf16_f32 v203, v38, v39
    v_exp_f32 v40, v40
    v_exp_f32 v41, v41
    v_mfma_f32_32x32x16_bf16 v[184:199], a[88:91], v[200:203], v[184:199]
    v_exp_f32 v42, v42
    v_exp_f32 v43, v43
    v_exp_f32 v44, v44
    v_exp_f32 v45, v45
    v_exp_f32 v46, v46
    v_exp_f32 v47, v47
    v_cvt_pk_bf16_f32 v204, v40, v41
    v_cvt_pk_bf16_f32 v205, v42, v43
    v_cvt_pk_bf16_f32 v206, v44, v45
    v_cvt_pk_bf16_f32 v207, v46, v47
    v_exp_f32 v48, v48
    v_exp_f32 v49, v49
    v_mfma_f32_32x32x16_bf16 v[184:199], a[92:95], v[204:207], v[184:199]
    v_exp_f32 v50, v50
    v_exp_f32 v51, v51
    v_exp_f32 v52, v52
    v_exp_f32 v53, v53
    v_mfma_f32_32x32x16_bf16 v[80:95], a[32:35], v[244:247], v[96:111]
    v_exp_f32 v54, v54
    v_exp_f32 v55, v55
    v_cvt_pk_bf16_f32 v208, v48, v49
    v_cvt_pk_bf16_f32 v209, v50, v51
    v_cvt_pk_bf16_f32 v210, v52, v53
    v_cvt_pk_bf16_f32 v211, v54, v55
    v_exp_f32 v56, v56
    v_exp_f32 v57, v57
    v_mfma_f32_32x32x16_bf16 v[168:183], a[96:99], v[208:211], v[168:183]
    v_exp_f32 v58, v58
    v_exp_f32 v59, v59
    v_exp_f32 v60, v60
    v_exp_f32 v61, v61
    v_exp_f32 v62, v62
    v_exp_f32 v63, v63
    v_cvt_pk_bf16_f32 v212, v56, v57
    v_cvt_pk_bf16_f32 v213, v58, v59
    v_cvt_pk_bf16_f32 v214, v60, v61
    v_cvt_pk_bf16_f32 v215, v62, v63
    v_exp_f32 v64, v64
    v_exp_f32 v65, v65
    v_mfma_f32_32x32x16_bf16 v[168:183], a[100:103], v[212:215], v[168:183]
    v_exp_f32 v66, v66
    v_exp_f32 v67, v67
    v_exp_f32 v68, v68
    v_exp_f32 v69, v69
    v_mfma_f32_32x32x16_bf16 v[32:47], a[32:35], v[248:251], v[112:127]
    v_exp_f32 v70, v70
    v_exp_f32 v71, v71
    v_cvt_pk_bf16_f32 v200, v64, v65
    v_cvt_pk_bf16_f32 v201, v66, v67
    v_cvt_pk_bf16_f32 v202, v68, v69
    v_cvt_pk_bf16_f32 v203, v70, v71
    v_exp_f32 v72, v72
    v_exp_f32 v73, v73
    v_mfma_f32_32x32x16_bf16 v[184:199], a[96:99], v[200:203], v[184:199]
    v_exp_f32 v74, v74
    v_exp_f32 v75, v75
    v_exp_f32 v76, v76
    v_exp_f32 v77, v77
    v_exp_f32 v78, v78
    v_exp_f32 v79, v79
    v_cvt_pk_bf16_f32 v204, v72, v73
    v_cvt_pk_bf16_f32 v205, v74, v75
    v_cvt_pk_bf16_f32 v206, v76, v77
    v_cvt_pk_bf16_f32 v207, v78, v79
    s_cmp_eq_u32 s57, 7
    s_nop 0
    v_mfma_f32_32x32x16_bf16 v[184:199], a[100:103], v[204:207], v[184:199]
    s_cbranch_scc1 L_f2done
    v_exp_f32 v80, v80
    v_exp_f32 v81, v81
    v_exp_f32 v82, v82
    v_exp_f32 v83, v83
    v_exp_f32 v84, v84
    v_exp_f32 v85, v85
    v_mfma_f32_32x32x16_bf16 v[48:63], a[36:39], v[244:247], v[96:111]
    v_exp_f32 v86, v86
    v_exp_f32 v87, v87
    v_cvt_pk_bf16_f32 v208, v80, v81
    v_cvt_pk_bf16_f32 v209, v82, v83
    v_cvt_pk_bf16_f32 v210, v84, v85
    v_cvt_pk_bf16_f32 v211, v86, v87
    v_exp_f32 v88, v88
    v_exp_f32 v89, v89
    v_mfma_f32_32x32x16_bf16 v[168:183], a[104:107], v[208:211], v[168:183]
    v_exp_f32 v90, v90
    v_exp_f32 v91, v91
    v_exp_f32 v92, v92
    v_exp_f32 v93, v93
    v_exp_f32 v94, v94
    v_exp_f32 v95, v95
    v_cvt_pk_bf16_f32 v212, v88, v89
    v_cvt_pk_bf16_f32 v213, v90, v91
    v_cvt_pk_bf16_f32 v214, v92, v93
    v_cvt_pk_bf16_f32 v215, v94, v95
    v_exp_f32 v32, v32
    v_exp_f32 v33, v33
    v_mfma_f32_32x32x16_bf16 v[168:183], a[108:111], v[212:215], v[168:183]
    v_exp_f32 v34, v34
    v_exp_f32 v35, v35
    v_exp_f32 v36, v36
    v_exp_f32 v37, v37
    v_exp_f32 v38, v38
    v_exp_f32 v39, v39
    v_cvt_pk_bf16_f32 v200, v32, v33
    v_cvt_pk_bf16_f32 v201, v34, v35
    v_cvt_pk_bf16_f32 v202, v36, v37
    v_cvt_pk_bf16_f32 v203, v38, v39
    v_bfi_b32 v200, v160, 0, v200
    v_bfi_b32 v201, v161, 0, v201
    v_bfi_b32 v202, v162, 0, v202
    v_bfi_b32 v203, v163, 0, v203
    v_exp_f32 v40, v40
    v_exp_f32 v41, v41
    v_mfma_f32_32x32x16_bf16 v[184:199], a[104:107], v[200:203], v[184:199]
    v_exp_f32 v42, v42
    v_exp_f32 v43, v43
    v_exp_f32 v44, v44
    v_exp_f32 v45, v45
    v_exp_f32 v46, v46
    v_exp_f32 v47, v47
    v_cvt_pk_bf16_f32 v204, v40, v41
    v_cvt_pk_bf16_f32 v205, v42, v43
    v_cvt_pk_bf16_f32 v206, v44, v45
    v_cvt_pk_bf16_f32 v207, v46, v47
    v_bfi_b32 v204, v164, 0, v204
    v_bfi_b32 v205, v165, 0, v205
    v_bfi_b32 v206, v166, 0, v206
    v_bfi_b32 v207, v167, 0, v207
    v_exp_f32 v48, v48
    v_exp_f32 v49, v49
    v_mfma_f32_32x32x16_bf16 v[184:199], a[108:111], v[204:207], v[184:199]
    v_exp_f32 v50, v50
    v_exp_f32 v51, v51
    v_exp_f32 v52, v52
    v_exp_f32 v53, v53
    v_exp_f32 v54, v54
    v_exp_f32 v55, v55
    v_cvt_pk_bf16_f32 v208, v48, v49
    v_cvt_pk_bf16_f32 v209, v50, v51
    v_cvt_pk_bf16_f32 v210, v52, v53
    v_cvt_pk_bf16_f32 v211, v54, v55
    v_bfi_b32 v208, v160, 0, v208
    v_bfi_b32 v209, v161, 0, v209
    v_bfi_b32 v210, v162, 0, v210
    v_bfi_b32 v211, v163, 0, v211
    v_exp_f32 v56, v56
    v_exp_f32 v57, v57
    v_mfma_f32_32x32x16_bf16 v[168:183], a[112:115], v[208:211], v[168:183]
    v_exp_f32 v58, v58
    v_exp_f32 v59, v59
    v_exp_f32 v60, v60
    v_exp_f32 v61, v61
    v_exp_f32 v62, v62
    v_exp_f32 v63, v63
    v_cvt_pk_bf16_f32 v212, v56, v57
    v_cvt_pk_bf16_f32 v213, v58, v59
    v_cvt_pk_bf16_f32 v214, v60, v61
    v_cvt_pk_bf16_f32 v215, v62, v63
    v_bfi_b32 v212, v164, 0, v212
    v_bfi_b32 v213, v165, 0, v213
    v_bfi_b32 v214, v166, 0, v214
    v_bfi_b32 v215, v167, 0, v215
    s_nop 0
    s_nop 0
    v_mfma_f32_32x32x16_bf16 v[168:183], a[116:119], v[212:215], v[168:183]
L_f2done:
    s_nop 15
    s_waitcnt vmcnt(0)
    v_rcp_f32 v20, v192
    s_nop 0
    v_pk_mul_f32 v[184:185], v[184:185], v[20:21] op_sel_hi:[1,0]
    v_pk_mul_f32 v[186:187], v[186:187], v[20:21] op_sel_hi:[1,0]
    v_pk_mul_f32 v[188:189], v[188:189], v[20:21] op_sel_hi:[1,0]
    v_pk_mul_f32 v[190:191], v[190:191], v[20:21] op_sel_hi:[1,0]
    v_cvt_pk_bf16_f32 v36, v184, v185
    v_cvt_pk_bf16_f32 v37, v186, v187
    v_cvt_pk_bf16_f32 v38, v188, v189
    v_cvt_pk_bf16_f32 v39, v190, v191
    v_rcp_f32 v18, v176
    buffer_store_dwordx4 v[36:39], v1, s[24:27], s58 offen sc1
    v_pk_mul_f32 v[168:169], v[168:169], v[18:19] op_sel_hi:[1,0]
    v_pk_mul_f32 v[170:171], v[170:171], v[18:19] op_sel_hi:[1,0]
    v_pk_mul_f32 v[172:173], v[172:173], v[18:19] op_sel_hi:[1,0]
    v_pk_mul_f32 v[174:175], v[174:175], v[18:19] op_sel_hi:[1,0]
    v_cvt_pk_bf16_f32 v32, v168, v169
    v_cvt_pk_bf16_f32 v33, v170, v171
    v_cvt_pk_bf16_f32 v34, v172, v173
    v_cvt_pk_bf16_f32 v35, v174, v175
    buffer_store_dwordx4 v[32:35], v1, s[24:27], s59 offen sc1
    s_branch L_p2ok
.section .rodata,"a"
.p2align 6
.amdhsa_kernel interleave_layers__sliding_block__glu_gated_reglu__prompt_kernel
  .amdhsa_next_free_vgpr 512
  .amdhsa_next_free_sgpr 102
  .amdhsa_accum_offset 256
  .amdhsa_group_segment_fixed_size 0
  .amdhsa_kernarg_size 80
  .amdhsa_user_sgpr_count 2
  .amdhsa_user_sgpr_kernarg_segment_ptr 1
  .amdhsa_system_sgpr_workgroup_id_x 1
.end_amdhsa_kernel
```
